```python
import torch

def _softmax(x, axis=-1):
    return torch.softmax(x, dim=axis)

def _gelu(x):
    return torch.nn.functional.gelu(x, approximate='tanh')

def _silu(x):
    return torch.nn.functional.silu(x)

def _sigmoid(x):
    return torch.sigmoid(x)

def _layernorm(x, axis=-1, eps=1e-05):
    m = x.mean(dim=axis, keepdim=True)
    v = x.var(dim=axis, keepdim=True, unbiased=False)
    return (x - m) / torch.sqrt(v + eps)

def _scatter_add(tgt, idx, src, axis=0):
    return tgt.clone().index_add_(axis, idx, src)

def _segment_sum(src, seg, n):
    out = torch.zeros((n,) + src.shape[1:], dtype=src.dtype)
    return out.index_add_(0, seg, src)

def _pad(x, pw):
    flat = tuple((v for pair in reversed(pw) for v in pair))
    return torch.nn.functional.pad(x, flat)
kernel_name = 'gated_mix__memory_aug_recurrent_mem_tr__ssm_conv_h3__prompt'

def setup_inputs():

    _w = lambda a: (lambda t: t.to(torch.bfloat16) if t.is_floating_point() else t)(torch.as_tensor(a))

    def _A_setup():
        B, S, Dm = (1, 2048, 512)
        H, Dh = (32, 128)
        M, seg = (8, 32)
        seg = min(seg, S)
        S = S // seg * seg
        return {'x': _w((lambda *s: torch.randn(*s, dtype=torch.bfloat16) * 0.05)(B, S, Dm)), 'mem0': _w((lambda *s: torch.randn(*s, dtype=torch.bfloat16) * 0.4)(B, M, Dm)), 'Wq': _w((lambda *s: torch.randn(*s, dtype=torch.bfloat16) * 6.4)(Dm, H, Dh) * Dm ** (-0.5)), 'Wk': _w((lambda *s: torch.randn(*s, dtype=torch.bfloat16) * 6.4)(Dm, H, Dh) * Dm ** (-0.5)), 'Wv': _w((lambda *s: torch.randn(*s, dtype=torch.bfloat16) * 0.4)(Dm, H, Dh) * Dm ** (-0.5)), 'Wo': _w((lambda *s: torch.randn(*s, dtype=torch.bfloat16) * 0.4)(H, Dh, Dm) * (H * Dh) ** (-0.5)), 'seg_len': seg}
    _A_in = _A_setup()

    def _B_setup():
        B, S, D = (1, 2048, 512)
        ks = 4
        return {'q': _w((lambda *s: torch.randn(*s, dtype=torch.bfloat16) * 0.05)(B, S, D)), 'k': _w((lambda *s: torch.randn(*s, dtype=torch.bfloat16) * 0.4)(B, S, D)), 'v': _w((lambda *s: torch.randn(*s, dtype=torch.bfloat16) * 0.4)(B, S, D)), 'shift_k': _w((lambda *s: torch.randn(*s, dtype=torch.bfloat16) * 0.4)(D, ks) * 0.5), 'ssm_k': _w((lambda *s: torch.randn(*s, dtype=torch.bfloat16) * 0.4)(D, S) * (1.0 / S ** 0.5)), 'ssm_D': _w((lambda *s: torch.randn(*s, dtype=torch.bfloat16) * 0.4)(D))}
    _B_in = _B_setup()
    return {'A_x': _A_in['x'], 'A_mem0': _A_in['mem0'], 'A_Wq': _A_in['Wq'], 'A_Wk': _A_in['Wk'], 'A_Wv': _A_in['Wv'], 'A_Wo': _A_in['Wo'], 'A_seg_len': _A_in['seg_len'], 'B_q': _B_in['q'], 'B_k': _B_in['k'], 'B_v': _B_in['v'], 'B_shift_k': _B_in['shift_k'], 'B_ssm_k': _B_in['ssm_k'], 'B_ssm_D': _B_in['ssm_D'], 'gate_w': _w((lambda *s: torch.randn(*s, dtype=torch.bfloat16) * 0.05)(512) * 16.0)}

def reference(A_x, A_mem0, A_Wq, A_Wk, A_Wv, A_Wo, A_seg_len, B_q, B_k, B_v, B_shift_k, B_ssm_k, B_ssm_D, gate_w):

    def _A_ref(x, mem0, Wq, Wk, Wv, Wo, seg_len):
        B, S, Dm = x.shape
        H, Dh = (Wq.shape[1], Wq.shape[2])
        M = mem0.shape[1]
        scale = Dh ** (-0.5)
        n_seg = S // seg_len
        L = M + seg_len
        idx = torch.arange(L)
        mask = (idx[:, None] < M) | (idx[:, None] >= idx[None, :])
        mem = mem0
        outs = []
        for s in range(n_seg):
            xs = x[:, s * seg_len:(s + 1) * seg_len, :].clone()
            h = torch.concatenate([mem, xs], axis=1)
            q = torch.einsum('btd,dhe->bhte', h, Wq)
            k = torch.einsum('btd,dhe->bhte', h, Wk)
            v = torch.einsum('btd,dhe->bhte', h, Wv)
            scores = torch.einsum('bhqe,bhke->bhqk', q, k) * scale
            scores = torch.where(mask[None, None], scores, -1000000000.0)
            p = _softmax(scores, axis=-1)
            o = torch.einsum('bhqk,bhke->bhqe', p, v)
            o = torch.einsum('bhte,hed->btd', o, Wo)
            mem = o[:, :M, :].clone()
            outs.append(o[:, M:, :])
        return torch.concatenate(outs, axis=1)

    def _B_ref(q, k, v, shift_k, ssm_k, ssm_D):
        B, S, D = q.shape
        ks = shift_k.shape[-1]
        k_pad = _pad(k, ((0, 0), (ks - 1, 0), (0, 0)))
        k_shift = torch.zeros_like(k)
        for t in range(ks):
            k_shift = k_shift + k_pad[:, t:t + S, :] * shift_k[:, ks - 1 - t][None, None, :]
        kv = k_shift * v
        L = 2 * S
        kv_pad = _pad(kv, ((0, 0), (0, S), (0, 0)))
        kf_pad = _pad(ssm_k, ((0, 0), (0, S)))
        kv_f = (lambda x, axes=(-2, -1): torch.fft.rfft2(x.float(), dim=axes))(kv_pad[:, None, :, :], axes=(1, 2))
        kf_f = (lambda x, axes=(-2, -1): torch.fft.rfft2(x.float(), dim=axes))(kf_pad[:, None, :], axes=(1, 2))
        kf_f = (lambda x, *d: x.permute(*d))(kf_f, 1, 2, 0)
        y_f = kv_f * kf_f[None, :, :, :]
        y = (lambda x, s, axes=(-2, -1): torch.fft.irfft2(x, s=s, dim=axes).to(torch.bfloat16))(y_f, (1, L), axes=(1, 2))[:, 0, :S, :]
        y = y + kv * ssm_D[None, None, :]
        return q * y
    x = A_x
    g = _sigmoid((x * gate_w).sum(-1, keepdims=True))
    a = _A_ref(x, A_mem0, A_Wq, A_Wk, A_Wv, A_Wo, A_seg_len)
    b = _B_ref(x, B_k, B_v, B_shift_k, B_ssm_k, B_ssm_D)
    return g * a + (1 - g) * b
```

```asm
; @launch grid=(256,1,1) block=(256,1,1) lds=163840
.amdgcn_target "amdgcn-amd-amdhsa--gfx950"
.text
.globl gated_mix__memory_aug_recurrent_mem_tr__ssm_conv_h3__prompt_kernel
.p2align 8
.type gated_mix__memory_aug_recurrent_mem_tr__ssm_conv_h3__prompt_kernel,@function
gated_mix__memory_aug_recurrent_mem_tr__ssm_conv_h3__prompt_kernel:
  s_cmp_ge_u32 s2, 256
  s_cbranch_scc1 Lend2
  s_load_dwordx2 s[8:9], s[0:1], 120
  s_load_dwordx4 s[48:51], s[0:1], 16
  s_load_dwordx4 s[52:55], s[0:1], 32
  s_getreg_b32 s3, hwreg(HW_REG_XCC_ID, 0, 3)
  s_lshl_b32 s3, s3, 2
  s_lshr_b32 s3, 0x43720561, s3
  s_and_b32 s3, s3, 7
  s_lshl_b32 s4, s3, 2
  s_add_u32 s5, s3, 2
  s_mul_i32 s5, s5, 86
  s_lshr_b32 s5, s5, 8
  s_lshl_b32 s5, s5, 6
  s_add_u32 s4, s4, s5
  v_mov_b32 v1, s4
  v_mov_b32 v2, 1
  v_mov_b32 v4, 0
  v_cmp_eq_u32 vcc, 0, v0
  s_waitcnt lgkmcnt(0)
  s_and_saveexec_b64 s[20:21], vcc
  s_cbranch_execz Lnoat
  global_atomic_add v3, v1, v2, s[8:9] sc0
Lnoat:
  s_mov_b64 exec, s[20:21]
  s_waitcnt vmcnt(0)
  s_and_saveexec_b64 s[20:21], vcc
  ds_write_b32 v4, v3
  s_waitcnt lgkmcnt(0)
  s_mov_b64 exec, s[20:21]
  s_barrier
  ds_read_b32 v3, v4
  s_waitcnt lgkmcnt(0)
  v_readfirstlane_b32 s10, v3
  s_barrier
  s_cmp_ge_u32 s10, 32
  s_cbranch_scc1 Lend2
  s_lshl_b32 s2, s3, 5
  s_add_u32 s2, s2, s10
  s_cmp_eq_u32 s3, 0
  s_cbranch_scc1 Rchain
  s_sub_u32 s10, s2, 32
  s_cmp_ge_u32 s10, 160
  s_cbranch_scc1 Rconv
  s_cmp_ge_u32 s10, 128
  s_cbranch_scc1 Rwarm
  s_mul_i32 s4, s10, 256
  s_lshr_b32 s4, s4, 10
  s_mul_i32 s5, s4, 4
  s_sub_u32 s12, s10, s5
  s_mov_b32 s10, s4
  s_getpc_b64 s[40:41]
LpcH:
  v_lshlrev_b32 v255, 7, v0
  v_add_u32 v255, 0, v255
  v_min_u32 v255, Rconv-LpcH-4, v255
  global_load_dword v254, v255, s[40:41]
  s_load_dwordx2 s[4:5], s[0:1], 128
  s_load_dwordx2 s[8:9], s[0:1], 120
  s_load_dwordx4 s[48:51], s[0:1], 16
  s_load_dwordx2 s[52:53], s[0:1], 32
  s_load_dwordx2 s[56:57], s[0:1], 0
  v_lshrrev_b32 v5, 6, v0
  v_and_b32 v2, 63, v0
  v_readfirstlane_b32 s11, v5
  v_and_b32 v3, 15, v2
  v_lshrrev_b32 v4, 4, v2
  v_lshlrev_b32 v1, 4, v2
  s_mov_b32 s6, 268435456
  s_mov_b32 s7, 0x00020000
  s_mov_b32 s30, 4194304
  s_mov_b32 s31, 0x00020000
  s_mov_b32 s58, 2097152
  s_mov_b32 s59, 0x00020000
  s_mov_b32 s18, 262144
  s_mov_b32 s26, 1040356334
  v_lshlrev_b32 v5, 2, v4
  v_xor_b32 v5, v5, v3
  v_lshlrev_b32 v5, 4, v5
  v_lshl_add_u32 v5, v4, 13, v5
  s_lshl_b32 s36, s10, 8
  s_lshl_b32 s37, s11, 18
  s_add_u32 s36, s36, s37
  v_add_u32 v10, s36, v5
  v_lshrrev_b32 v5, 2, v3
  v_lshl_add_u32 v12, v4, 3, v5
  v_lshlrev_b32 v12, 8, v12
  v_xor_b32 v5, s11, v5
  v_and_b32 v11, 3, v3
  v_lshl_add_u32 v5, v5, 2, v11
  v_lshl_add_u32 v12, v5, 4, v12
  v_add_u32 v13, 65536, v12
  v_xor_b32 v5, v4, v3
  v_lshlrev_b32 v11, 10, v3
  v_add_u32 v11, 131072, v11
  v_xor_b32 v14, 0, v5
  v_lshl_add_u32 v6, v14, 4, v11
  v_xor_b32 v14, 4, v5
  v_lshl_add_u32 v7, v14, 4, v11
  v_xor_b32 v14, 8, v5
  v_lshl_add_u32 v8, v14, 4, v11
  v_xor_b32 v14, 12, v5
  v_lshl_add_u32 v9, v14, 4, v11
  s_lshl_b32 s38, s11, 13
  s_mov_b32 s13, s12
  s_mov_b32 s19, 131072
  s_waitcnt lgkmcnt(0)
  v_mul_u32_u24 v14, 16384, v2
  s_mul_i32 s36, s12, 4096
  s_mul_i32 s37, s10, 128
  s_add_u32 s36, s36, s37
  v_add_u32 v14, s36, v14
  s_lshl_b32 s22, s10, 7
  s_lshl_b32 s37, s12, 4
  s_add_u32 s22, s22, s37
  s_add_u32 s22, s22, 262144
  v_mov_b32 v15, s22
  v_cmp_gt_u32 vcc, 262144, v14
  s_add_u32 s22, s22, 78643200
  s_mov_b32 s36, 78643200
  v_cndmask_b32 v14, v15, v14, vcc
  v_mov_b32 v15, s12
  v_cndmask_b32 v15, v15, 0, vcc
  s_cmp_lg_u32 s11, 0
  s_cbranch_scc1 Hnz
  s_mov_b64 exec, 0x1ffff
  buffer_store_dword v15, v14, s[4:7], s36 offen sc1
  s_mov_b64 exec, -1
Hnz:
  s_lshl_b32 s36, s13, 15
  s_and_b32 s37, s11, 1
  s_lshl_b32 s39, s37, 14
  s_add_u32 s36, s36, s39
  s_lshr_b32 s39, s11, 1
  s_lshl_b32 s39, s39, 12
  s_add_u32 s36, s36, s39
  s_lshl_b32 s37, s37, 7
  s_add_u32 s40, s19, s38
  s_xor_b32 s39, s37, 0
  v_xor_b32 v14, s39, v1
  s_add_u32 m0, s40, 0
  s_add_u32 s39, s36, 0
  buffer_load_dwordx4 v14, s[56:59], s39 offen lds
  s_xor_b32 s39, s37, 16
  v_xor_b32 v14, s39, v1
  s_add_u32 m0, s40, 1024
  s_add_u32 s39, s36, 1024
  buffer_load_dwordx4 v14, s[56:59], s39 offen lds
  s_xor_b32 s39, s37, 32
  v_xor_b32 v14, s39, v1
  s_add_u32 m0, s40, 2048
  s_add_u32 s39, s36, 2048
  buffer_load_dwordx4 v14, s[56:59], s39 offen lds
  s_xor_b32 s39, s37, 48
  v_xor_b32 v14, s39, v1
  s_add_u32 m0, s40, 3072
  s_add_u32 s39, s36, 3072
  buffer_load_dwordx4 v14, s[56:59], s39 offen lds
  s_xor_b32 s39, s37, 64
  v_xor_b32 v14, s39, v1
  s_add_u32 m0, s40, 4096
  s_add_u32 s39, s36, 8192
  buffer_load_dwordx4 v14, s[56:59], s39 offen lds
  s_xor_b32 s39, s37, 80
  v_xor_b32 v14, s39, v1
  s_add_u32 m0, s40, 5120
  s_add_u32 s39, s36, 9216
  buffer_load_dwordx4 v14, s[56:59], s39 offen lds
  s_xor_b32 s39, s37, 96
  v_xor_b32 v14, s39, v1
  s_add_u32 m0, s40, 6144
  s_add_u32 s39, s36, 10240
  buffer_load_dwordx4 v14, s[56:59], s39 offen lds
  s_xor_b32 s39, s37, 112
  v_xor_b32 v14, s39, v1
  s_add_u32 m0, s40, 7168
  s_add_u32 s39, s36, 11264
  buffer_load_dwordx4 v14, s[56:59], s39 offen lds
  s_mov_b32 s28, s50
  s_mov_b32 s29, s51
  s_add_u32 m0, s38, 0
  s_mov_b32 s37, 0
  buffer_load_dwordx4 v10, s[28:31], s37 offen lds
  s_add_u32 m0, s38, 1024
  s_mov_b32 s37, 32768
  buffer_load_dwordx4 v10, s[28:31], s37 offen lds
  s_add_u32 m0, s38, 2048
  s_mov_b32 s37, 65536
  buffer_load_dwordx4 v10, s[28:31], s37 offen lds
  s_add_u32 m0, s38, 3072
  s_mov_b32 s37, 98304
  buffer_load_dwordx4 v10, s[28:31], s37 offen lds
  s_add_u32 m0, s38, 4096
  s_mov_b32 s37, 131072
  buffer_load_dwordx4 v10, s[28:31], s37 offen lds
  s_add_u32 m0, s38, 5120
  s_mov_b32 s37, 163840
  buffer_load_dwordx4 v10, s[28:31], s37 offen lds
  s_add_u32 m0, s38, 6144
  s_mov_b32 s37, 196608
  buffer_load_dwordx4 v10, s[28:31], s37 offen lds
  s_add_u32 m0, s38, 7168
  s_mov_b32 s37, 229376
  buffer_load_dwordx4 v10, s[28:31], s37 offen lds
  s_add_u32 m0, s38, 32768
  s_mov_b32 s37, 1048576
  buffer_load_dwordx4 v10, s[28:31], s37 offen lds
  s_add_u32 m0, s38, 33792
  s_mov_b32 s37, 1081344
  buffer_load_dwordx4 v10, s[28:31], s37 offen lds
  s_add_u32 m0, s38, 34816
  s_mov_b32 s37, 1114112
  buffer_load_dwordx4 v10, s[28:31], s37 offen lds
  s_add_u32 m0, s38, 35840
  s_mov_b32 s37, 1146880
  buffer_load_dwordx4 v10, s[28:31], s37 offen lds
  s_add_u32 m0, s38, 36864
  s_mov_b32 s37, 1179648
  buffer_load_dwordx4 v10, s[28:31], s37 offen lds
  s_add_u32 m0, s38, 37888
  s_mov_b32 s37, 1212416
  buffer_load_dwordx4 v10, s[28:31], s37 offen lds
  s_add_u32 m0, s38, 38912
  s_mov_b32 s37, 1245184
  buffer_load_dwordx4 v10, s[28:31], s37 offen lds
  s_add_u32 m0, s38, 39936
  s_mov_b32 s37, 1277952
  buffer_load_dwordx4 v10, s[28:31], s37 offen lds
  s_add_u32 m0, s38, 65536
  s_mov_b32 s37, 2097152
  buffer_load_dwordx4 v10, s[28:31], s37 offen lds
  s_add_u32 m0, s38, 66560
  s_mov_b32 s37, 2129920
  buffer_load_dwordx4 v10, s[28:31], s37 offen lds
  s_add_u32 m0, s38, 67584
  s_mov_b32 s37, 2162688
  buffer_load_dwordx4 v10, s[28:31], s37 offen lds
  s_add_u32 m0, s38, 68608
  s_mov_b32 s37, 2195456
  buffer_load_dwordx4 v10, s[28:31], s37 offen lds
  s_add_u32 m0, s38, 69632
  s_mov_b32 s37, 2228224
  buffer_load_dwordx4 v10, s[28:31], s37 offen lds
  s_add_u32 m0, s38, 70656
  s_mov_b32 s37, 2260992
  buffer_load_dwordx4 v10, s[28:31], s37 offen lds
  s_add_u32 m0, s38, 71680
  s_mov_b32 s37, 2293760
  buffer_load_dwordx4 v10, s[28:31], s37 offen lds
  s_add_u32 m0, s38, 72704
  s_mov_b32 s37, 2326528
  buffer_load_dwordx4 v10, s[28:31], s37 offen lds
  s_waitcnt vmcnt(16)
  s_barrier
  s_cmp_lg_u32 s11, 0
  s_cbranch_scc1 Hna
  v_mov_b32 v14, 40
  v_mov_b32 v15, 1
  s_mov_b64 exec, 1
  global_atomic_add v14, v15, s[8:9]
  s_mov_b64 exec, -1
Hna:
  s_add_u32 m0, s38, 98304
  s_mov_b32 s37, 3145728
  buffer_load_dwordx4 v10, s[28:31], s37 offen lds
  s_add_u32 m0, s38, 99328
  s_mov_b32 s37, 3178496
  buffer_load_dwordx4 v10, s[28:31], s37 offen lds
  s_add_u32 m0, s38, 100352
  s_mov_b32 s37, 3211264
  buffer_load_dwordx4 v10, s[28:31], s37 offen lds
  s_add_u32 m0, s38, 101376
  s_mov_b32 s37, 3244032
  buffer_load_dwordx4 v10, s[28:31], s37 offen lds
  s_add_u32 m0, s38, 102400
  s_mov_b32 s37, 3276800
  buffer_load_dwordx4 v10, s[28:31], s37 offen lds
  s_add_u32 m0, s38, 103424
  s_mov_b32 s37, 3309568
  buffer_load_dwordx4 v10, s[28:31], s37 offen lds
  s_add_u32 m0, s38, 104448
  s_mov_b32 s37, 3342336
  buffer_load_dwordx4 v10, s[28:31], s37 offen lds
  s_add_u32 m0, s38, 105472
  s_mov_b32 s37, 3375104
  buffer_load_dwordx4 v10, s[28:31], s37 offen lds
  ds_read_b64_tr_b16 a[0:1], v12 offset:0
  ds_read_b64_tr_b16 a[2:3], v12 offset:1024
  ds_read_b64_tr_b16 a[4:5], v12 offset:8
  ds_read_b64_tr_b16 a[6:7], v12 offset:1032
  ds_read_b64_tr_b16 a[8:9], v12 offset:8192
  ds_read_b64_tr_b16 a[10:11], v12 offset:9216
  ds_read_b64_tr_b16 a[12:13], v12 offset:8200
  ds_read_b64_tr_b16 a[14:15], v12 offset:9224
  s_waitcnt lgkmcnt(0)
  ds_read_b64_tr_b16 a[16:17], v12 offset:16384
  ds_read_b64_tr_b16 a[18:19], v12 offset:17408
  ds_read_b64_tr_b16 a[20:21], v12 offset:16392
  ds_read_b64_tr_b16 a[22:23], v12 offset:17416
  ds_read_b64_tr_b16 a[24:25], v12 offset:24576
  ds_read_b64_tr_b16 a[26:27], v12 offset:25600
  ds_read_b64_tr_b16 a[28:29], v12 offset:24584
  ds_read_b64_tr_b16 a[30:31], v12 offset:25608
  s_waitcnt lgkmcnt(0)
  s_waitcnt vmcnt(16)
  s_barrier
  s_mov_b32 s28, s52
  s_mov_b32 s29, s53
  s_add_u32 m0, s38, 0
  s_mov_b32 s37, 0
  buffer_load_dwordx4 v10, s[28:31], s37 offen lds
  s_add_u32 m0, s38, 1024
  s_mov_b32 s37, 32768
  buffer_load_dwordx4 v10, s[28:31], s37 offen lds
  s_add_u32 m0, s38, 2048
  s_mov_b32 s37, 65536
  buffer_load_dwordx4 v10, s[28:31], s37 offen lds
  s_add_u32 m0, s38, 3072
  s_mov_b32 s37, 98304
  buffer_load_dwordx4 v10, s[28:31], s37 offen lds
  s_add_u32 m0, s38, 4096
  s_mov_b32 s37, 131072
  buffer_load_dwordx4 v10, s[28:31], s37 offen lds
  s_add_u32 m0, s38, 5120
  s_mov_b32 s37, 163840
  buffer_load_dwordx4 v10, s[28:31], s37 offen lds
  s_add_u32 m0, s38, 6144
  s_mov_b32 s37, 196608
  buffer_load_dwordx4 v10, s[28:31], s37 offen lds
  s_add_u32 m0, s38, 7168
  s_mov_b32 s37, 229376
  buffer_load_dwordx4 v10, s[28:31], s37 offen lds
  ds_read_b64_tr_b16 a[32:33], v12 offset:32768
  ds_read_b64_tr_b16 a[34:35], v12 offset:33792
  ds_read_b64_tr_b16 a[36:37], v12 offset:32776
  ds_read_b64_tr_b16 a[38:39], v12 offset:33800
  ds_read_b64_tr_b16 a[40:41], v12 offset:40960
  ds_read_b64_tr_b16 a[42:43], v12 offset:41984
  ds_read_b64_tr_b16 a[44:45], v12 offset:40968
  ds_read_b64_tr_b16 a[46:47], v12 offset:41992
  s_waitcnt lgkmcnt(0)
  ds_read_b64_tr_b16 a[48:49], v12 offset:49152
  ds_read_b64_tr_b16 a[50:51], v12 offset:50176
  ds_read_b64_tr_b16 a[52:53], v12 offset:49160
  ds_read_b64_tr_b16 a[54:55], v12 offset:50184
  ds_read_b64_tr_b16 a[56:57], v12 offset:57344
  ds_read_b64_tr_b16 a[58:59], v12 offset:58368
  ds_read_b64_tr_b16 a[60:61], v12 offset:57352
  ds_read_b64_tr_b16 a[62:63], v12 offset:58376
  s_waitcnt lgkmcnt(0)
  s_waitcnt vmcnt(16)
  s_barrier
  s_add_u32 m0, s38, 32768
  s_mov_b32 s37, 1048576
  buffer_load_dwordx4 v10, s[28:31], s37 offen lds
  s_add_u32 m0, s38, 33792
  s_mov_b32 s37, 1081344
  buffer_load_dwordx4 v10, s[28:31], s37 offen lds
  s_add_u32 m0, s38, 34816
  s_mov_b32 s37, 1114112
  buffer_load_dwordx4 v10, s[28:31], s37 offen lds
  s_add_u32 m0, s38, 35840
  s_mov_b32 s37, 1146880
  buffer_load_dwordx4 v10, s[28:31], s37 offen lds
  s_add_u32 m0, s38, 36864
  s_mov_b32 s37, 1179648
  buffer_load_dwordx4 v10, s[28:31], s37 offen lds
  s_add_u32 m0, s38, 37888
  s_mov_b32 s37, 1212416
  buffer_load_dwordx4 v10, s[28:31], s37 offen lds
  s_add_u32 m0, s38, 38912
  s_mov_b32 s37, 1245184
  buffer_load_dwordx4 v10, s[28:31], s37 offen lds
  s_add_u32 m0, s38, 39936
  s_mov_b32 s37, 1277952
  buffer_load_dwordx4 v10, s[28:31], s37 offen lds
  ds_read_b64_tr_b16 a[64:65], v13 offset:0
  ds_read_b64_tr_b16 a[66:67], v13 offset:1024
  ds_read_b64_tr_b16 a[68:69], v13 offset:8
  ds_read_b64_tr_b16 a[70:71], v13 offset:1032
  ds_read_b64_tr_b16 a[72:73], v13 offset:8192
  ds_read_b64_tr_b16 a[74:75], v13 offset:9216
  ds_read_b64_tr_b16 a[76:77], v13 offset:8200
  ds_read_b64_tr_b16 a[78:79], v13 offset:9224
  s_waitcnt lgkmcnt(0)
  ds_read_b64_tr_b16 a[80:81], v13 offset:16384
  ds_read_b64_tr_b16 a[82:83], v13 offset:17408
  ds_read_b64_tr_b16 a[84:85], v13 offset:16392
  ds_read_b64_tr_b16 a[86:87], v13 offset:17416
  ds_read_b64_tr_b16 a[88:89], v13 offset:24576
  ds_read_b64_tr_b16 a[90:91], v13 offset:25600
  ds_read_b64_tr_b16 a[92:93], v13 offset:24584
  ds_read_b64_tr_b16 a[94:95], v13 offset:25608
  s_waitcnt lgkmcnt(0)
  s_waitcnt vmcnt(16)
  s_barrier
  s_add_u32 m0, s38, 65536
  s_mov_b32 s37, 2097152
  buffer_load_dwordx4 v10, s[28:31], s37 offen lds
  s_add_u32 m0, s38, 66560
  s_mov_b32 s37, 2129920
  buffer_load_dwordx4 v10, s[28:31], s37 offen lds
  s_add_u32 m0, s38, 67584
  s_mov_b32 s37, 2162688
  buffer_load_dwordx4 v10, s[28:31], s37 offen lds
  s_add_u32 m0, s38, 68608
  s_mov_b32 s37, 2195456
  buffer_load_dwordx4 v10, s[28:31], s37 offen lds
  s_add_u32 m0, s38, 69632
  s_mov_b32 s37, 2228224
  buffer_load_dwordx4 v10, s[28:31], s37 offen lds
  s_add_u32 m0, s38, 70656
  s_mov_b32 s37, 2260992
  buffer_load_dwordx4 v10, s[28:31], s37 offen lds
  s_add_u32 m0, s38, 71680
  s_mov_b32 s37, 2293760
  buffer_load_dwordx4 v10, s[28:31], s37 offen lds
  s_add_u32 m0, s38, 72704
  s_mov_b32 s37, 2326528
  buffer_load_dwordx4 v10, s[28:31], s37 offen lds
  ds_read_b64_tr_b16 a[96:97], v13 offset:32768
  ds_read_b64_tr_b16 a[98:99], v13 offset:33792
  ds_read_b64_tr_b16 a[100:101], v13 offset:32776
  ds_read_b64_tr_b16 a[102:103], v13 offset:33800
  ds_read_b64_tr_b16 a[104:105], v13 offset:40960
  ds_read_b64_tr_b16 a[106:107], v13 offset:41984
  ds_read_b64_tr_b16 a[108:109], v13 offset:40968
  ds_read_b64_tr_b16 a[110:111], v13 offset:41992
  s_waitcnt lgkmcnt(0)
  ds_read_b64_tr_b16 a[112:113], v13 offset:49152
  ds_read_b64_tr_b16 a[114:115], v13 offset:50176
  ds_read_b64_tr_b16 a[116:117], v13 offset:49160
  ds_read_b64_tr_b16 a[118:119], v13 offset:50184
  ds_read_b64_tr_b16 a[120:121], v13 offset:57344
  ds_read_b64_tr_b16 a[122:123], v13 offset:58368
  ds_read_b64_tr_b16 a[124:125], v13 offset:57352
  ds_read_b64_tr_b16 a[126:127], v13 offset:58376
  s_waitcnt lgkmcnt(0)
  s_waitcnt vmcnt(16)
  s_barrier
  s_add_u32 m0, s38, 98304
  s_mov_b32 s37, 3145728
  buffer_load_dwordx4 v10, s[28:31], s37 offen lds
  s_add_u32 m0, s38, 99328
  s_mov_b32 s37, 3178496
  buffer_load_dwordx4 v10, s[28:31], s37 offen lds
  s_add_u32 m0, s38, 100352
  s_mov_b32 s37, 3211264
  buffer_load_dwordx4 v10, s[28:31], s37 offen lds
  s_add_u32 m0, s38, 101376
  s_mov_b32 s37, 3244032
  buffer_load_dwordx4 v10, s[28:31], s37 offen lds
  s_add_u32 m0, s38, 102400
  s_mov_b32 s37, 3276800
  buffer_load_dwordx4 v10, s[28:31], s37 offen lds
  s_add_u32 m0, s38, 103424
  s_mov_b32 s37, 3309568
  buffer_load_dwordx4 v10, s[28:31], s37 offen lds
  s_add_u32 m0, s38, 104448
  s_mov_b32 s37, 3342336
  buffer_load_dwordx4 v10, s[28:31], s37 offen lds
  s_add_u32 m0, s38, 105472
  s_mov_b32 s37, 3375104
  buffer_load_dwordx4 v10, s[28:31], s37 offen lds
  ds_read_b64_tr_b16 a[128:129], v12 offset:0
  ds_read_b64_tr_b16 a[130:131], v12 offset:1024
  ds_read_b64_tr_b16 a[132:133], v12 offset:8
  ds_read_b64_tr_b16 a[134:135], v12 offset:1032
  ds_read_b64_tr_b16 a[136:137], v12 offset:8192
  ds_read_b64_tr_b16 a[138:139], v12 offset:9216
  ds_read_b64_tr_b16 a[140:141], v12 offset:8200
  ds_read_b64_tr_b16 a[142:143], v12 offset:9224
  s_waitcnt lgkmcnt(0)
  ds_read_b64_tr_b16 a[144:145], v12 offset:16384
  ds_read_b64_tr_b16 a[146:147], v12 offset:17408
  ds_read_b64_tr_b16 a[148:149], v12 offset:16392
  ds_read_b64_tr_b16 a[150:151], v12 offset:17416
  ds_read_b64_tr_b16 a[152:153], v12 offset:24576
  ds_read_b64_tr_b16 a[154:155], v12 offset:25600
  ds_read_b64_tr_b16 a[156:157], v12 offset:24584
  ds_read_b64_tr_b16 a[158:159], v12 offset:25608
  s_waitcnt lgkmcnt(0)
  s_waitcnt vmcnt(16)
  s_barrier
  s_mov_b32 s28, s48
  s_mov_b32 s29, s49
  s_add_u32 m0, s38, 0
  s_mov_b32 s37, 0
  buffer_load_dwordx4 v10, s[28:31], s37 offen lds
  s_add_u32 m0, s38, 1024
  s_mov_b32 s37, 32768
  buffer_load_dwordx4 v10, s[28:31], s37 offen lds
  s_add_u32 m0, s38, 2048
  s_mov_b32 s37, 65536
  buffer_load_dwordx4 v10, s[28:31], s37 offen lds
  s_add_u32 m0, s38, 3072
  s_mov_b32 s37, 98304
  buffer_load_dwordx4 v10, s[28:31], s37 offen lds
  s_add_u32 m0, s38, 4096
  s_mov_b32 s37, 131072
  buffer_load_dwordx4 v10, s[28:31], s37 offen lds
  s_add_u32 m0, s38, 5120
  s_mov_b32 s37, 163840
  buffer_load_dwordx4 v10, s[28:31], s37 offen lds
  s_add_u32 m0, s38, 6144
  s_mov_b32 s37, 196608
  buffer_load_dwordx4 v10, s[28:31], s37 offen lds
  s_add_u32 m0, s38, 7168
  s_mov_b32 s37, 229376
  buffer_load_dwordx4 v10, s[28:31], s37 offen lds
  ds_read_b64_tr_b16 a[160:161], v12 offset:32768
  ds_read_b64_tr_b16 a[162:163], v12 offset:33792
  ds_read_b64_tr_b16 a[164:165], v12 offset:32776
  ds_read_b64_tr_b16 a[166:167], v12 offset:33800
  ds_read_b64_tr_b16 a[168:169], v12 offset:40960
  ds_read_b64_tr_b16 a[170:171], v12 offset:41984
  ds_read_b64_tr_b16 a[172:173], v12 offset:40968
  ds_read_b64_tr_b16 a[174:175], v12 offset:41992
  s_waitcnt lgkmcnt(0)
  ds_read_b64_tr_b16 a[176:177], v12 offset:49152
  ds_read_b64_tr_b16 a[178:179], v12 offset:50176
  ds_read_b64_tr_b16 a[180:181], v12 offset:49160
  ds_read_b64_tr_b16 a[182:183], v12 offset:50184
  ds_read_b64_tr_b16 a[184:185], v12 offset:57344
  ds_read_b64_tr_b16 a[186:187], v12 offset:58368
  ds_read_b64_tr_b16 a[188:189], v12 offset:57352
  ds_read_b64_tr_b16 a[190:191], v12 offset:58376
  s_waitcnt lgkmcnt(0)
  s_waitcnt vmcnt(16)
  s_barrier
  s_add_u32 m0, s38, 32768
  s_mov_b32 s37, 1048576
  buffer_load_dwordx4 v10, s[28:31], s37 offen lds
  s_add_u32 m0, s38, 33792
  s_mov_b32 s37, 1081344
  buffer_load_dwordx4 v10, s[28:31], s37 offen lds
  s_add_u32 m0, s38, 34816
  s_mov_b32 s37, 1114112
  buffer_load_dwordx4 v10, s[28:31], s37 offen lds
  s_add_u32 m0, s38, 35840
  s_mov_b32 s37, 1146880
  buffer_load_dwordx4 v10, s[28:31], s37 offen lds
  s_add_u32 m0, s38, 36864
  s_mov_b32 s37, 1179648
  buffer_load_dwordx4 v10, s[28:31], s37 offen lds
  s_add_u32 m0, s38, 37888
  s_mov_b32 s37, 1212416
  buffer_load_dwordx4 v10, s[28:31], s37 offen lds
  s_add_u32 m0, s38, 38912
  s_mov_b32 s37, 1245184
  buffer_load_dwordx4 v10, s[28:31], s37 offen lds
  s_add_u32 m0, s38, 39936
  s_mov_b32 s37, 1277952
  buffer_load_dwordx4 v10, s[28:31], s37 offen lds
  ds_read_b64_tr_b16 a[192:193], v13 offset:0
  ds_read_b64_tr_b16 a[194:195], v13 offset:1024
  ds_read_b64_tr_b16 a[196:197], v13 offset:8
  ds_read_b64_tr_b16 a[198:199], v13 offset:1032
  ds_read_b64_tr_b16 a[200:201], v13 offset:8192
  ds_read_b64_tr_b16 a[202:203], v13 offset:9216
  ds_read_b64_tr_b16 a[204:205], v13 offset:8200
  ds_read_b64_tr_b16 a[206:207], v13 offset:9224
  s_waitcnt lgkmcnt(0)
  ds_read_b64_tr_b16 a[208:209], v13 offset:16384
  ds_read_b64_tr_b16 a[210:211], v13 offset:17408
  ds_read_b64_tr_b16 a[212:213], v13 offset:16392
  ds_read_b64_tr_b16 a[214:215], v13 offset:17416
  ds_read_b64_tr_b16 a[216:217], v13 offset:24576
  ds_read_b64_tr_b16 a[218:219], v13 offset:25600
  ds_read_b64_tr_b16 a[220:221], v13 offset:24584
  ds_read_b64_tr_b16 a[222:223], v13 offset:25608
  s_waitcnt lgkmcnt(0)
  s_waitcnt vmcnt(16)
  s_barrier
  s_add_u32 m0, s38, 65536
  s_mov_b32 s37, 2097152
  buffer_load_dwordx4 v10, s[28:31], s37 offen lds
  s_add_u32 m0, s38, 66560
  s_mov_b32 s37, 2129920
  buffer_load_dwordx4 v10, s[28:31], s37 offen lds
  s_add_u32 m0, s38, 67584
  s_mov_b32 s37, 2162688
  buffer_load_dwordx4 v10, s[28:31], s37 offen lds
  s_add_u32 m0, s38, 68608
  s_mov_b32 s37, 2195456
  buffer_load_dwordx4 v10, s[28:31], s37 offen lds
  s_add_u32 m0, s38, 69632
  s_mov_b32 s37, 2228224
  buffer_load_dwordx4 v10, s[28:31], s37 offen lds
  s_add_u32 m0, s38, 70656
  s_mov_b32 s37, 2260992
  buffer_load_dwordx4 v10, s[28:31], s37 offen lds
  s_add_u32 m0, s38, 71680
  s_mov_b32 s37, 2293760
  buffer_load_dwordx4 v10, s[28:31], s37 offen lds
  s_add_u32 m0, s38, 72704
  s_mov_b32 s37, 2326528
  buffer_load_dwordx4 v10, s[28:31], s37 offen lds
  ds_read_b64_tr_b16 a[224:225], v13 offset:32768
  ds_read_b64_tr_b16 a[226:227], v13 offset:33792
  ds_read_b64_tr_b16 a[228:229], v13 offset:32776
  ds_read_b64_tr_b16 a[230:231], v13 offset:33800
  ds_read_b64_tr_b16 a[232:233], v13 offset:40960
  ds_read_b64_tr_b16 a[234:235], v13 offset:41984
  ds_read_b64_tr_b16 a[236:237], v13 offset:40968
  ds_read_b64_tr_b16 a[238:239], v13 offset:41992
  s_waitcnt lgkmcnt(0)
  ds_read_b64_tr_b16 a[240:241], v13 offset:49152
  ds_read_b64_tr_b16 a[242:243], v13 offset:50176
  ds_read_b64_tr_b16 a[244:245], v13 offset:49160
  ds_read_b64_tr_b16 a[246:247], v13 offset:50184
  ds_read_b64_tr_b16 a[248:249], v13 offset:57344
  ds_read_b64_tr_b16 a[250:251], v13 offset:58368
  ds_read_b64_tr_b16 a[252:253], v13 offset:57352
  ds_read_b64_tr_b16 a[254:255], v13 offset:58376
  s_waitcnt lgkmcnt(0)
  s_waitcnt vmcnt(16)
  s_barrier
  s_add_u32 m0, s38, 98304
  s_mov_b32 s37, 3145728
  buffer_load_dwordx4 v10, s[28:31], s37 offen lds
  s_add_u32 m0, s38, 99328
  s_mov_b32 s37, 3178496
  buffer_load_dwordx4 v10, s[28:31], s37 offen lds
  s_add_u32 m0, s38, 100352
  s_mov_b32 s37, 3211264
  buffer_load_dwordx4 v10, s[28:31], s37 offen lds
  s_add_u32 m0, s38, 101376
  s_mov_b32 s37, 3244032
  buffer_load_dwordx4 v10, s[28:31], s37 offen lds
  s_add_u32 m0, s38, 102400
  s_mov_b32 s37, 3276800
  buffer_load_dwordx4 v10, s[28:31], s37 offen lds
  s_add_u32 m0, s38, 103424
  s_mov_b32 s37, 3309568
  buffer_load_dwordx4 v10, s[28:31], s37 offen lds
  s_add_u32 m0, s38, 104448
  s_mov_b32 s37, 3342336
  buffer_load_dwordx4 v10, s[28:31], s37 offen lds
  s_add_u32 m0, s38, 105472
  s_mov_b32 s37, 3375104
  buffer_load_dwordx4 v10, s[28:31], s37 offen lds
  ds_read_b64_tr_b16 v[128:129], v12 offset:0
  ds_read_b64_tr_b16 v[130:131], v12 offset:1024
  ds_read_b64_tr_b16 v[132:133], v12 offset:8
  ds_read_b64_tr_b16 v[134:135], v12 offset:1032
  ds_read_b64_tr_b16 v[136:137], v12 offset:8192
  ds_read_b64_tr_b16 v[138:139], v12 offset:9216
  ds_read_b64_tr_b16 v[140:141], v12 offset:8200
  ds_read_b64_tr_b16 v[142:143], v12 offset:9224
  s_waitcnt lgkmcnt(0)
  ds_read_b64_tr_b16 v[144:145], v12 offset:16384
  ds_read_b64_tr_b16 v[146:147], v12 offset:17408
  ds_read_b64_tr_b16 v[148:149], v12 offset:16392
  ds_read_b64_tr_b16 v[150:151], v12 offset:17416
  ds_read_b64_tr_b16 v[152:153], v12 offset:24576
  ds_read_b64_tr_b16 v[154:155], v12 offset:25600
  ds_read_b64_tr_b16 v[156:157], v12 offset:24584
  ds_read_b64_tr_b16 v[158:159], v12 offset:25608
  s_waitcnt lgkmcnt(0)
  s_waitcnt vmcnt(16)
  s_barrier
  ds_read_b64_tr_b16 v[160:161], v12 offset:32768
  ds_read_b64_tr_b16 v[162:163], v12 offset:33792
  ds_read_b64_tr_b16 v[164:165], v12 offset:32776
  ds_read_b64_tr_b16 v[166:167], v12 offset:33800
  ds_read_b64_tr_b16 v[168:169], v12 offset:40960
  ds_read_b64_tr_b16 v[170:171], v12 offset:41984
  ds_read_b64_tr_b16 v[172:173], v12 offset:40968
  ds_read_b64_tr_b16 v[174:175], v12 offset:41992
  s_waitcnt lgkmcnt(0)
  ds_read_b64_tr_b16 v[176:177], v12 offset:49152
  ds_read_b64_tr_b16 v[178:179], v12 offset:50176
  ds_read_b64_tr_b16 v[180:181], v12 offset:49160
  ds_read_b64_tr_b16 v[182:183], v12 offset:50184
  ds_read_b64_tr_b16 v[184:185], v12 offset:57344
  ds_read_b64_tr_b16 v[186:187], v12 offset:58368
  ds_read_b64_tr_b16 v[188:189], v12 offset:57352
  ds_read_b64_tr_b16 v[190:191], v12 offset:58376
  s_waitcnt lgkmcnt(0)
  s_waitcnt vmcnt(8)
  s_barrier
  ds_read_b64_tr_b16 v[192:193], v13 offset:0
  ds_read_b64_tr_b16 v[194:195], v13 offset:1024
  ds_read_b64_tr_b16 v[196:197], v13 offset:8
  ds_read_b64_tr_b16 v[198:199], v13 offset:1032
  ds_read_b64_tr_b16 v[200:201], v13 offset:8192
  ds_read_b64_tr_b16 v[202:203], v13 offset:9216
  ds_read_b64_tr_b16 v[204:205], v13 offset:8200
  ds_read_b64_tr_b16 v[206:207], v13 offset:9224
  s_waitcnt lgkmcnt(0)
  ds_read_b64_tr_b16 v[208:209], v13 offset:16384
  ds_read_b64_tr_b16 v[210:211], v13 offset:17408
  ds_read_b64_tr_b16 v[212:213], v13 offset:16392
  ds_read_b64_tr_b16 v[214:215], v13 offset:17416
  ds_read_b64_tr_b16 v[216:217], v13 offset:24576
  ds_read_b64_tr_b16 v[218:219], v13 offset:25600
  ds_read_b64_tr_b16 v[220:221], v13 offset:24584
  ds_read_b64_tr_b16 v[222:223], v13 offset:25608
  s_waitcnt lgkmcnt(0)
  s_waitcnt vmcnt(0)
  s_barrier
  ds_read_b64_tr_b16 v[224:225], v13 offset:32768
  ds_read_b64_tr_b16 v[226:227], v13 offset:33792
  ds_read_b64_tr_b16 v[228:229], v13 offset:32776
  ds_read_b64_tr_b16 v[230:231], v13 offset:33800
  ds_read_b64_tr_b16 v[232:233], v13 offset:40960
  ds_read_b64_tr_b16 v[234:235], v13 offset:41984
  ds_read_b64_tr_b16 v[236:237], v13 offset:40968
  ds_read_b64_tr_b16 v[238:239], v13 offset:41992
  s_waitcnt lgkmcnt(0)
  ds_read_b64_tr_b16 v[240:241], v13 offset:49152
  ds_read_b64_tr_b16 v[242:243], v13 offset:50176
  ds_read_b64_tr_b16 v[244:245], v13 offset:49160
  ds_read_b64_tr_b16 v[246:247], v13 offset:50184
  ds_read_b64_tr_b16 v[248:249], v13 offset:57344
  ds_read_b64_tr_b16 v[250:251], v13 offset:58368
  ds_read_b64_tr_b16 v[252:253], v13 offset:57352
  ds_read_b64_tr_b16 v[254:255], v13 offset:58376
  s_waitcnt lgkmcnt(0)
  v_lshrrev_b32 v5, 2, v3
  v_sub_u32 v5, v5, v4
  v_lshlrev_b32 v5, 3, v5
  v_and_b32 v11, 3, v3
  v_add_u32 v5, v5, v11
  s_and_b32 s36, s11, 1
  s_lshl_b32 s36, s36, 2
  v_add_u32 v5, s36, v5
  v_cmp_le_i32 s[60:61], 0, v5
  v_cmp_le_i32 s[62:63], 1, v5
  v_cmp_le_i32 s[64:65], 2, v5
  v_cmp_le_i32 s[66:67], 3, v5
  v_cmp_le_i32 s[68:69], 4, v5
  v_cmp_le_i32 s[70:71], 5, v5
  v_cmp_le_i32 s[72:73], 6, v5
  v_cmp_le_i32 s[74:75], 7, v5
  v_cmp_gt_u32 s[76:77], 2, v4
  v_and_b32 v2, 7, v3
  v_lshl_add_u32 v2, v4, 3, v2
  v_lshlrev_b32 v2, 4, v2
  s_lshl_b32 s36, s11, 11
  v_add_u32 v3, s36, v1
  v_add_u32 v3, 73728, v3
  v_add_u32 v4, 73728, v1
  s_lshr_b32 s36, s11, 1
  s_lshl_b32 s36, s36, 12
  v_add_u32 v5, s36, v4
  v_mov_b32 v10, 32
  v_mov_b32 v11, 0xff800000
  s_mov_b32 s15, s12
  s_mov_b32 s14, 0
  s_mov_b32 s20, 0
  s_mov_b32 s21, 0
  s_barrier
H1top:
  s_lshl_b32 s16, s15, 5
  s_add_u32 s16, s16, s10
  s_lshl_b32 s16, s16, 2
  s_add_u32 s16, s16, s11
  s_lshl_b32 s16, s16, 12
  s_add_u32 s15, s15, 4
  s_xor_b32 s19, s19, 229376
  s_cmp_ge_u32 s15, 64
  s_cbranch_scc1 H1nx
  s_lshl_b32 s36, s15, 15
  s_and_b32 s37, s11, 1
  s_lshl_b32 s39, s37, 14
  s_add_u32 s36, s36, s39
  s_lshr_b32 s39, s11, 1
  s_lshl_b32 s39, s39, 12
  s_add_u32 s36, s36, s39
  s_lshl_b32 s37, s37, 7
  s_add_u32 s40, s19, s38
  s_xor_b32 s39, s37, 0
  v_xor_b32 v14, s39, v1
  s_add_u32 m0, s40, 0
  s_add_u32 s39, s36, 0
  buffer_load_dwordx4 v14, s[56:59], s39 offen lds
  s_xor_b32 s39, s37, 16
  v_xor_b32 v14, s39, v1
  s_add_u32 m0, s40, 1024
  s_add_u32 s39, s36, 1024
  buffer_load_dwordx4 v14, s[56:59], s39 offen lds
  s_xor_b32 s39, s37, 32
  v_xor_b32 v14, s39, v1
  s_add_u32 m0, s40, 2048
  s_add_u32 s39, s36, 2048
  buffer_load_dwordx4 v14, s[56:59], s39 offen lds
  s_xor_b32 s39, s37, 48
  v_xor_b32 v14, s39, v1
  s_add_u32 m0, s40, 3072
  s_add_u32 s39, s36, 3072
  buffer_load_dwordx4 v14, s[56:59], s39 offen lds
  s_xor_b32 s39, s37, 64
  v_xor_b32 v14, s39, v1
  s_add_u32 m0, s40, 4096
  s_add_u32 s39, s36, 8192
  buffer_load_dwordx4 v14, s[56:59], s39 offen lds
  s_xor_b32 s39, s37, 80
  v_xor_b32 v14, s39, v1
  s_add_u32 m0, s40, 5120
  s_add_u32 s39, s36, 9216
  buffer_load_dwordx4 v14, s[56:59], s39 offen lds
  s_xor_b32 s39, s37, 96
  v_xor_b32 v14, s39, v1
  s_add_u32 m0, s40, 6144
  s_add_u32 s39, s36, 10240
  buffer_load_dwordx4 v14, s[56:59], s39 offen lds
  s_xor_b32 s39, s37, 112
  v_xor_b32 v14, s39, v1
  s_add_u32 m0, s40, 7168
  s_add_u32 s39, s36, 11264
  buffer_load_dwordx4 v14, s[56:59], s39 offen lds
H1nx:
  ds_read_b128 v[20:23], v6 offset:0
  ds_read_b128 v[24:27], v6 offset:16384
  ds_read_b128 v[28:31], v7 offset:0
  ds_read_b128 v[32:35], v7 offset:16384
  ds_read_b128 v[36:39], v8 offset:0
  ds_read_b128 v[40:43], v8 offset:16384
  s_waitcnt lgkmcnt(4)
  v_mfma_f32_16x16x32_bf16 v[44:47], a[0:3], v[20:23], 0
  v_mfma_f32_16x16x32_bf16 v[60:63], v[20:23], a[128:131], 0
  v_mfma_f32_16x16x32_bf16 v[76:79], v[128:131], v[20:23], 0
  v_mfma_f32_16x16x32_bf16 v[48:51], a[4:7], v[20:23], 0
  v_mfma_f32_16x16x32_bf16 v[64:67], v[20:23], a[132:135], 0
  v_mfma_f32_16x16x32_bf16 v[80:83], v[132:135], v[20:23], 0
  v_mfma_f32_16x16x32_bf16 v[52:55], a[0:3], v[24:27], 0
  v_mfma_f32_16x16x32_bf16 v[68:71], v[24:27], a[128:131], 0
  v_mfma_f32_16x16x32_bf16 v[84:87], v[128:131], v[24:27], 0
  v_mfma_f32_16x16x32_bf16 v[56:59], a[4:7], v[24:27], 0
  v_mfma_f32_16x16x32_bf16 v[72:75], v[24:27], a[132:135], 0
  v_mfma_f32_16x16x32_bf16 v[88:91], v[132:135], v[24:27], 0
  ds_read_b128 v[20:23], v9 offset:0
  ds_read_b128 v[24:27], v9 offset:16384
  s_waitcnt lgkmcnt(4)
  v_mfma_f32_16x16x32_bf16 v[44:47], a[8:11], v[28:31], v[44:47]
  v_mfma_f32_16x16x32_bf16 v[60:63], v[28:31], a[136:139], v[60:63]
  v_mfma_f32_16x16x32_bf16 v[76:79], v[136:139], v[28:31], v[76:79]
  v_mfma_f32_16x16x32_bf16 v[48:51], a[12:15], v[28:31], v[48:51]
  v_mfma_f32_16x16x32_bf16 v[64:67], v[28:31], a[140:143], v[64:67]
  v_mfma_f32_16x16x32_bf16 v[80:83], v[140:143], v[28:31], v[80:83]
  v_mfma_f32_16x16x32_bf16 v[52:55], a[8:11], v[32:35], v[52:55]
  v_mfma_f32_16x16x32_bf16 v[68:71], v[32:35], a[136:139], v[68:71]
  v_mfma_f32_16x16x32_bf16 v[84:87], v[136:139], v[32:35], v[84:87]
  v_mfma_f32_16x16x32_bf16 v[56:59], a[12:15], v[32:35], v[56:59]
  v_mfma_f32_16x16x32_bf16 v[72:75], v[32:35], a[140:143], v[72:75]
  v_mfma_f32_16x16x32_bf16 v[88:91], v[140:143], v[32:35], v[88:91]
  ds_read_b128 v[28:31], v6 offset:256
  ds_read_b128 v[32:35], v6 offset:16640
  s_waitcnt lgkmcnt(4)
  v_mfma_f32_16x16x32_bf16 v[44:47], a[16:19], v[36:39], v[44:47]
  v_mfma_f32_16x16x32_bf16 v[60:63], v[36:39], a[144:147], v[60:63]
  v_mfma_f32_16x16x32_bf16 v[76:79], v[144:147], v[36:39], v[76:79]
  v_mfma_f32_16x16x32_bf16 v[48:51], a[20:23], v[36:39], v[48:51]
  v_mfma_f32_16x16x32_bf16 v[64:67], v[36:39], a[148:151], v[64:67]
  v_mfma_f32_16x16x32_bf16 v[80:83], v[148:151], v[36:39], v[80:83]
  v_mfma_f32_16x16x32_bf16 v[52:55], a[16:19], v[40:43], v[52:55]
  v_mfma_f32_16x16x32_bf16 v[68:71], v[40:43], a[144:147], v[68:71]
  v_mfma_f32_16x16x32_bf16 v[84:87], v[144:147], v[40:43], v[84:87]
  v_mfma_f32_16x16x32_bf16 v[56:59], a[20:23], v[40:43], v[56:59]
  v_mfma_f32_16x16x32_bf16 v[72:75], v[40:43], a[148:151], v[72:75]
  v_mfma_f32_16x16x32_bf16 v[88:91], v[148:151], v[40:43], v[88:91]
  ds_read_b128 v[36:39], v7 offset:256
  ds_read_b128 v[40:43], v7 offset:16640
  s_waitcnt lgkmcnt(4)
  v_mfma_f32_16x16x32_bf16 v[44:47], a[24:27], v[20:23], v[44:47]
  v_mfma_f32_16x16x32_bf16 v[60:63], v[20:23], a[152:155], v[60:63]
  v_mfma_f32_16x16x32_bf16 v[76:79], v[152:155], v[20:23], v[76:79]
  v_mfma_f32_16x16x32_bf16 v[48:51], a[28:31], v[20:23], v[48:51]
  v_mfma_f32_16x16x32_bf16 v[64:67], v[20:23], a[156:159], v[64:67]
  v_mfma_f32_16x16x32_bf16 v[80:83], v[156:159], v[20:23], v[80:83]
  v_mfma_f32_16x16x32_bf16 v[52:55], a[24:27], v[24:27], v[52:55]
  v_mfma_f32_16x16x32_bf16 v[68:71], v[24:27], a[152:155], v[68:71]
  v_mfma_f32_16x16x32_bf16 v[84:87], v[152:155], v[24:27], v[84:87]
  v_mfma_f32_16x16x32_bf16 v[56:59], a[28:31], v[24:27], v[56:59]
  v_mfma_f32_16x16x32_bf16 v[72:75], v[24:27], a[156:159], v[72:75]
  v_mfma_f32_16x16x32_bf16 v[88:91], v[156:159], v[24:27], v[88:91]
  ds_read_b128 v[20:23], v8 offset:256
  ds_read_b128 v[24:27], v8 offset:16640
  s_waitcnt lgkmcnt(4)
  v_mfma_f32_16x16x32_bf16 v[44:47], a[32:35], v[28:31], v[44:47]
  v_mfma_f32_16x16x32_bf16 v[60:63], v[28:31], a[160:163], v[60:63]
  v_mfma_f32_16x16x32_bf16 v[76:79], v[160:163], v[28:31], v[76:79]
  v_mfma_f32_16x16x32_bf16 v[48:51], a[36:39], v[28:31], v[48:51]
  v_mfma_f32_16x16x32_bf16 v[64:67], v[28:31], a[164:167], v[64:67]
  v_mfma_f32_16x16x32_bf16 v[80:83], v[164:167], v[28:31], v[80:83]
  v_mfma_f32_16x16x32_bf16 v[52:55], a[32:35], v[32:35], v[52:55]
  v_mfma_f32_16x16x32_bf16 v[68:71], v[32:35], a[160:163], v[68:71]
  v_mfma_f32_16x16x32_bf16 v[84:87], v[160:163], v[32:35], v[84:87]
  v_mfma_f32_16x16x32_bf16 v[56:59], a[36:39], v[32:35], v[56:59]
  v_mfma_f32_16x16x32_bf16 v[72:75], v[32:35], a[164:167], v[72:75]
  v_mfma_f32_16x16x32_bf16 v[88:91], v[164:167], v[32:35], v[88:91]
  ds_read_b128 v[28:31], v9 offset:256
  ds_read_b128 v[32:35], v9 offset:16640
  s_waitcnt lgkmcnt(4)
  v_mfma_f32_16x16x32_bf16 v[44:47], a[40:43], v[36:39], v[44:47]
  v_mfma_f32_16x16x32_bf16 v[60:63], v[36:39], a[168:171], v[60:63]
  v_mfma_f32_16x16x32_bf16 v[76:79], v[168:171], v[36:39], v[76:79]
  v_mfma_f32_16x16x32_bf16 v[48:51], a[44:47], v[36:39], v[48:51]
  v_mfma_f32_16x16x32_bf16 v[64:67], v[36:39], a[172:175], v[64:67]
  v_mfma_f32_16x16x32_bf16 v[80:83], v[172:175], v[36:39], v[80:83]
  v_mfma_f32_16x16x32_bf16 v[52:55], a[40:43], v[40:43], v[52:55]
  v_mfma_f32_16x16x32_bf16 v[68:71], v[40:43], a[168:171], v[68:71]
  v_mfma_f32_16x16x32_bf16 v[84:87], v[168:171], v[40:43], v[84:87]
  v_mfma_f32_16x16x32_bf16 v[56:59], a[44:47], v[40:43], v[56:59]
  v_mfma_f32_16x16x32_bf16 v[72:75], v[40:43], a[172:175], v[72:75]
  v_mfma_f32_16x16x32_bf16 v[88:91], v[172:175], v[40:43], v[88:91]
  ds_read_b128 v[36:39], v6 offset:512
  ds_read_b128 v[40:43], v6 offset:16896
  s_waitcnt lgkmcnt(4)
  v_mfma_f32_16x16x32_bf16 v[44:47], a[48:51], v[20:23], v[44:47]
  v_mfma_f32_16x16x32_bf16 v[60:63], v[20:23], a[176:179], v[60:63]
  v_mfma_f32_16x16x32_bf16 v[76:79], v[176:179], v[20:23], v[76:79]
  v_mfma_f32_16x16x32_bf16 v[48:51], a[52:55], v[20:23], v[48:51]
  v_mfma_f32_16x16x32_bf16 v[64:67], v[20:23], a[180:183], v[64:67]
  v_mfma_f32_16x16x32_bf16 v[80:83], v[180:183], v[20:23], v[80:83]
  v_mfma_f32_16x16x32_bf16 v[52:55], a[48:51], v[24:27], v[52:55]
  v_mfma_f32_16x16x32_bf16 v[68:71], v[24:27], a[176:179], v[68:71]
  v_mfma_f32_16x16x32_bf16 v[84:87], v[176:179], v[24:27], v[84:87]
  v_mfma_f32_16x16x32_bf16 v[56:59], a[52:55], v[24:27], v[56:59]
  v_mfma_f32_16x16x32_bf16 v[72:75], v[24:27], a[180:183], v[72:75]
  v_mfma_f32_16x16x32_bf16 v[88:91], v[180:183], v[24:27], v[88:91]
  ds_read_b128 v[20:23], v7 offset:512
  ds_read_b128 v[24:27], v7 offset:16896
  s_waitcnt lgkmcnt(4)
  v_mfma_f32_16x16x32_bf16 v[44:47], a[56:59], v[28:31], v[44:47]
  v_mfma_f32_16x16x32_bf16 v[60:63], v[28:31], a[184:187], v[60:63]
  v_mfma_f32_16x16x32_bf16 v[76:79], v[184:187], v[28:31], v[76:79]
  v_mfma_f32_16x16x32_bf16 v[48:51], a[60:63], v[28:31], v[48:51]
  v_mfma_f32_16x16x32_bf16 v[64:67], v[28:31], a[188:191], v[64:67]
  v_mfma_f32_16x16x32_bf16 v[80:83], v[188:191], v[28:31], v[80:83]
  v_mfma_f32_16x16x32_bf16 v[52:55], a[56:59], v[32:35], v[52:55]
  v_mfma_f32_16x16x32_bf16 v[68:71], v[32:35], a[184:187], v[68:71]
  v_mfma_f32_16x16x32_bf16 v[84:87], v[184:187], v[32:35], v[84:87]
  v_mfma_f32_16x16x32_bf16 v[56:59], a[60:63], v[32:35], v[56:59]
  v_mfma_f32_16x16x32_bf16 v[72:75], v[32:35], a[188:191], v[72:75]
  v_mfma_f32_16x16x32_bf16 v[88:91], v[188:191], v[32:35], v[88:91]
  ds_read_b128 v[28:31], v8 offset:512
  ds_read_b128 v[32:35], v8 offset:16896
  s_waitcnt lgkmcnt(4)
  v_mfma_f32_16x16x32_bf16 v[44:47], a[64:67], v[36:39], v[44:47]
  v_mfma_f32_16x16x32_bf16 v[60:63], v[36:39], a[192:195], v[60:63]
  v_mfma_f32_16x16x32_bf16 v[76:79], v[192:195], v[36:39], v[76:79]
  v_mfma_f32_16x16x32_bf16 v[48:51], a[68:71], v[36:39], v[48:51]
  v_mfma_f32_16x16x32_bf16 v[64:67], v[36:39], a[196:199], v[64:67]
  v_mfma_f32_16x16x32_bf16 v[80:83], v[196:199], v[36:39], v[80:83]
  v_mfma_f32_16x16x32_bf16 v[52:55], a[64:67], v[40:43], v[52:55]
  v_mfma_f32_16x16x32_bf16 v[68:71], v[40:43], a[192:195], v[68:71]
  v_mfma_f32_16x16x32_bf16 v[84:87], v[192:195], v[40:43], v[84:87]
  v_mfma_f32_16x16x32_bf16 v[56:59], a[68:71], v[40:43], v[56:59]
  v_mfma_f32_16x16x32_bf16 v[72:75], v[40:43], a[196:199], v[72:75]
  v_mfma_f32_16x16x32_bf16 v[88:91], v[196:199], v[40:43], v[88:91]
  ds_read_b128 v[36:39], v9 offset:512
  ds_read_b128 v[40:43], v9 offset:16896
  s_waitcnt lgkmcnt(4)
  v_mfma_f32_16x16x32_bf16 v[44:47], a[72:75], v[20:23], v[44:47]
  v_mfma_f32_16x16x32_bf16 v[60:63], v[20:23], a[200:203], v[60:63]
  v_mfma_f32_16x16x32_bf16 v[76:79], v[200:203], v[20:23], v[76:79]
  v_mfma_f32_16x16x32_bf16 v[48:51], a[76:79], v[20:23], v[48:51]
  v_mfma_f32_16x16x32_bf16 v[64:67], v[20:23], a[204:207], v[64:67]
  v_mfma_f32_16x16x32_bf16 v[80:83], v[204:207], v[20:23], v[80:83]
  v_mfma_f32_16x16x32_bf16 v[52:55], a[72:75], v[24:27], v[52:55]
  v_mfma_f32_16x16x32_bf16 v[68:71], v[24:27], a[200:203], v[68:71]
  v_mfma_f32_16x16x32_bf16 v[84:87], v[200:203], v[24:27], v[84:87]
  v_mfma_f32_16x16x32_bf16 v[56:59], a[76:79], v[24:27], v[56:59]
  v_mfma_f32_16x16x32_bf16 v[72:75], v[24:27], a[204:207], v[72:75]
  v_mfma_f32_16x16x32_bf16 v[88:91], v[204:207], v[24:27], v[88:91]
  ds_read_b128 v[20:23], v6 offset:768
  ds_read_b128 v[24:27], v6 offset:17152
  s_waitcnt lgkmcnt(4)
  v_mfma_f32_16x16x32_bf16 v[44:47], a[80:83], v[28:31], v[44:47]
  v_mfma_f32_16x16x32_bf16 v[60:63], v[28:31], a[208:211], v[60:63]
  v_mfma_f32_16x16x32_bf16 v[76:79], v[208:211], v[28:31], v[76:79]
  v_mfma_f32_16x16x32_bf16 v[48:51], a[84:87], v[28:31], v[48:51]
  v_mfma_f32_16x16x32_bf16 v[64:67], v[28:31], a[212:215], v[64:67]
  v_mfma_f32_16x16x32_bf16 v[80:83], v[212:215], v[28:31], v[80:83]
  v_mfma_f32_16x16x32_bf16 v[52:55], a[80:83], v[32:35], v[52:55]
  v_mfma_f32_16x16x32_bf16 v[68:71], v[32:35], a[208:211], v[68:71]
  v_mfma_f32_16x16x32_bf16 v[84:87], v[208:211], v[32:35], v[84:87]
  v_mfma_f32_16x16x32_bf16 v[56:59], a[84:87], v[32:35], v[56:59]
  v_mfma_f32_16x16x32_bf16 v[72:75], v[32:35], a[212:215], v[72:75]
  v_mfma_f32_16x16x32_bf16 v[88:91], v[212:215], v[32:35], v[88:91]
  ds_read_b128 v[28:31], v7 offset:768
  ds_read_b128 v[32:35], v7 offset:17152
  s_waitcnt lgkmcnt(4)
  v_mfma_f32_16x16x32_bf16 v[44:47], a[88:91], v[36:39], v[44:47]
  v_mfma_f32_16x16x32_bf16 v[60:63], v[36:39], a[216:219], v[60:63]
  v_mfma_f32_16x16x32_bf16 v[76:79], v[216:219], v[36:39], v[76:79]
  v_mfma_f32_16x16x32_bf16 v[48:51], a[92:95], v[36:39], v[48:51]
  v_mfma_f32_16x16x32_bf16 v[64:67], v[36:39], a[220:223], v[64:67]
  v_mfma_f32_16x16x32_bf16 v[80:83], v[220:223], v[36:39], v[80:83]
  v_mfma_f32_16x16x32_bf16 v[52:55], a[88:91], v[40:43], v[52:55]
  v_mfma_f32_16x16x32_bf16 v[68:71], v[40:43], a[216:219], v[68:71]
  v_mfma_f32_16x16x32_bf16 v[84:87], v[216:219], v[40:43], v[84:87]
  v_mfma_f32_16x16x32_bf16 v[56:59], a[92:95], v[40:43], v[56:59]
  v_mfma_f32_16x16x32_bf16 v[72:75], v[40:43], a[220:223], v[72:75]
  v_mfma_f32_16x16x32_bf16 v[88:91], v[220:223], v[40:43], v[88:91]
  ds_read_b128 v[36:39], v8 offset:768
  ds_read_b128 v[40:43], v8 offset:17152
  s_waitcnt lgkmcnt(4)
  v_mfma_f32_16x16x32_bf16 v[44:47], a[96:99], v[20:23], v[44:47]
  v_mfma_f32_16x16x32_bf16 v[60:63], v[20:23], a[224:227], v[60:63]
  v_mfma_f32_16x16x32_bf16 v[76:79], v[224:227], v[20:23], v[76:79]
  v_mfma_f32_16x16x32_bf16 v[48:51], a[100:103], v[20:23], v[48:51]
  v_mfma_f32_16x16x32_bf16 v[64:67], v[20:23], a[228:231], v[64:67]
  v_mfma_f32_16x16x32_bf16 v[80:83], v[228:231], v[20:23], v[80:83]
  v_mfma_f32_16x16x32_bf16 v[52:55], a[96:99], v[24:27], v[52:55]
  v_mfma_f32_16x16x32_bf16 v[68:71], v[24:27], a[224:227], v[68:71]
  v_mfma_f32_16x16x32_bf16 v[84:87], v[224:227], v[24:27], v[84:87]
  v_mfma_f32_16x16x32_bf16 v[56:59], a[100:103], v[24:27], v[56:59]
  v_mfma_f32_16x16x32_bf16 v[72:75], v[24:27], a[228:231], v[72:75]
  v_mfma_f32_16x16x32_bf16 v[88:91], v[228:231], v[24:27], v[88:91]
  ds_read_b128 v[20:23], v9 offset:768
  ds_read_b128 v[24:27], v9 offset:17152
  s_waitcnt lgkmcnt(4)
  v_mfma_f32_16x16x32_bf16 v[44:47], a[104:107], v[28:31], v[44:47]
  v_mfma_f32_16x16x32_bf16 v[60:63], v[28:31], a[232:235], v[60:63]
  v_mfma_f32_16x16x32_bf16 v[76:79], v[232:235], v[28:31], v[76:79]
  v_mfma_f32_16x16x32_bf16 v[48:51], a[108:111], v[28:31], v[48:51]
  v_mfma_f32_16x16x32_bf16 v[64:67], v[28:31], a[236:239], v[64:67]
  v_mfma_f32_16x16x32_bf16 v[80:83], v[236:239], v[28:31], v[80:83]
  v_mfma_f32_16x16x32_bf16 v[52:55], a[104:107], v[32:35], v[52:55]
  v_mfma_f32_16x16x32_bf16 v[68:71], v[32:35], a[232:235], v[68:71]
  v_mfma_f32_16x16x32_bf16 v[84:87], v[232:235], v[32:35], v[84:87]
  v_mfma_f32_16x16x32_bf16 v[56:59], a[108:111], v[32:35], v[56:59]
  v_mfma_f32_16x16x32_bf16 v[72:75], v[32:35], a[236:239], v[72:75]
  v_mfma_f32_16x16x32_bf16 v[88:91], v[236:239], v[32:35], v[88:91]
  s_waitcnt lgkmcnt(2)
  v_mfma_f32_16x16x32_bf16 v[44:47], a[112:115], v[36:39], v[44:47]
  v_mfma_f32_16x16x32_bf16 v[60:63], v[36:39], a[240:243], v[60:63]
  v_mfma_f32_16x16x32_bf16 v[76:79], v[240:243], v[36:39], v[76:79]
  v_mfma_f32_16x16x32_bf16 v[48:51], a[116:119], v[36:39], v[48:51]
  v_mfma_f32_16x16x32_bf16 v[64:67], v[36:39], a[244:247], v[64:67]
  v_mfma_f32_16x16x32_bf16 v[80:83], v[244:247], v[36:39], v[80:83]
  v_mfma_f32_16x16x32_bf16 v[52:55], a[112:115], v[40:43], v[52:55]
  v_mfma_f32_16x16x32_bf16 v[68:71], v[40:43], a[240:243], v[68:71]
  v_mfma_f32_16x16x32_bf16 v[84:87], v[240:243], v[40:43], v[84:87]
  v_mfma_f32_16x16x32_bf16 v[56:59], a[116:119], v[40:43], v[56:59]
  v_mfma_f32_16x16x32_bf16 v[72:75], v[40:43], a[244:247], v[72:75]
  v_mfma_f32_16x16x32_bf16 v[88:91], v[244:247], v[40:43], v[88:91]
  s_waitcnt lgkmcnt(0)
  v_mfma_f32_16x16x32_bf16 v[44:47], a[120:123], v[20:23], v[44:47]
  v_mfma_f32_16x16x32_bf16 v[60:63], v[20:23], a[248:251], v[60:63]
  v_mfma_f32_16x16x32_bf16 v[76:79], v[248:251], v[20:23], v[76:79]
  v_mfma_f32_16x16x32_bf16 v[48:51], a[124:127], v[20:23], v[48:51]
  v_mfma_f32_16x16x32_bf16 v[64:67], v[20:23], a[252:255], v[64:67]
  v_mfma_f32_16x16x32_bf16 v[80:83], v[252:255], v[20:23], v[80:83]
  v_mfma_f32_16x16x32_bf16 v[52:55], a[120:123], v[24:27], v[52:55]
  v_mfma_f32_16x16x32_bf16 v[68:71], v[24:27], a[248:251], v[68:71]
  v_mfma_f32_16x16x32_bf16 v[84:87], v[248:251], v[24:27], v[84:87]
  v_mfma_f32_16x16x32_bf16 v[56:59], a[124:127], v[24:27], v[56:59]
  v_mfma_f32_16x16x32_bf16 v[72:75], v[24:27], a[252:255], v[72:75]
  v_mfma_f32_16x16x32_bf16 v[88:91], v[252:255], v[24:27], v[88:91]
  v_xor_b32 v6, 229376, v6
  v_xor_b32 v7, 229376, v7
  v_xor_b32 v8, 229376, v8
  v_xor_b32 v9, 229376, v9
  s_mul_i32 s36, s11, 6144
  s_add_u32 s36, s36, s20
  v_add_u32 v12, s36, v1
  s_nop 1
  v_cvt_pk_bf16_f32 v92, v44, v45
  v_cvt_pk_bf16_f32 v93, v46, v47
  v_cvt_pk_bf16_f32 v94, v48, v49
  v_cvt_pk_bf16_f32 v95, v50, v51
  buffer_store_dwordx4 v[92:95], v1, s[4:7], s16 offen offset:0 sc1
  v_cvt_pk_bf16_f32 v96, v52, v53
  v_cvt_pk_bf16_f32 v97, v54, v55
  v_cvt_pk_bf16_f32 v98, v56, v57
  v_cvt_pk_bf16_f32 v99, v58, v59
  buffer_store_dwordx4 v[96:99], v1, s[4:7], s16 offen offset:1024 sc1
  v_cvt_pk_bf16_f32 v100, v60, v61
  v_cvt_pk_bf16_f32 v101, v62, v63
  v_cvt_pk_bf16_f32 v102, v68, v69
  v_cvt_pk_bf16_f32 v103, v70, v71
  buffer_store_dwordx4 v[100:103], v1, s[4:7], s16 offen offset:2048 sc1
  v_cvt_pk_bf16_f32 v104, v64, v65
  v_cvt_pk_bf16_f32 v105, v66, v67
  v_cvt_pk_bf16_f32 v106, v72, v73
  v_cvt_pk_bf16_f32 v107, v74, v75
  buffer_store_dwordx4 v[104:107], v1, s[4:7], s16 offen offset:3072 sc1
  v_cvt_pk_bf16_f32 v108, v76, v77
  v_cvt_pk_bf16_f32 v109, v78, v79
  v_cvt_pk_bf16_f32 v110, v80, v81
  v_cvt_pk_bf16_f32 v111, v82, v83
  v_cvt_pk_bf16_f32 v112, v84, v85
  v_cvt_pk_bf16_f32 v113, v86, v87
  v_cvt_pk_bf16_f32 v114, v88, v89
  v_cvt_pk_bf16_f32 v115, v90, v91
  ds_write_b128 v12, v[92:95] offset:0
  ds_write_b128 v12, v[96:99] offset:1024
  ds_write_b128 v12, v[100:103] offset:2048
  ds_write_b128 v12, v[104:107] offset:3072
  ds_write_b128 v12, v[108:111] offset:4096
  ds_write_b128 v12, v[112:115] offset:5120
  s_add_u32 s20, s20, 24576
  s_cmp_eq_u32 s20, 73728
  s_cselect_b32 s20, 0, s20
  s_add_u32 s14, s14, 1
  s_cmp_ge_u32 s15, 64
  s_cselect_b32 s14, 15, s14
  s_cselect_b32 s36, 99, s15
  s_waitcnt vmcnt(0) lgkmcnt(0)
  s_barrier
  s_cmp_lg_u32 s11, 0
  s_cbranch_scc1 Hnf1
  v_mov_b32 v14, s36
  s_mov_b64 exec, 1
  buffer_store_dword v14, off, s[4:7], s22 sc1
  s_mov_b64 exec, -1
Hnf1:
  s_cmp_lt_u32 s14, 3
  s_cbranch_scc1 H1top
H3top:
  s_lshl_b32 s17, s13, 5
  s_add_u32 s17, s17, s10
  s_lshl_b32 s17, s17, 13
  s_and_b32 s36, s11, 1
  s_lshl_b32 s36, s36, 10
  s_add_u32 s17, s17, s36
  s_add_u32 s36, s36, s21
  v_add_u32 v12, s21, v1
  v_add_u32 v13, s36, v1
  s_lshr_b32 s36, s11, 1
  s_lshl_b32 s37, s36, 12
  s_add_u32 s17, s17, s37
  s_add_u32 s17, s17, 50331648
  s_mul_i32 s36, s36, 12288
  ds_read_b128 v[20:23], v13 offset:4096
  ds_read_b128 v[64:67], v12 offset:0
  ds_read_b128 v[68:71], v12 offset:1024
  ds_read_b128 v[24:27], v13 offset:10240
  ds_read_b128 v[72:75], v12 offset:6144
  ds_read_b128 v[76:79], v12 offset:7168
  ds_read_b128 v[28:31], v13 offset:16384
  ds_read_b128 v[80:83], v12 offset:12288
  ds_read_b128 v[84:87], v12 offset:13312
  ds_read_b128 v[32:35], v13 offset:22528
  ds_read_b128 v[88:91], v12 offset:18432
  ds_read_b128 v[92:95], v12 offset:19456
  v_add_u32 v12, s36, v12
  s_waitcnt lgkmcnt(0)
  v_mfma_f32_16x16x32_bf16 v[52:55], v[64:67], v[20:23], 0
  v_mfma_f32_16x16x32_bf16 v[56:59], v[68:71], v[20:23], 0
  v_mfma_f32_16x16x32_bf16 v[52:55], v[72:75], v[24:27], v[52:55]
  v_mfma_f32_16x16x32_bf16 v[56:59], v[76:79], v[24:27], v[56:59]
  v_mfma_f32_16x16x32_bf16 v[52:55], v[80:83], v[28:31], v[52:55]
  v_mfma_f32_16x16x32_bf16 v[56:59], v[84:87], v[28:31], v[56:59]
  v_mfma_f32_16x16x32_bf16 v[52:55], v[88:91], v[32:35], v[52:55]
  v_mfma_f32_16x16x32_bf16 v[56:59], v[92:95], v[32:35], v[56:59]
  s_nop 7
  v_cndmask_b32 v52, v11, v52, s[60:61]
  v_cndmask_b32 v53, v11, v53, s[62:63]
  v_cndmask_b32 v54, v11, v54, s[64:65]
  v_cndmask_b32 v55, v11, v55, s[66:67]
  v_cndmask_b32 v56, v11, v56, s[68:69]
  v_cndmask_b32 v57, v11, v57, s[70:71]
  v_cndmask_b32 v58, v11, v58, s[72:73]
  v_cndmask_b32 v59, v11, v59, s[74:75]
  v_max3_f32 v16, v52, v53, v54
  v_max3_f32 v16, v16, v55, v56
  v_max3_f32 v16, v16, v57, v58
  v_max_f32 v16, v16, v59
  v_add_u32 v13, 81920, v2
  s_cmp_lg_u32 s11, 0
  s_cbranch_scc1 H3go
  s_cmp_ge_u32 s13, 58
  s_cbranch_scc1 H3go
  s_cmp_lg_u32 s13, s12
  s_cbranch_scc1 Htd
Htw:
  global_load_dword v14, v10, s[8:9] sc1
  s_sub_u32 s18, s18, 1
  s_cbranch_scc1 Htg
  s_waitcnt vmcnt(0)
  v_readfirstlane_b32 s36, v14
  s_cmp_ge_u32 s36, 32
  s_cbranch_scc1 Htd
  s_sleep 16
  s_branch Htw
Htg:
  s_mov_b32 s18, 0
Htd:
  s_mul_i32 s37, s13, 8320
  s_add_u32 s37, s37, 77611136
H3poll:
  buffer_load_dword v14, off, s[4:7], s37 sc1
  s_sub_u32 s18, s18, 1
  s_cbranch_scc1 H3gv
  s_waitcnt vmcnt(0)
  v_readfirstlane_b32 s36, v14
  s_cmp_lg_u32 s36, -1
  s_cbranch_scc1 H3go
  s_sleep 2
  s_branch H3poll
H3gv:
  s_mov_b32 s18, 0
H3go:
  s_barrier
  s_mul_i32 s36, s13, 8320
  s_lshl_b32 s37, s11, 11
  s_add_u32 s36, s36, 77594624
  s_add_u32 s36, s36, s37
H3q:
  buffer_load_dwordx4 v[64:67], v1, s[4:7], s36 offen sc1
  buffer_load_dwordx4 v[68:71], v1, s[4:7], s36 offen offset:1024 sc1
  s_cmp_lt_u32 s13, 58
  s_waitcnt vmcnt(0)
  s_cbranch_scc1 H3d
  v_max3_u32 v14, v64, v65, v66
  v_max3_u32 v14, v14, v67, v68
  v_max3_u32 v14, v14, v69, v70
  v_max_u32 v14, v14, v71
  v_cmp_eq_u32 vcc, -1, v14
  s_cbranch_vccz H3d
  s_sleep 1
  s_sub_u32 s18, s18, 1
  s_cbranch_scc0 H3q
  s_mov_b32 s18, 0
H3d:
  ds_write_b128 v3, v[64:67] offset:8192
  ds_write_b128 v3, v[68:71] offset:9216
  s_waitcnt lgkmcnt(0)
  s_barrier
  ds_read_b128 v[64:67], v13 offset:0
  ds_read_b128 v[68:71], v13 offset:2048
  ds_read_b128 v[72:75], v13 offset:4096
  ds_read_b128 v[76:79], v13 offset:6144
  ds_read_b128 v[80:83], v13 offset:512
  ds_read_b128 v[84:87], v13 offset:2560
  ds_read_b128 v[88:91], v13 offset:4608
  ds_read_b128 v[92:95], v13 offset:6656
  ds_read_b128 v[96:99], v13 offset:1024
  ds_read_b128 v[100:103], v13 offset:3072
  ds_read_b128 v[104:107], v13 offset:5120
  ds_read_b128 v[108:111], v13 offset:7168
  ds_read_b128 v[112:115], v13 offset:1536
  ds_read_b128 v[116:119], v13 offset:3584
  ds_read_b128 v[120:123], v13 offset:5632
  ds_read_b128 v[124:127], v13 offset:7680
  s_waitcnt lgkmcnt(15)
  v_mfma_f32_16x16x32_bf16 v[36:39], a[0:3], v[64:67], 0
  v_mfma_f32_16x16x32_bf16 v[40:43], a[4:7], v[64:67], 0
  v_mfma_f32_16x16x32_bf16 v[44:47], v[64:67], a[128:131], 0
  v_mfma_f32_16x16x32_bf16 v[48:51], v[64:67], a[132:135], 0
  s_waitcnt lgkmcnt(14)
  v_mfma_f32_16x16x32_bf16 v[36:39], a[8:11], v[68:71], v[36:39]
  v_mfma_f32_16x16x32_bf16 v[40:43], a[12:15], v[68:71], v[40:43]
  v_mfma_f32_16x16x32_bf16 v[44:47], v[68:71], a[136:139], v[44:47]
  v_mfma_f32_16x16x32_bf16 v[48:51], v[68:71], a[140:143], v[48:51]
  s_waitcnt lgkmcnt(13)
  v_mfma_f32_16x16x32_bf16 v[36:39], a[16:19], v[72:75], v[36:39]
  v_mfma_f32_16x16x32_bf16 v[40:43], a[20:23], v[72:75], v[40:43]
  v_mfma_f32_16x16x32_bf16 v[44:47], v[72:75], a[144:147], v[44:47]
  v_mfma_f32_16x16x32_bf16 v[48:51], v[72:75], a[148:151], v[48:51]
  s_waitcnt lgkmcnt(12)
  v_mfma_f32_16x16x32_bf16 v[36:39], a[24:27], v[76:79], v[36:39]
  v_mfma_f32_16x16x32_bf16 v[40:43], a[28:31], v[76:79], v[40:43]
  v_mfma_f32_16x16x32_bf16 v[44:47], v[76:79], a[152:155], v[44:47]
  v_mfma_f32_16x16x32_bf16 v[48:51], v[76:79], a[156:159], v[48:51]
  s_waitcnt lgkmcnt(11)
  v_mfma_f32_16x16x32_bf16 v[36:39], a[32:35], v[80:83], v[36:39]
  v_mfma_f32_16x16x32_bf16 v[40:43], a[36:39], v[80:83], v[40:43]
  v_mfma_f32_16x16x32_bf16 v[44:47], v[80:83], a[160:163], v[44:47]
  v_mfma_f32_16x16x32_bf16 v[48:51], v[80:83], a[164:167], v[48:51]
  s_waitcnt lgkmcnt(10)
  v_mfma_f32_16x16x32_bf16 v[36:39], a[40:43], v[84:87], v[36:39]
  v_mfma_f32_16x16x32_bf16 v[40:43], a[44:47], v[84:87], v[40:43]
  v_mfma_f32_16x16x32_bf16 v[44:47], v[84:87], a[168:171], v[44:47]
  v_mfma_f32_16x16x32_bf16 v[48:51], v[84:87], a[172:175], v[48:51]
  s_waitcnt lgkmcnt(9)
  v_mfma_f32_16x16x32_bf16 v[36:39], a[48:51], v[88:91], v[36:39]
  v_mfma_f32_16x16x32_bf16 v[40:43], a[52:55], v[88:91], v[40:43]
  v_mfma_f32_16x16x32_bf16 v[44:47], v[88:91], a[176:179], v[44:47]
  v_mfma_f32_16x16x32_bf16 v[48:51], v[88:91], a[180:183], v[48:51]
  s_waitcnt lgkmcnt(8)
  v_mfma_f32_16x16x32_bf16 v[36:39], a[56:59], v[92:95], v[36:39]
  v_mfma_f32_16x16x32_bf16 v[40:43], a[60:63], v[92:95], v[40:43]
  v_mfma_f32_16x16x32_bf16 v[44:47], v[92:95], a[184:187], v[44:47]
  v_mfma_f32_16x16x32_bf16 v[48:51], v[92:95], a[188:191], v[48:51]
  s_waitcnt lgkmcnt(0)
  v_mfma_f32_16x16x32_bf16 v[36:39], a[64:67], v[96:99], v[36:39]
  v_mfma_f32_16x16x32_bf16 v[40:43], a[68:71], v[96:99], v[40:43]
  v_mfma_f32_16x16x32_bf16 v[44:47], v[96:99], a[192:195], v[44:47]
  v_mfma_f32_16x16x32_bf16 v[48:51], v[96:99], a[196:199], v[48:51]
  ds_read_b128 v[64:67], v12 offset:2048
  v_mfma_f32_16x16x32_bf16 v[36:39], a[72:75], v[100:103], v[36:39]
  v_mfma_f32_16x16x32_bf16 v[40:43], a[76:79], v[100:103], v[40:43]
  v_mfma_f32_16x16x32_bf16 v[44:47], v[100:103], a[200:203], v[44:47]
  v_mfma_f32_16x16x32_bf16 v[48:51], v[100:103], a[204:207], v[48:51]
  ds_read_b128 v[68:71], v12 offset:3072
  v_mfma_f32_16x16x32_bf16 v[36:39], a[80:83], v[104:107], v[36:39]
  v_mfma_f32_16x16x32_bf16 v[40:43], a[84:87], v[104:107], v[40:43]
  v_mfma_f32_16x16x32_bf16 v[44:47], v[104:107], a[208:211], v[44:47]
  v_mfma_f32_16x16x32_bf16 v[48:51], v[104:107], a[212:215], v[48:51]
  ds_read_b128 v[72:75], v12 offset:8192
  v_mfma_f32_16x16x32_bf16 v[36:39], a[88:91], v[108:111], v[36:39]
  v_mfma_f32_16x16x32_bf16 v[40:43], a[92:95], v[108:111], v[40:43]
  v_mfma_f32_16x16x32_bf16 v[44:47], v[108:111], a[216:219], v[44:47]
  v_mfma_f32_16x16x32_bf16 v[48:51], v[108:111], a[220:223], v[48:51]
  ds_read_b128 v[76:79], v12 offset:9216
  v_mfma_f32_16x16x32_bf16 v[36:39], a[96:99], v[112:115], v[36:39]
  v_mfma_f32_16x16x32_bf16 v[40:43], a[100:103], v[112:115], v[40:43]
  v_mfma_f32_16x16x32_bf16 v[44:47], v[112:115], a[224:227], v[44:47]
  v_mfma_f32_16x16x32_bf16 v[48:51], v[112:115], a[228:231], v[48:51]
  v_mfma_f32_16x16x32_bf16 v[36:39], a[104:107], v[116:119], v[36:39]
  v_mfma_f32_16x16x32_bf16 v[40:43], a[108:111], v[116:119], v[40:43]
  v_mfma_f32_16x16x32_bf16 v[44:47], v[116:119], a[232:235], v[44:47]
  v_mfma_f32_16x16x32_bf16 v[48:51], v[116:119], a[236:239], v[48:51]
  v_mfma_f32_16x16x32_bf16 v[36:39], a[112:115], v[120:123], v[36:39]
  v_mfma_f32_16x16x32_bf16 v[40:43], a[116:119], v[120:123], v[40:43]
  v_mfma_f32_16x16x32_bf16 v[44:47], v[120:123], a[240:243], v[44:47]
  v_mfma_f32_16x16x32_bf16 v[48:51], v[120:123], a[244:247], v[48:51]
  v_mfma_f32_16x16x32_bf16 v[36:39], a[120:123], v[124:127], v[36:39]
  v_mfma_f32_16x16x32_bf16 v[40:43], a[124:127], v[124:127], v[40:43]
  v_mfma_f32_16x16x32_bf16 v[44:47], v[124:127], a[248:251], v[44:47]
  v_mfma_f32_16x16x32_bf16 v[48:51], v[124:127], a[252:255], v[48:51]
  s_nop 3
  v_cvt_pk_bf16_f32 v80, v36, v37
  v_cvt_pk_bf16_f32 v81, v38, v39
  v_cvt_pk_bf16_f32 v82, v40, v41
  v_cvt_pk_bf16_f32 v83, v42, v43
  v_cvt_pk_bf16_f32 v84, v44, v45
  v_cvt_pk_bf16_f32 v85, v46, v47
  v_cvt_pk_bf16_f32 v86, v48, v49
  v_cvt_pk_bf16_f32 v87, v50, v51
  ds_write_b128 v3, v[80:83]
  ds_write_b128 v3, v[84:87] offset:1024
  s_waitcnt lgkmcnt(0)
  s_barrier
  ds_read_b128 v[80:83], v4 offset:0
  ds_read_b128 v[84:87], v4 offset:2048
  ds_read_b128 v[88:91], v4 offset:4096
  ds_read_b128 v[92:95], v4 offset:6144
  ds_read_b128 v[96:99], v5 offset:1024
  ds_read_b128 v[100:103], v5 offset:3072
  s_waitcnt lgkmcnt(5)
  v_mfma_f32_16x16x32_bf16 v[60:63], v[80:83], v[20:23], 0
  s_waitcnt lgkmcnt(4)
  v_mfma_f32_16x16x32_bf16 v[60:63], v[84:87], v[24:27], v[60:63]
  s_waitcnt lgkmcnt(3)
  v_mfma_f32_16x16x32_bf16 v[60:63], v[88:91], v[28:31], v[60:63]
  s_waitcnt lgkmcnt(2)
  v_mfma_f32_16x16x32_bf16 v[60:63], v[92:95], v[32:35], v[60:63]
  s_nop 7
  v_cndmask_b32 v60, v11, v60, s[76:77]
  v_cndmask_b32 v61, v11, v61, s[76:77]
  v_cndmask_b32 v62, v11, v62, s[76:77]
  v_cndmask_b32 v63, v11, v63, s[76:77]
  v_max3_f32 v16, v16, v60, v61
  v_max3_f32 v17, v16, v62, v63
  v_max3_f32 v16, v16, v62, v63
  s_nop 1
  v_permlane16_swap_b32 v16, v17
  v_max_f32 v18, v16, v17
  v_max_f32 v19, v16, v17
  s_nop 1
  v_permlane32_swap_b32 v18, v19
  v_max_f32 v16, v18, v19
  v_mul_f32 v16, s26, v16
  v_fma_f32 v52, v52, s26, -v16
  v_fma_f32 v53, v53, s26, -v16
  v_fma_f32 v54, v54, s26, -v16
  v_fma_f32 v55, v55, s26, -v16
  v_fma_f32 v56, v56, s26, -v16
  v_fma_f32 v57, v57, s26, -v16
  v_fma_f32 v58, v58, s26, -v16
  v_fma_f32 v59, v59, s26, -v16
  v_fma_f32 v60, v60, s26, -v16
  v_fma_f32 v61, v61, s26, -v16
  v_fma_f32 v62, v62, s26, -v16
  v_fma_f32 v63, v63, s26, -v16
  v_exp_f32 v52, v52
  v_exp_f32 v53, v53
  v_exp_f32 v54, v54
  v_exp_f32 v55, v55
  v_exp_f32 v56, v56
  v_exp_f32 v57, v57
  v_exp_f32 v58, v58
  v_exp_f32 v59, v59
  v_exp_f32 v60, v60
  v_exp_f32 v61, v61
  v_exp_f32 v62, v62
  v_exp_f32 v63, v63
  v_cvt_pk_bf16_f32 v104, v52, v53
  v_cvt_pk_bf16_f32 v105, v54, v55
  v_cvt_pk_bf16_f32 v106, v56, v57
  v_cvt_pk_bf16_f32 v107, v58, v59
  v_cvt_pk_bf16_f32 v108, v60, v61
  v_cvt_pk_bf16_f32 v109, v62, v63
  s_waitcnt lgkmcnt(0)
  s_nop 0
  v_mfma_f32_16x16x32_bf16 v[36:39], v[64:67], v[104:107], 0
  v_mfma_f32_16x16x32_bf16 v[40:43], v[68:71], v[104:107], 0
  v_mfma_f32_16x16x32_bf16 v[44:47], v[72:75], v[104:107], 0
  v_mfma_f32_16x16x32_bf16 v[48:51], v[76:79], v[104:107], 0
  v_mfma_f32_16x16x16_bf16 v[36:39], v[96:97], v[108:109], v[36:39]
  v_mfma_f32_16x16x16_bf16 v[40:43], v[98:99], v[108:109], v[40:43]
  v_mfma_f32_16x16x16_bf16 v[44:47], v[100:101], v[108:109], v[44:47]
  v_mfma_f32_16x16x16_bf16 v[48:51], v[102:103], v[108:109], v[48:51]
  v_add_f32 v52, v52, v53
  v_add_f32 v54, v54, v55
  v_add_f32 v56, v56, v57
  v_add_f32 v58, v58, v59
  v_add_f32 v60, v60, v61
  v_add_f32 v62, v62, v63
  v_add_f32 v52, v52, v54
  v_add_f32 v56, v56, v58
  v_add_f32 v60, v60, v62
  v_add_f32 v16, v52, v56
  v_add_f32 v17, v16, v60
  v_add_f32 v16, v16, v60
  s_nop 1
  v_permlane16_swap_b32 v16, v17
  v_add_f32 v18, v16, v17
  v_add_f32 v19, v16, v17
  s_nop 1
  v_permlane32_swap_b32 v18, v19
  v_add_f32 v16, v18, v19
  v_rcp_f32 v16, v16
  s_nop 0
  v_mul_f32 v36, v36, v16
  v_mul_f32 v37, v37, v16
  v_mul_f32 v38, v38, v16
  v_mul_f32 v39, v39, v16
  v_mul_f32 v40, v40, v16
  v_mul_f32 v41, v41, v16
  v_mul_f32 v42, v42, v16
  v_mul_f32 v43, v43, v16
  v_mul_f32 v44, v44, v16
  v_mul_f32 v45, v45, v16
  v_mul_f32 v46, v46, v16
  v_mul_f32 v47, v47, v16
  v_mul_f32 v48, v48, v16
  v_mul_f32 v49, v49, v16
  v_mul_f32 v50, v50, v16
  v_mul_f32 v51, v51, v16
  v_cvt_pk_bf16_f32 v112, v36, v37
  v_cvt_pk_bf16_f32 v113, v38, v39
  v_cvt_pk_bf16_f32 v114, v40, v41
  v_cvt_pk_bf16_f32 v115, v42, v43
  v_cvt_pk_bf16_f32 v116, v44, v45
  v_cvt_pk_bf16_f32 v117, v46, v47
  v_cvt_pk_bf16_f32 v118, v48, v49
  v_cvt_pk_bf16_f32 v119, v50, v51
  buffer_store_dwordx4 v[112:115], v1, s[4:7], s17 offen offset:0 sc1
  buffer_store_dwordx4 v[116:119], v1, s[4:7], s17 offen offset:2048 sc1
  s_add_u32 s21, s21, 24576
  s_cmp_eq_u32 s21, 73728
  s_cselect_b32 s21, 0, s21
  s_lshl_b32 s36, s13, 5
  s_add_u32 s36, s36, s10
  s_mul_i32 s36, s36, 128
  s_add_u32 s36, s36, 78643200
  s_add_u32 s13, s13, 4
  s_waitcnt vmcnt(0) lgkmcnt(0)
  s_barrier
  s_cmp_lg_u32 s11, 0
  s_cbranch_scc1 Hnf3
  v_mov_b32 v14, 1
  s_mov_b64 exec, 1
  buffer_store_dword v14, off, s[4:7], s36 sc1
  s_mov_b64 exec, -1
Hnf3:
  s_cmp_lt_u32 s15, 64
  s_cbranch_scc1 H1top
  s_cmp_lt_u32 s13, 64
  s_cbranch_scc1 H3top
  s_branch Lend
Rwarm:
  s_and_b32 s10, s10, 31
  s_lshl_b32 s10, s10, 17
  v_lshlrev_b32 v1, 6, v0
  v_add_u32 v1, s10, v1
  v_mov_b32 v2, v1
  global_load_dword v3, v2, s[48:49]
  v_add_u32 v2, 16384, v2
  global_load_dword v3, v2, s[48:49]
  v_add_u32 v2, 16384, v2
  global_load_dword v3, v2, s[48:49]
  v_add_u32 v2, 16384, v2
  global_load_dword v3, v2, s[48:49]
  v_add_u32 v2, 16384, v2
  global_load_dword v3, v2, s[48:49]
  v_add_u32 v2, 16384, v2
  global_load_dword v3, v2, s[48:49]
  v_add_u32 v2, 16384, v2
  global_load_dword v3, v2, s[48:49]
  v_add_u32 v2, 16384, v2
  global_load_dword v3, v2, s[48:49]
  v_add_u32 v2, 16384, v2
  v_mov_b32 v2, v1
  global_load_dword v3, v2, s[52:53]
  v_add_u32 v2, 16384, v2
  global_load_dword v3, v2, s[52:53]
  v_add_u32 v2, 16384, v2
  global_load_dword v3, v2, s[52:53]
  v_add_u32 v2, 16384, v2
  global_load_dword v3, v2, s[52:53]
  v_add_u32 v2, 16384, v2
  global_load_dword v3, v2, s[52:53]
  v_add_u32 v2, 16384, v2
  global_load_dword v3, v2, s[52:53]
  v_add_u32 v2, 16384, v2
  global_load_dword v3, v2, s[52:53]
  v_add_u32 v2, 16384, v2
  global_load_dword v3, v2, s[52:53]
  v_add_u32 v2, 16384, v2
  v_mov_b32 v2, v1
  global_load_dword v3, v2, s[54:55]
  v_add_u32 v2, 16384, v2
  global_load_dword v3, v2, s[54:55]
  v_add_u32 v2, 16384, v2
  global_load_dword v3, v2, s[54:55]
  v_add_u32 v2, 16384, v2
  global_load_dword v3, v2, s[54:55]
  v_add_u32 v2, 16384, v2
  global_load_dword v3, v2, s[54:55]
  v_add_u32 v2, 16384, v2
  global_load_dword v3, v2, s[54:55]
  v_add_u32 v2, 16384, v2
  global_load_dword v3, v2, s[54:55]
  v_add_u32 v2, 16384, v2
  global_load_dword v3, v2, s[54:55]
  v_add_u32 v2, 16384, v2
  s_waitcnt vmcnt(0)
  s_branch Lend2
Rconv:
  s_sub_u32 s10, s10, 160
  s_getpc_b64 s[40:41]
LpcO:
  v_lshlrev_b32 v255, 7, v0
  v_add_u32 v255, 0, v255
  v_min_u32 v255, Rchain-LpcO-4, v255
  global_load_dword v254, v255, s[40:41]
  s_load_dwordx2 s[4:5], s[0:1], 128
  s_load_dwordx2 s[8:9], s[0:1], 120
  s_load_dwordx4 s[48:51], s[0:1], 64
  s_load_dwordx4 s[52:55], s[0:1], 80
  s_load_dwordx4 s[56:59], s[0:1], 96
  s_load_dwordx2 s[60:61], s[0:1], 0
  s_load_dwordx2 s[62:63], s[0:1], 40
  s_load_dwordx2 s[64:65], s[0:1], 112
  v_lshrrev_b32 v5, 6, v0
  v_and_b32 v2, 63, v0
  v_readfirstlane_b32 s11, v5
  v_and_b32 v3, 15, v2
  v_lshrrev_b32 v4, 4, v2
  v_lshlrev_b32 v1, 4, v2
  s_mov_b32 s6, 268435456
  s_mov_b32 s7, 0x00020000
  s_mov_b32 s30, 2097152
  s_mov_b32 s31, 0x00020000
  s_mov_b32 s66, 2097152
  s_mov_b32 s67, 0x00020000
  s_mov_b32 s18, 262144
  s_and_b32 s12, s10, 15
  s_lshr_b32 s13, s10, 4
  s_lshl_b32 s36, s12, 2
  s_add_u32 s36, s36, s13
  s_lshl_b32 s37, s36, 4
  s_lshl_b32 s38, s36, 6
  s_waitcnt lgkmcnt(0)
  s_add_u32 s52, s52, s38
  s_addc_u32 s53, s53, 0
  s_add_u32 s56, s56, s37
  s_addc_u32 s57, s57, 0
  s_load_dwordx16 s[80:95], s[52:53], 0
  s_load_dwordx4 s[96:99], s[56:57], 0
  v_lshlrev_b32 v6, 13, v0
  v_add_u32 v6, s37, v6
  v_subrev_u32 v7, 3072, v6
  v_add_u32 v8, 4096, v6
  s_mov_b32 s28, s48
  s_mov_b32 s29, s49
  buffer_load_dwordx4 v[16:19], v7, s[28:31], 0 offen offset:0
  buffer_load_dwordx4 v[20:23], v7, s[28:31], 0 offen offset:1024
  buffer_load_dwordx4 v[24:27], v7, s[28:31], 0 offen offset:2048
  buffer_load_dwordx4 v[28:31], v6, s[28:31], 0 offen offset:0
  buffer_load_dwordx4 v[32:35], v6, s[28:31], 0 offen offset:1024
  buffer_load_dwordx4 v[36:39], v6, s[28:31], 0 offen offset:2048
  buffer_load_dwordx4 v[40:43], v6, s[28:31], 0 offen offset:3072
  buffer_load_dwordx4 v[44:47], v8, s[28:31], 0 offen offset:0
  buffer_load_dwordx4 v[48:51], v8, s[28:31], 0 offen offset:1024
  buffer_load_dwordx4 v[52:55], v8, s[28:31], 0 offen offset:2048
  buffer_load_dwordx4 v[56:59], v8, s[28:31], 0 offen offset:3072
  s_mov_b32 s28, s50
  s_mov_b32 s29, s51
  buffer_load_dwordx4 v[60:63], v6, s[28:31], 0 offen offset:0
  buffer_load_dwordx4 v[64:67], v6, s[28:31], 0 offen offset:1024
  buffer_load_dwordx4 v[68:71], v6, s[28:31], 0 offen offset:2048
  buffer_load_dwordx4 v[72:75], v6, s[28:31], 0 offen offset:3072
  buffer_load_dwordx4 v[76:79], v8, s[28:31], 0 offen offset:0
  buffer_load_dwordx4 v[80:83], v8, s[28:31], 0 offen offset:1024
  buffer_load_dwordx4 v[84:87], v8, s[28:31], 0 offen offset:2048
  buffer_load_dwordx4 v[88:91], v8, s[28:31], 0 offen offset:3072
  s_mov_b32 s28, s54
  s_mov_b32 s29, s55
  s_lshl_b32 s38, s36, 15
  s_lshl_b32 s39, s11, 13
  s_add_u32 s38, s38, s39
  s_mul_i32 s39, s11, 8320
  s_add_u32 m0, s39, 36928
  s_add_u32 s40, s38, 0
  buffer_load_dwordx4 v1, s[28:31], s40 offen lds
  s_add_u32 m0, s39, 37952
  s_add_u32 s40, s38, 1024
  buffer_load_dwordx4 v1, s[28:31], s40 offen lds
  s_add_u32 m0, s39, 38976
  s_add_u32 s40, s38, 2048
  buffer_load_dwordx4 v1, s[28:31], s40 offen lds
  s_add_u32 m0, s39, 40000
  s_add_u32 s40, s38, 3072
  buffer_load_dwordx4 v1, s[28:31], s40 offen lds
  s_add_u32 m0, s39, 41088
  s_add_u32 s40, s38, 4096
  buffer_load_dwordx4 v1, s[28:31], s40 offen lds
  s_add_u32 m0, s39, 42112
  s_add_u32 s40, s38, 5120
  buffer_load_dwordx4 v1, s[28:31], s40 offen lds
  s_add_u32 m0, s39, 43136
  s_add_u32 s40, s38, 6144
  buffer_load_dwordx4 v1, s[28:31], s40 offen lds
  s_add_u32 m0, s39, 44160
  s_add_u32 s40, s38, 7168
  buffer_load_dwordx4 v1, s[28:31], s40 offen lds
  v_mov_b32 v124, 0
  v_mov_b32 v125, 0
  v_mov_b32 v126, 0
  v_mov_b32 v127, 0
  v_lshrrev_b32 v9, 5, v0
  v_mul_u32_u24 v10, 4608, v9
  v_and_b32 v11, 31, v0
  v_lshl_add_u32 v10, v11, 4, v10
  ds_write_b128 v10, v[124:127] offset:0
  v_mul_u32_u24 v10, 4160, v9
  v_and_b32 v11, 3, v0
  v_lshl_add_u32 v10, v11, 4, v10
  ds_write_b128 v10, v[124:127] offset:36864
  s_lshl_b32 s38, s10, 15
  s_lshl_b32 s39, s11, 13
  s_add_u32 s38, s38, s39
  v_add_u32 v9, s38, v1
  v_add_u32 v10, 4096, v9
  global_load_dwordx4 v[160:163], v1, s[58:59]
  global_load_dwordx4 v[128:131], v9, s[60:61] offset:0
  global_load_dwordx4 v[132:135], v9, s[60:61] offset:1024
  global_load_dwordx4 v[136:139], v9, s[60:61] offset:2048
  global_load_dwordx4 v[140:143], v9, s[60:61] offset:3072
  global_load_dwordx4 v[144:147], v10, s[60:61] offset:0
  global_load_dwordx4 v[148:151], v10, s[60:61] offset:1024
  global_load_dwordx4 v[152:155], v10, s[60:61] offset:2048
  global_load_dwordx4 v[156:159], v10, s[60:61] offset:3072
  s_waitcnt vmcnt(0) lgkmcnt(0)
  v_lshlrev_b32 v164, 16, v160
  v_and_b32 v165, 0xffff0000, v160
  v_lshlrev_b32 v166, 16, v161
  v_and_b32 v167, 0xffff0000, v161
  v_lshlrev_b32 v168, 16, v162
  v_and_b32 v169, 0xffff0000, v162
  v_lshlrev_b32 v170, 16, v163
  v_and_b32 v171, 0xffff0000, v163
  v_lshlrev_b32 v172, 16, v128
  v_and_b32 v173, 0xffff0000, v128
  v_mul_f32 v172, v172, v164
  v_mul_f32 v173, v173, v165
  v_cvt_pk_bf16_f32 v174, v172, v173
  v_lshlrev_b32 v172, 16, v174
  v_and_b32 v173, 0xffff0000, v174
  v_add_f32 v180, v172, v173
  v_lshlrev_b32 v172, 16, v129
  v_and_b32 v173, 0xffff0000, v129
  v_mul_f32 v172, v172, v166
  v_mul_f32 v173, v173, v167
  v_cvt_pk_bf16_f32 v174, v172, v173
  v_lshlrev_b32 v172, 16, v174
  v_and_b32 v173, 0xffff0000, v174
  v_add_f32 v172, v172, v173
  v_add_f32 v180, v180, v172
  v_lshlrev_b32 v172, 16, v130
  v_and_b32 v173, 0xffff0000, v130
  v_mul_f32 v172, v172, v168
  v_mul_f32 v173, v173, v169
  v_cvt_pk_bf16_f32 v174, v172, v173
  v_lshlrev_b32 v172, 16, v174
  v_and_b32 v173, 0xffff0000, v174
  v_add_f32 v172, v172, v173
  v_add_f32 v180, v180, v172
  v_lshlrev_b32 v172, 16, v131
  v_and_b32 v173, 0xffff0000, v131
  v_mul_f32 v172, v172, v170
  v_mul_f32 v173, v173, v171
  v_cvt_pk_bf16_f32 v174, v172, v173
  v_lshlrev_b32 v172, 16, v174
  v_and_b32 v173, 0xffff0000, v174
  v_add_f32 v172, v172, v173
  v_add_f32 v180, v180, v172
  v_lshlrev_b32 v172, 16, v132
  v_and_b32 v173, 0xffff0000, v132
  v_mul_f32 v172, v172, v164
  v_mul_f32 v173, v173, v165
  v_cvt_pk_bf16_f32 v174, v172, v173
  v_lshlrev_b32 v172, 16, v174
  v_and_b32 v173, 0xffff0000, v174
  v_add_f32 v181, v172, v173
  v_lshlrev_b32 v172, 16, v133
  v_and_b32 v173, 0xffff0000, v133
  v_mul_f32 v172, v172, v166
  v_mul_f32 v173, v173, v167
  v_cvt_pk_bf16_f32 v174, v172, v173
  v_lshlrev_b32 v172, 16, v174
  v_and_b32 v173, 0xffff0000, v174
  v_add_f32 v172, v172, v173
  v_add_f32 v181, v181, v172
  v_lshlrev_b32 v172, 16, v134
  v_and_b32 v173, 0xffff0000, v134
  v_mul_f32 v172, v172, v168
  v_mul_f32 v173, v173, v169
  v_cvt_pk_bf16_f32 v174, v172, v173
  v_lshlrev_b32 v172, 16, v174
  v_and_b32 v173, 0xffff0000, v174
  v_add_f32 v172, v172, v173
  v_add_f32 v181, v181, v172
  v_lshlrev_b32 v172, 16, v135
  v_and_b32 v173, 0xffff0000, v135
  v_mul_f32 v172, v172, v170
  v_mul_f32 v173, v173, v171
  v_cvt_pk_bf16_f32 v174, v172, v173
  v_lshlrev_b32 v172, 16, v174
  v_and_b32 v173, 0xffff0000, v174
  v_add_f32 v172, v172, v173
  v_add_f32 v181, v181, v172
  v_lshlrev_b32 v172, 16, v136
  v_and_b32 v173, 0xffff0000, v136
  v_mul_f32 v172, v172, v164
  v_mul_f32 v173, v173, v165
  v_cvt_pk_bf16_f32 v174, v172, v173
  v_lshlrev_b32 v172, 16, v174
  v_and_b32 v173, 0xffff0000, v174
  v_add_f32 v182, v172, v173
  v_lshlrev_b32 v172, 16, v137
  v_and_b32 v173, 0xffff0000, v137
  v_mul_f32 v172, v172, v166
  v_mul_f32 v173, v173, v167
  v_cvt_pk_bf16_f32 v174, v172, v173
  v_lshlrev_b32 v172, 16, v174
  v_and_b32 v173, 0xffff0000, v174
  v_add_f32 v172, v172, v173
  v_add_f32 v182, v182, v172
  v_lshlrev_b32 v172, 16, v138
  v_and_b32 v173, 0xffff0000, v138
  v_mul_f32 v172, v172, v168
  v_mul_f32 v173, v173, v169
  v_cvt_pk_bf16_f32 v174, v172, v173
  v_lshlrev_b32 v172, 16, v174
  v_and_b32 v173, 0xffff0000, v174
  v_add_f32 v172, v172, v173
  v_add_f32 v182, v182, v172
  v_lshlrev_b32 v172, 16, v139
  v_and_b32 v173, 0xffff0000, v139
  v_mul_f32 v172, v172, v170
  v_mul_f32 v173, v173, v171
  v_cvt_pk_bf16_f32 v174, v172, v173
  v_lshlrev_b32 v172, 16, v174
  v_and_b32 v173, 0xffff0000, v174
  v_add_f32 v172, v172, v173
  v_add_f32 v182, v182, v172
  v_lshlrev_b32 v172, 16, v140
  v_and_b32 v173, 0xffff0000, v140
  v_mul_f32 v172, v172, v164
  v_mul_f32 v173, v173, v165
  v_cvt_pk_bf16_f32 v174, v172, v173
  v_lshlrev_b32 v172, 16, v174
  v_and_b32 v173, 0xffff0000, v174
  v_add_f32 v183, v172, v173
  v_lshlrev_b32 v172, 16, v141
  v_and_b32 v173, 0xffff0000, v141
  v_mul_f32 v172, v172, v166
  v_mul_f32 v173, v173, v167
  v_cvt_pk_bf16_f32 v174, v172, v173
  v_lshlrev_b32 v172, 16, v174
  v_and_b32 v173, 0xffff0000, v174
  v_add_f32 v172, v172, v173
  v_add_f32 v183, v183, v172
  v_lshlrev_b32 v172, 16, v142
  v_and_b32 v173, 0xffff0000, v142
  v_mul_f32 v172, v172, v168
  v_mul_f32 v173, v173, v169
  v_cvt_pk_bf16_f32 v174, v172, v173
  v_lshlrev_b32 v172, 16, v174
  v_and_b32 v173, 0xffff0000, v174
  v_add_f32 v172, v172, v173
  v_add_f32 v183, v183, v172
  v_lshlrev_b32 v172, 16, v143
  v_and_b32 v173, 0xffff0000, v143
  v_mul_f32 v172, v172, v170
  v_mul_f32 v173, v173, v171
  v_cvt_pk_bf16_f32 v174, v172, v173
  v_lshlrev_b32 v172, 16, v174
  v_and_b32 v173, 0xffff0000, v174
  v_add_f32 v172, v172, v173
  v_add_f32 v183, v183, v172
  v_lshlrev_b32 v172, 16, v144
  v_and_b32 v173, 0xffff0000, v144
  v_mul_f32 v172, v172, v164
  v_mul_f32 v173, v173, v165
  v_cvt_pk_bf16_f32 v174, v172, v173
  v_lshlrev_b32 v172, 16, v174
  v_and_b32 v173, 0xffff0000, v174
  v_add_f32 v184, v172, v173
  v_lshlrev_b32 v172, 16, v145
  v_and_b32 v173, 0xffff0000, v145
  v_mul_f32 v172, v172, v166
  v_mul_f32 v173, v173, v167
  v_cvt_pk_bf16_f32 v174, v172, v173
  v_lshlrev_b32 v172, 16, v174
  v_and_b32 v173, 0xffff0000, v174
  v_add_f32 v172, v172, v173
  v_add_f32 v184, v184, v172
  v_lshlrev_b32 v172, 16, v146
  v_and_b32 v173, 0xffff0000, v146
  v_mul_f32 v172, v172, v168
  v_mul_f32 v173, v173, v169
  v_cvt_pk_bf16_f32 v174, v172, v173
  v_lshlrev_b32 v172, 16, v174
  v_and_b32 v173, 0xffff0000, v174
  v_add_f32 v172, v172, v173
  v_add_f32 v184, v184, v172
  v_lshlrev_b32 v172, 16, v147
  v_and_b32 v173, 0xffff0000, v147
  v_mul_f32 v172, v172, v170
  v_mul_f32 v173, v173, v171
  v_cvt_pk_bf16_f32 v174, v172, v173
  v_lshlrev_b32 v172, 16, v174
  v_and_b32 v173, 0xffff0000, v174
  v_add_f32 v172, v172, v173
  v_add_f32 v184, v184, v172
  v_lshlrev_b32 v172, 16, v148
  v_and_b32 v173, 0xffff0000, v148
  v_mul_f32 v172, v172, v164
  v_mul_f32 v173, v173, v165
  v_cvt_pk_bf16_f32 v174, v172, v173
  v_lshlrev_b32 v172, 16, v174
  v_and_b32 v173, 0xffff0000, v174
  v_add_f32 v185, v172, v173
  v_lshlrev_b32 v172, 16, v149
  v_and_b32 v173, 0xffff0000, v149
  v_mul_f32 v172, v172, v166
  v_mul_f32 v173, v173, v167
  v_cvt_pk_bf16_f32 v174, v172, v173
  v_lshlrev_b32 v172, 16, v174
  v_and_b32 v173, 0xffff0000, v174
  v_add_f32 v172, v172, v173
  v_add_f32 v185, v185, v172
  v_lshlrev_b32 v172, 16, v150
  v_and_b32 v173, 0xffff0000, v150
  v_mul_f32 v172, v172, v168
  v_mul_f32 v173, v173, v169
  v_cvt_pk_bf16_f32 v174, v172, v173
  v_lshlrev_b32 v172, 16, v174
  v_and_b32 v173, 0xffff0000, v174
  v_add_f32 v172, v172, v173
  v_add_f32 v185, v185, v172
  v_lshlrev_b32 v172, 16, v151
  v_and_b32 v173, 0xffff0000, v151
  v_mul_f32 v172, v172, v170
  v_mul_f32 v173, v173, v171
  v_cvt_pk_bf16_f32 v174, v172, v173
  v_lshlrev_b32 v172, 16, v174
  v_and_b32 v173, 0xffff0000, v174
  v_add_f32 v172, v172, v173
  v_add_f32 v185, v185, v172
  v_lshlrev_b32 v172, 16, v152
  v_and_b32 v173, 0xffff0000, v152
  v_mul_f32 v172, v172, v164
  v_mul_f32 v173, v173, v165
  v_cvt_pk_bf16_f32 v174, v172, v173
  v_lshlrev_b32 v172, 16, v174
  v_and_b32 v173, 0xffff0000, v174
  v_add_f32 v186, v172, v173
  v_lshlrev_b32 v172, 16, v153
  v_and_b32 v173, 0xffff0000, v153
  v_mul_f32 v172, v172, v166
  v_mul_f32 v173, v173, v167
  v_cvt_pk_bf16_f32 v174, v172, v173
  v_lshlrev_b32 v172, 16, v174
  v_and_b32 v173, 0xffff0000, v174
  v_add_f32 v172, v172, v173
  v_add_f32 v186, v186, v172
  v_lshlrev_b32 v172, 16, v154
  v_and_b32 v173, 0xffff0000, v154
  v_mul_f32 v172, v172, v168
  v_mul_f32 v173, v173, v169
  v_cvt_pk_bf16_f32 v174, v172, v173
  v_lshlrev_b32 v172, 16, v174
  v_and_b32 v173, 0xffff0000, v174
  v_add_f32 v172, v172, v173
  v_add_f32 v186, v186, v172
  v_lshlrev_b32 v172, 16, v155
  v_and_b32 v173, 0xffff0000, v155
  v_mul_f32 v172, v172, v170
  v_mul_f32 v173, v173, v171
  v_cvt_pk_bf16_f32 v174, v172, v173
  v_lshlrev_b32 v172, 16, v174
  v_and_b32 v173, 0xffff0000, v174
  v_add_f32 v172, v172, v173
  v_add_f32 v186, v186, v172
  v_lshlrev_b32 v172, 16, v156
  v_and_b32 v173, 0xffff0000, v156
  v_mul_f32 v172, v172, v164
  v_mul_f32 v173, v173, v165
  v_cvt_pk_bf16_f32 v174, v172, v173
  v_lshlrev_b32 v172, 16, v174
  v_and_b32 v173, 0xffff0000, v174
  v_add_f32 v187, v172, v173
  v_lshlrev_b32 v172, 16, v157
  v_and_b32 v173, 0xffff0000, v157
  v_mul_f32 v172, v172, v166
  v_mul_f32 v173, v173, v167
  v_cvt_pk_bf16_f32 v174, v172, v173
  v_lshlrev_b32 v172, 16, v174
  v_and_b32 v173, 0xffff0000, v174
  v_add_f32 v172, v172, v173
  v_add_f32 v187, v187, v172
  v_lshlrev_b32 v172, 16, v158
  v_and_b32 v173, 0xffff0000, v158
  v_mul_f32 v172, v172, v168
  v_mul_f32 v173, v173, v169
  v_cvt_pk_bf16_f32 v174, v172, v173
  v_lshlrev_b32 v172, 16, v174
  v_and_b32 v173, 0xffff0000, v174
  v_add_f32 v172, v172, v173
  v_add_f32 v187, v187, v172
  v_lshlrev_b32 v172, 16, v159
  v_and_b32 v173, 0xffff0000, v159
  v_mul_f32 v172, v172, v170
  v_mul_f32 v173, v173, v171
  v_cvt_pk_bf16_f32 v174, v172, v173
  v_lshlrev_b32 v172, 16, v174
  v_and_b32 v173, 0xffff0000, v174
  v_add_f32 v172, v172, v173
  v_add_f32 v187, v187, v172
  s_nop 1
  v_add_f32_dpp v180, v180, v180 quad_perm:[1,0,3,2] row_mask:0xf bank_mask:0xf
  v_add_f32_dpp v181, v181, v181 quad_perm:[1,0,3,2] row_mask:0xf bank_mask:0xf
  v_add_f32_dpp v182, v182, v182 quad_perm:[1,0,3,2] row_mask:0xf bank_mask:0xf
  v_add_f32_dpp v183, v183, v183 quad_perm:[1,0,3,2] row_mask:0xf bank_mask:0xf
  v_add_f32_dpp v184, v184, v184 quad_perm:[1,0,3,2] row_mask:0xf bank_mask:0xf
  v_add_f32_dpp v185, v185, v185 quad_perm:[1,0,3,2] row_mask:0xf bank_mask:0xf
  v_add_f32_dpp v186, v186, v186 quad_perm:[1,0,3,2] row_mask:0xf bank_mask:0xf
  v_add_f32_dpp v187, v187, v187 quad_perm:[1,0,3,2] row_mask:0xf bank_mask:0xf
  v_add_f32_dpp v180, v180, v180 quad_perm:[2,3,0,1] row_mask:0xf bank_mask:0xf
  v_add_f32_dpp v181, v181, v181 quad_perm:[2,3,0,1] row_mask:0xf bank_mask:0xf
  v_add_f32_dpp v182, v182, v182 quad_perm:[2,3,0,1] row_mask:0xf bank_mask:0xf
  v_add_f32_dpp v183, v183, v183 quad_perm:[2,3,0,1] row_mask:0xf bank_mask:0xf
  v_add_f32_dpp v184, v184, v184 quad_perm:[2,3,0,1] row_mask:0xf bank_mask:0xf
  v_add_f32_dpp v185, v185, v185 quad_perm:[2,3,0,1] row_mask:0xf bank_mask:0xf
  v_add_f32_dpp v186, v186, v186 quad_perm:[2,3,0,1] row_mask:0xf bank_mask:0xf
  v_add_f32_dpp v187, v187, v187 quad_perm:[2,3,0,1] row_mask:0xf bank_mask:0xf
  v_add_f32_dpp v180, v180, v180 row_ror:4 row_mask:0xf bank_mask:0xf
  v_add_f32_dpp v181, v181, v181 row_ror:4 row_mask:0xf bank_mask:0xf
  v_add_f32_dpp v182, v182, v182 row_ror:4 row_mask:0xf bank_mask:0xf
  v_add_f32_dpp v183, v183, v183 row_ror:4 row_mask:0xf bank_mask:0xf
  v_add_f32_dpp v184, v184, v184 row_ror:4 row_mask:0xf bank_mask:0xf
  v_add_f32_dpp v185, v185, v185 row_ror:4 row_mask:0xf bank_mask:0xf
  v_add_f32_dpp v186, v186, v186 row_ror:4 row_mask:0xf bank_mask:0xf
  v_add_f32_dpp v187, v187, v187 row_ror:4 row_mask:0xf bank_mask:0xf
  v_add_f32_dpp v180, v180, v180 row_ror:8 row_mask:0xf bank_mask:0xf
  v_add_f32_dpp v181, v181, v181 row_ror:8 row_mask:0xf bank_mask:0xf
  v_add_f32_dpp v182, v182, v182 row_ror:8 row_mask:0xf bank_mask:0xf
  v_add_f32_dpp v183, v183, v183 row_ror:8 row_mask:0xf bank_mask:0xf
  v_add_f32_dpp v184, v184, v184 row_ror:8 row_mask:0xf bank_mask:0xf
  v_add_f32_dpp v185, v185, v185 row_ror:8 row_mask:0xf bank_mask:0xf
  v_add_f32_dpp v186, v186, v186 row_ror:8 row_mask:0xf bank_mask:0xf
  v_add_f32_dpp v187, v187, v187 row_ror:8 row_mask:0xf bank_mask:0xf
  v_and_b32 v172, 7, v3
  v_mov_b32 v173, v180
  v_cmp_eq_u32 vcc, 1, v172
  s_nop 1
  v_cndmask_b32 v173, v173, v181, vcc
  v_cmp_eq_u32 vcc, 2, v172
  s_nop 1
  v_cndmask_b32 v173, v173, v182, vcc
  v_cmp_eq_u32 vcc, 3, v172
  s_nop 1
  v_cndmask_b32 v173, v173, v183, vcc
  v_cmp_eq_u32 vcc, 4, v172
  s_nop 1
  v_cndmask_b32 v173, v173, v184, vcc
  v_cmp_eq_u32 vcc, 5, v172
  s_nop 1
  v_cndmask_b32 v173, v173, v185, vcc
  v_cmp_eq_u32 vcc, 6, v172
  s_nop 1
  v_cndmask_b32 v173, v173, v186, vcc
  v_cmp_eq_u32 vcc, 7, v172
  s_nop 1
  v_cndmask_b32 v173, v173, v187, vcc
  v_mov_b32 v174, v173
  s_nop 1
  v_permlane16_swap_b32 v173, v174
  v_add_f32 v175, v173, v174
  v_add_f32 v176, v173, v174
  s_nop 1
  v_permlane32_swap_b32 v175, v176
  v_add_f32 v173, v175, v176
  v_cvt_pk_bf16_f32 v173, v173, v173
  v_and_b32 v173, 0xffff0000, v173
  v_mul_f32 v173, 3216550459, v173
  v_exp_f32 v173, v173
  s_nop 0
  v_add_f32 v173, 1.0, v173
  v_rcp_f32 v173, v173
  s_nop 0
  v_cvt_pk_bf16_f32 v173, v173, v173
  v_and_b32 v173, 0xffff0000, v173
  s_lshr_b32 s38, s38, 8
  s_add_u32 s38, s38, 71303168
  v_lshlrev_b32 v172, 2, v172
  s_mov_b64 exec, 0xff
  buffer_store_dword v173, v172, s[4:7], s38 offen sc1
  s_mov_b64 exec, -1
  global_load_dwordx4 v[128:131], v6, s[60:61] offset:0
  global_load_dwordx4 v[132:135], v6, s[60:61] offset:1024
  global_load_dwordx4 v[136:139], v6, s[60:61] offset:2048
  global_load_dwordx4 v[140:143], v6, s[60:61] offset:3072
  global_load_dwordx4 v[144:147], v8, s[60:61] offset:0
  global_load_dwordx4 v[148:151], v8, s[60:61] offset:1024
  global_load_dwordx4 v[152:155], v8, s[60:61] offset:2048
  global_load_dwordx4 v[156:159], v8, s[60:61] offset:3072
  v_lshlrev_b32 v9, 4, v0
  v_add_u32 v9, 512, v9
  v_lshlrev_b32 v160, 16, v16
  v_lshlrev_b32 v161, 16, v20
  v_lshlrev_b32 v162, 16, v24
  v_lshlrev_b32 v163, 16, v28
  v_lshlrev_b32 v164, 16, v32
  v_lshlrev_b32 v165, 16, v36
  v_lshlrev_b32 v166, 16, v40
  v_lshlrev_b32 v167, 16, v44
  v_lshlrev_b32 v168, 16, v48
  v_lshlrev_b32 v169, 16, v52
  v_lshlrev_b32 v170, 16, v56
  s_lshl_b32 s100, s80, 16
  s_and_b32 s101, s80, 0xffff0000
  s_lshl_b32 s68, s81, 16
  s_and_b32 s69, s81, 0xffff0000
  v_mul_f32 v172, s69, v160
  v_mul_f32 v173, s69, v161
  v_cvt_pk_bf16_f32 v174, v172, v173
  v_lshlrev_b32 v176, 16, v174
  v_and_b32 v177, 0xffff0000, v174
  v_mul_f32 v172, s68, v161
  v_mul_f32 v173, s68, v162
  v_cvt_pk_bf16_f32 v174, v172, v173
  v_lshlrev_b32 v172, 16, v174
  v_and_b32 v173, 0xffff0000, v174
  v_add_f32 v176, v176, v172
  v_add_f32 v177, v177, v173
  v_cvt_pk_bf16_f32 v174, v176, v177
  v_lshlrev_b32 v176, 16, v174
  v_and_b32 v177, 0xffff0000, v174
  v_mul_f32 v172, s101, v162
  v_mul_f32 v173, s101, v163
  v_cvt_pk_bf16_f32 v174, v172, v173
  v_lshlrev_b32 v172, 16, v174
  v_and_b32 v173, 0xffff0000, v174
  v_add_f32 v176, v176, v172
  v_add_f32 v177, v177, v173
  v_cvt_pk_bf16_f32 v174, v176, v177
  v_lshlrev_b32 v176, 16, v174
  v_and_b32 v177, 0xffff0000, v174
  v_mul_f32 v172, s100, v163
  v_mul_f32 v173, s100, v164
  v_cvt_pk_bf16_f32 v174, v172, v173
  v_lshlrev_b32 v172, 16, v174
  v_and_b32 v173, 0xffff0000, v174
  v_add_f32 v176, v176, v172
  v_add_f32 v177, v177, v173
  v_cvt_pk_bf16_f32 v174, v176, v177
  v_lshlrev_b32 v176, 16, v174
  v_and_b32 v177, 0xffff0000, v174
  v_lshlrev_b32 v172, 16, v60
  v_mul_f32 v172, v172, v176
  v_lshlrev_b32 v173, 16, v64
  v_mul_f32 v173, v173, v177
  v_cvt_pk_bf16_f32 v95, v173, v172
  v_mul_f32 v172, s69, v162
  v_mul_f32 v173, s69, v163
  v_cvt_pk_bf16_f32 v174, v172, v173
  v_lshlrev_b32 v176, 16, v174
  v_and_b32 v177, 0xffff0000, v174
  v_mul_f32 v172, s68, v163
  v_mul_f32 v173, s68, v164
  v_cvt_pk_bf16_f32 v174, v172, v173
  v_lshlrev_b32 v172, 16, v174
  v_and_b32 v173, 0xffff0000, v174
  v_add_f32 v176, v176, v172
  v_add_f32 v177, v177, v173
  v_cvt_pk_bf16_f32 v174, v176, v177
  v_lshlrev_b32 v176, 16, v174
  v_and_b32 v177, 0xffff0000, v174
  v_mul_f32 v172, s101, v164
  v_mul_f32 v173, s101, v165
  v_cvt_pk_bf16_f32 v174, v172, v173
  v_lshlrev_b32 v172, 16, v174
  v_and_b32 v173, 0xffff0000, v174
  v_add_f32 v176, v176, v172
  v_add_f32 v177, v177, v173
  v_cvt_pk_bf16_f32 v174, v176, v177
  v_lshlrev_b32 v176, 16, v174
  v_and_b32 v177, 0xffff0000, v174
  v_mul_f32 v172, s100, v165
  v_mul_f32 v173, s100, v166
  v_cvt_pk_bf16_f32 v174, v172, v173
  v_lshlrev_b32 v172, 16, v174
  v_and_b32 v173, 0xffff0000, v174
  v_add_f32 v176, v176, v172
  v_add_f32 v177, v177, v173
  v_cvt_pk_bf16_f32 v174, v176, v177
  v_lshlrev_b32 v176, 16, v174
  v_and_b32 v177, 0xffff0000, v174
  v_lshlrev_b32 v172, 16, v68
  v_mul_f32 v172, v172, v176
  v_lshlrev_b32 v173, 16, v72
  v_mul_f32 v173, v173, v177
  v_cvt_pk_bf16_f32 v94, v173, v172
  v_mul_f32 v172, s69, v164
  v_mul_f32 v173, s69, v165
  v_cvt_pk_bf16_f32 v174, v172, v173
  v_lshlrev_b32 v176, 16, v174
  v_and_b32 v177, 0xffff0000, v174
  v_mul_f32 v172, s68, v165
  v_mul_f32 v173, s68, v166
  v_cvt_pk_bf16_f32 v174, v172, v173
  v_lshlrev_b32 v172, 16, v174
  v_and_b32 v173, 0xffff0000, v174
  v_add_f32 v176, v176, v172
  v_add_f32 v177, v177, v173
  v_cvt_pk_bf16_f32 v174, v176, v177
  v_lshlrev_b32 v176, 16, v174
  v_and_b32 v177, 0xffff0000, v174
  v_mul_f32 v172, s101, v166
  v_mul_f32 v173, s101, v167
  v_cvt_pk_bf16_f32 v174, v172, v173
  v_lshlrev_b32 v172, 16, v174
  v_and_b32 v173, 0xffff0000, v174
  v_add_f32 v176, v176, v172
  v_add_f32 v177, v177, v173
  v_cvt_pk_bf16_f32 v174, v176, v177
  v_lshlrev_b32 v176, 16, v174
  v_and_b32 v177, 0xffff0000, v174
  v_mul_f32 v172, s100, v167
  v_mul_f32 v173, s100, v168
  v_cvt_pk_bf16_f32 v174, v172, v173
  v_lshlrev_b32 v172, 16, v174
  v_and_b32 v173, 0xffff0000, v174
  v_add_f32 v176, v176, v172
  v_add_f32 v177, v177, v173
  v_cvt_pk_bf16_f32 v174, v176, v177
  v_lshlrev_b32 v176, 16, v174
  v_and_b32 v177, 0xffff0000, v174
  v_lshlrev_b32 v172, 16, v76
  v_mul_f32 v172, v172, v176
  v_lshlrev_b32 v173, 16, v80
  v_mul_f32 v173, v173, v177
  v_cvt_pk_bf16_f32 v93, v173, v172
  v_mul_f32 v172, s69, v166
  v_mul_f32 v173, s69, v167
  v_cvt_pk_bf16_f32 v174, v172, v173
  v_lshlrev_b32 v176, 16, v174
  v_and_b32 v177, 0xffff0000, v174
  v_mul_f32 v172, s68, v167
  v_mul_f32 v173, s68, v168
  v_cvt_pk_bf16_f32 v174, v172, v173
  v_lshlrev_b32 v172, 16, v174
  v_and_b32 v173, 0xffff0000, v174
  v_add_f32 v176, v176, v172
  v_add_f32 v177, v177, v173
  v_cvt_pk_bf16_f32 v174, v176, v177
  v_lshlrev_b32 v176, 16, v174
  v_and_b32 v177, 0xffff0000, v174
  v_mul_f32 v172, s101, v168
  v_mul_f32 v173, s101, v169
  v_cvt_pk_bf16_f32 v174, v172, v173
  v_lshlrev_b32 v172, 16, v174
  v_and_b32 v173, 0xffff0000, v174
  v_add_f32 v176, v176, v172
  v_add_f32 v177, v177, v173
  v_cvt_pk_bf16_f32 v174, v176, v177
  v_lshlrev_b32 v176, 16, v174
  v_and_b32 v177, 0xffff0000, v174
  v_mul_f32 v172, s100, v169
  v_mul_f32 v173, s100, v170
  v_cvt_pk_bf16_f32 v174, v172, v173
  v_lshlrev_b32 v172, 16, v174
  v_and_b32 v173, 0xffff0000, v174
  v_add_f32 v176, v176, v172
  v_add_f32 v177, v177, v173
  v_cvt_pk_bf16_f32 v174, v176, v177
  v_lshlrev_b32 v176, 16, v174
  v_and_b32 v177, 0xffff0000, v174
  v_lshlrev_b32 v172, 16, v84
  v_mul_f32 v172, v172, v176
  v_lshlrev_b32 v173, 16, v88
  v_mul_f32 v173, v173, v177
  v_cvt_pk_bf16_f32 v92, v173, v172
  ds_write_b128 v9, v[92:95] offset:0
  v_and_b32 v160, 0xffff0000, v16
  v_and_b32 v161, 0xffff0000, v20
  v_and_b32 v162, 0xffff0000, v24
  v_and_b32 v163, 0xffff0000, v28
  v_and_b32 v164, 0xffff0000, v32
  v_and_b32 v165, 0xffff0000, v36
  v_and_b32 v166, 0xffff0000, v40
  v_and_b32 v167, 0xffff0000, v44
  v_and_b32 v168, 0xffff0000, v48
  v_and_b32 v169, 0xffff0000, v52
  v_and_b32 v170, 0xffff0000, v56
  s_lshl_b32 s100, s82, 16
  s_and_b32 s101, s82, 0xffff0000
  s_lshl_b32 s68, s83, 16
  s_and_b32 s69, s83, 0xffff0000
  v_mul_f32 v172, s69, v160
  v_mul_f32 v173, s69, v161
  v_cvt_pk_bf16_f32 v174, v172, v173
  v_lshlrev_b32 v176, 16, v174
  v_and_b32 v177, 0xffff0000, v174
  v_mul_f32 v172, s68, v161
  v_mul_f32 v173, s68, v162
  v_cvt_pk_bf16_f32 v174, v172, v173
  v_lshlrev_b32 v172, 16, v174
  v_and_b32 v173, 0xffff0000, v174
  v_add_f32 v176, v176, v172
  v_add_f32 v177, v177, v173
  v_cvt_pk_bf16_f32 v174, v176, v177
  v_lshlrev_b32 v176, 16, v174
  v_and_b32 v177, 0xffff0000, v174
  v_mul_f32 v172, s101, v162
  v_mul_f32 v173, s101, v163
  v_cvt_pk_bf16_f32 v174, v172, v173
  v_lshlrev_b32 v172, 16, v174
  v_and_b32 v173, 0xffff0000, v174
  v_add_f32 v176, v176, v172
  v_add_f32 v177, v177, v173
  v_cvt_pk_bf16_f32 v174, v176, v177
  v_lshlrev_b32 v176, 16, v174
  v_and_b32 v177, 0xffff0000, v174
  v_mul_f32 v172, s100, v163
  v_mul_f32 v173, s100, v164
  v_cvt_pk_bf16_f32 v174, v172, v173
  v_lshlrev_b32 v172, 16, v174
  v_and_b32 v173, 0xffff0000, v174
  v_add_f32 v176, v176, v172
  v_add_f32 v177, v177, v173
  v_cvt_pk_bf16_f32 v174, v176, v177
  v_lshlrev_b32 v176, 16, v174
  v_and_b32 v177, 0xffff0000, v174
  v_and_b32 v172, 0xffff0000, v60
  v_mul_f32 v172, v172, v176
  v_and_b32 v173, 0xffff0000, v64
  v_mul_f32 v173, v173, v177
  v_cvt_pk_bf16_f32 v99, v173, v172
  v_mul_f32 v172, s69, v162
  v_mul_f32 v173, s69, v163
  v_cvt_pk_bf16_f32 v174, v172, v173
  v_lshlrev_b32 v176, 16, v174
  v_and_b32 v177, 0xffff0000, v174
  v_mul_f32 v172, s68, v163
  v_mul_f32 v173, s68, v164
  v_cvt_pk_bf16_f32 v174, v172, v173
  v_lshlrev_b32 v172, 16, v174
  v_and_b32 v173, 0xffff0000, v174
  v_add_f32 v176, v176, v172
  v_add_f32 v177, v177, v173
  v_cvt_pk_bf16_f32 v174, v176, v177
  v_lshlrev_b32 v176, 16, v174
  v_and_b32 v177, 0xffff0000, v174
  v_mul_f32 v172, s101, v164
  v_mul_f32 v173, s101, v165
  v_cvt_pk_bf16_f32 v174, v172, v173
  v_lshlrev_b32 v172, 16, v174
  v_and_b32 v173, 0xffff0000, v174
  v_add_f32 v176, v176, v172
  v_add_f32 v177, v177, v173
  v_cvt_pk_bf16_f32 v174, v176, v177
  v_lshlrev_b32 v176, 16, v174
  v_and_b32 v177, 0xffff0000, v174
  v_mul_f32 v172, s100, v165
  v_mul_f32 v173, s100, v166
  v_cvt_pk_bf16_f32 v174, v172, v173
  v_lshlrev_b32 v172, 16, v174
  v_and_b32 v173, 0xffff0000, v174
  v_add_f32 v176, v176, v172
  v_add_f32 v177, v177, v173
  v_cvt_pk_bf16_f32 v174, v176, v177
  v_lshlrev_b32 v176, 16, v174
  v_and_b32 v177, 0xffff0000, v174
  v_and_b32 v172, 0xffff0000, v68
  v_mul_f32 v172, v172, v176
  v_and_b32 v173, 0xffff0000, v72
  v_mul_f32 v173, v173, v177
  v_cvt_pk_bf16_f32 v98, v173, v172
  v_mul_f32 v172, s69, v164
  v_mul_f32 v173, s69, v165
  v_cvt_pk_bf16_f32 v174, v172, v173
  v_lshlrev_b32 v176, 16, v174
  v_and_b32 v177, 0xffff0000, v174
  v_mul_f32 v172, s68, v165
  v_mul_f32 v173, s68, v166
  v_cvt_pk_bf16_f32 v174, v172, v173
  v_lshlrev_b32 v172, 16, v174
  v_and_b32 v173, 0xffff0000, v174
  v_add_f32 v176, v176, v172
  v_add_f32 v177, v177, v173
  v_cvt_pk_bf16_f32 v174, v176, v177
  v_lshlrev_b32 v176, 16, v174
  v_and_b32 v177, 0xffff0000, v174
  v_mul_f32 v172, s101, v166
  v_mul_f32 v173, s101, v167
  v_cvt_pk_bf16_f32 v174, v172, v173
  v_lshlrev_b32 v172, 16, v174
  v_and_b32 v173, 0xffff0000, v174
  v_add_f32 v176, v176, v172
  v_add_f32 v177, v177, v173
  v_cvt_pk_bf16_f32 v174, v176, v177
  v_lshlrev_b32 v176, 16, v174
  v_and_b32 v177, 0xffff0000, v174
  v_mul_f32 v172, s100, v167
  v_mul_f32 v173, s100, v168
  v_cvt_pk_bf16_f32 v174, v172, v173
  v_lshlrev_b32 v172, 16, v174
  v_and_b32 v173, 0xffff0000, v174
  v_add_f32 v176, v176, v172
  v_add_f32 v177, v177, v173
  v_cvt_pk_bf16_f32 v174, v176, v177
  v_lshlrev_b32 v176, 16, v174
  v_and_b32 v177, 0xffff0000, v174
  v_and_b32 v172, 0xffff0000, v76
  v_mul_f32 v172, v172, v176
  v_and_b32 v173, 0xffff0000, v80
  v_mul_f32 v173, v173, v177
  v_cvt_pk_bf16_f32 v97, v173, v172
  v_mul_f32 v172, s69, v166
  v_mul_f32 v173, s69, v167
  v_cvt_pk_bf16_f32 v174, v172, v173
  v_lshlrev_b32 v176, 16, v174
  v_and_b32 v177, 0xffff0000, v174
  v_mul_f32 v172, s68, v167
  v_mul_f32 v173, s68, v168
  v_cvt_pk_bf16_f32 v174, v172, v173
  v_lshlrev_b32 v172, 16, v174
  v_and_b32 v173, 0xffff0000, v174
  v_add_f32 v176, v176, v172
  v_add_f32 v177, v177, v173
  v_cvt_pk_bf16_f32 v174, v176, v177
  v_lshlrev_b32 v176, 16, v174
  v_and_b32 v177, 0xffff0000, v174
  v_mul_f32 v172, s101, v168
  v_mul_f32 v173, s101, v169
  v_cvt_pk_bf16_f32 v174, v172, v173
  v_lshlrev_b32 v172, 16, v174
  v_and_b32 v173, 0xffff0000, v174
  v_add_f32 v176, v176, v172
  v_add_f32 v177, v177, v173
  v_cvt_pk_bf16_f32 v174, v176, v177
  v_lshlrev_b32 v176, 16, v174
  v_and_b32 v177, 0xffff0000, v174
  v_mul_f32 v172, s100, v169
  v_mul_f32 v173, s100, v170
  v_cvt_pk_bf16_f32 v174, v172, v173
  v_lshlrev_b32 v172, 16, v174
  v_and_b32 v173, 0xffff0000, v174
  v_add_f32 v176, v176, v172
  v_add_f32 v177, v177, v173
  v_cvt_pk_bf16_f32 v174, v176, v177
  v_lshlrev_b32 v176, 16, v174
  v_and_b32 v177, 0xffff0000, v174
  v_and_b32 v172, 0xffff0000, v84
  v_mul_f32 v172, v172, v176
  v_and_b32 v173, 0xffff0000, v88
  v_mul_f32 v173, v173, v177
  v_cvt_pk_bf16_f32 v96, v173, v172
  ds_write_b128 v9, v[96:99] offset:4608
  v_lshlrev_b32 v160, 16, v17
  v_lshlrev_b32 v161, 16, v21
  v_lshlrev_b32 v162, 16, v25
  v_lshlrev_b32 v163, 16, v29
  v_lshlrev_b32 v164, 16, v33
  v_lshlrev_b32 v165, 16, v37
  v_lshlrev_b32 v166, 16, v41
  v_lshlrev_b32 v167, 16, v45
  v_lshlrev_b32 v168, 16, v49
  v_lshlrev_b32 v169, 16, v53
  v_lshlrev_b32 v170, 16, v57
  s_lshl_b32 s100, s84, 16
  s_and_b32 s101, s84, 0xffff0000
  s_lshl_b32 s68, s85, 16
  s_and_b32 s69, s85, 0xffff0000
  v_mul_f32 v172, s69, v160
  v_mul_f32 v173, s69, v161
  v_cvt_pk_bf16_f32 v174, v172, v173
  v_lshlrev_b32 v176, 16, v174
  v_and_b32 v177, 0xffff0000, v174
  v_mul_f32 v172, s68, v161
  v_mul_f32 v173, s68, v162
  v_cvt_pk_bf16_f32 v174, v172, v173
  v_lshlrev_b32 v172, 16, v174
  v_and_b32 v173, 0xffff0000, v174
  v_add_f32 v176, v176, v172
  v_add_f32 v177, v177, v173
  v_cvt_pk_bf16_f32 v174, v176, v177
  v_lshlrev_b32 v176, 16, v174
  v_and_b32 v177, 0xffff0000, v174
  v_mul_f32 v172, s101, v162
  v_mul_f32 v173, s101, v163
  v_cvt_pk_bf16_f32 v174, v172, v173
  v_lshlrev_b32 v172, 16, v174
  v_and_b32 v173, 0xffff0000, v174
  v_add_f32 v176, v176, v172
  v_add_f32 v177, v177, v173
  v_cvt_pk_bf16_f32 v174, v176, v177
  v_lshlrev_b32 v176, 16, v174
  v_and_b32 v177, 0xffff0000, v174
  v_mul_f32 v172, s100, v163
  v_mul_f32 v173, s100, v164
  v_cvt_pk_bf16_f32 v174, v172, v173
  v_lshlrev_b32 v172, 16, v174
  v_and_b32 v173, 0xffff0000, v174
  v_add_f32 v176, v176, v172
  v_add_f32 v177, v177, v173
  v_cvt_pk_bf16_f32 v174, v176, v177
  v_lshlrev_b32 v176, 16, v174
  v_and_b32 v177, 0xffff0000, v174
  v_lshlrev_b32 v172, 16, v61
  v_mul_f32 v172, v172, v176
  v_lshlrev_b32 v173, 16, v65
  v_mul_f32 v173, v173, v177
  v_cvt_pk_bf16_f32 v103, v173, v172
  v_mul_f32 v172, s69, v162
  v_mul_f32 v173, s69, v163
  v_cvt_pk_bf16_f32 v174, v172, v173
  v_lshlrev_b32 v176, 16, v174
  v_and_b32 v177, 0xffff0000, v174
  v_mul_f32 v172, s68, v163
  v_mul_f32 v173, s68, v164
  v_cvt_pk_bf16_f32 v174, v172, v173
  v_lshlrev_b32 v172, 16, v174
  v_and_b32 v173, 0xffff0000, v174
  v_add_f32 v176, v176, v172
  v_add_f32 v177, v177, v173
  v_cvt_pk_bf16_f32 v174, v176, v177
  v_lshlrev_b32 v176, 16, v174
  v_and_b32 v177, 0xffff0000, v174
  v_mul_f32 v172, s101, v164
  v_mul_f32 v173, s101, v165
  v_cvt_pk_bf16_f32 v174, v172, v173
  v_lshlrev_b32 v172, 16, v174
  v_and_b32 v173, 0xffff0000, v174
  v_add_f32 v176, v176, v172
  v_add_f32 v177, v177, v173
  v_cvt_pk_bf16_f32 v174, v176, v177
  v_lshlrev_b32 v176, 16, v174
  v_and_b32 v177, 0xffff0000, v174
  v_mul_f32 v172, s100, v165
  v_mul_f32 v173, s100, v166
  v_cvt_pk_bf16_f32 v174, v172, v173
  v_lshlrev_b32 v172, 16, v174
  v_and_b32 v173, 0xffff0000, v174
  v_add_f32 v176, v176, v172
  v_add_f32 v177, v177, v173
  v_cvt_pk_bf16_f32 v174, v176, v177
  v_lshlrev_b32 v176, 16, v174
  v_and_b32 v177, 0xffff0000, v174
  v_lshlrev_b32 v172, 16, v69
  v_mul_f32 v172, v172, v176
  v_lshlrev_b32 v173, 16, v73
  v_mul_f32 v173, v173, v177
  v_cvt_pk_bf16_f32 v102, v173, v172
  v_mul_f32 v172, s69, v164
  v_mul_f32 v173, s69, v165
  v_cvt_pk_bf16_f32 v174, v172, v173
  v_lshlrev_b32 v176, 16, v174
  v_and_b32 v177, 0xffff0000, v174
  v_mul_f32 v172, s68, v165
  v_mul_f32 v173, s68, v166
  v_cvt_pk_bf16_f32 v174, v172, v173
  v_lshlrev_b32 v172, 16, v174
  v_and_b32 v173, 0xffff0000, v174
  v_add_f32 v176, v176, v172
  v_add_f32 v177, v177, v173
  v_cvt_pk_bf16_f32 v174, v176, v177
  v_lshlrev_b32 v176, 16, v174
  v_and_b32 v177, 0xffff0000, v174
  v_mul_f32 v172, s101, v166
  v_mul_f32 v173, s101, v167
  v_cvt_pk_bf16_f32 v174, v172, v173
  v_lshlrev_b32 v172, 16, v174
  v_and_b32 v173, 0xffff0000, v174
  v_add_f32 v176, v176, v172
  v_add_f32 v177, v177, v173
  v_cvt_pk_bf16_f32 v174, v176, v177
  v_lshlrev_b32 v176, 16, v174
  v_and_b32 v177, 0xffff0000, v174
  v_mul_f32 v172, s100, v167
  v_mul_f32 v173, s100, v168
  v_cvt_pk_bf16_f32 v174, v172, v173
  v_lshlrev_b32 v172, 16, v174
  v_and_b32 v173, 0xffff0000, v174
  v_add_f32 v176, v176, v172
  v_add_f32 v177, v177, v173
  v_cvt_pk_bf16_f32 v174, v176, v177
  v_lshlrev_b32 v176, 16, v174
  v_and_b32 v177, 0xffff0000, v174
  v_lshlrev_b32 v172, 16, v77
  v_mul_f32 v172, v172, v176
  v_lshlrev_b32 v173, 16, v81
  v_mul_f32 v173, v173, v177
  v_cvt_pk_bf16_f32 v101, v173, v172
  v_mul_f32 v172, s69, v166
  v_mul_f32 v173, s69, v167
  v_cvt_pk_bf16_f32 v174, v172, v173
  v_lshlrev_b32 v176, 16, v174
  v_and_b32 v177, 0xffff0000, v174
  v_mul_f32 v172, s68, v167
  v_mul_f32 v173, s68, v168
  v_cvt_pk_bf16_f32 v174, v172, v173
  v_lshlrev_b32 v172, 16, v174
  v_and_b32 v173, 0xffff0000, v174
  v_add_f32 v176, v176, v172
  v_add_f32 v177, v177, v173
  v_cvt_pk_bf16_f32 v174, v176, v177
  v_lshlrev_b32 v176, 16, v174
  v_and_b32 v177, 0xffff0000, v174
  v_mul_f32 v172, s101, v168
  v_mul_f32 v173, s101, v169
  v_cvt_pk_bf16_f32 v174, v172, v173
  v_lshlrev_b32 v172, 16, v174
  v_and_b32 v173, 0xffff0000, v174
  v_add_f32 v176, v176, v172
  v_add_f32 v177, v177, v173
  v_cvt_pk_bf16_f32 v174, v176, v177
  v_lshlrev_b32 v176, 16, v174
  v_and_b32 v177, 0xffff0000, v174
  v_mul_f32 v172, s100, v169
  v_mul_f32 v173, s100, v170
  v_cvt_pk_bf16_f32 v174, v172, v173
  v_lshlrev_b32 v172, 16, v174
  v_and_b32 v173, 0xffff0000, v174
  v_add_f32 v176, v176, v172
  v_add_f32 v177, v177, v173
  v_cvt_pk_bf16_f32 v174, v176, v177
  v_lshlrev_b32 v176, 16, v174
  v_and_b32 v177, 0xffff0000, v174
  v_lshlrev_b32 v172, 16, v85
  v_mul_f32 v172, v172, v176
  v_lshlrev_b32 v173, 16, v89
  v_mul_f32 v173, v173, v177
  v_cvt_pk_bf16_f32 v100, v173, v172
  ds_write_b128 v9, v[100:103] offset:9216
  v_and_b32 v160, 0xffff0000, v17
  v_and_b32 v161, 0xffff0000, v21
  v_and_b32 v162, 0xffff0000, v25
  v_and_b32 v163, 0xffff0000, v29
  v_and_b32 v164, 0xffff0000, v33
  v_and_b32 v165, 0xffff0000, v37
  v_and_b32 v166, 0xffff0000, v41
  v_and_b32 v167, 0xffff0000, v45
  v_and_b32 v168, 0xffff0000, v49
  v_and_b32 v169, 0xffff0000, v53
  v_and_b32 v170, 0xffff0000, v57
  s_lshl_b32 s100, s86, 16
  s_and_b32 s101, s86, 0xffff0000
  s_lshl_b32 s68, s87, 16
  s_and_b32 s69, s87, 0xffff0000
  v_mul_f32 v172, s69, v160
  v_mul_f32 v173, s69, v161
  v_cvt_pk_bf16_f32 v174, v172, v173
  v_lshlrev_b32 v176, 16, v174
  v_and_b32 v177, 0xffff0000, v174
  v_mul_f32 v172, s68, v161
  v_mul_f32 v173, s68, v162
  v_cvt_pk_bf16_f32 v174, v172, v173
  v_lshlrev_b32 v172, 16, v174
  v_and_b32 v173, 0xffff0000, v174
  v_add_f32 v176, v176, v172
  v_add_f32 v177, v177, v173
  v_cvt_pk_bf16_f32 v174, v176, v177
  v_lshlrev_b32 v176, 16, v174
  v_and_b32 v177, 0xffff0000, v174
  v_mul_f32 v172, s101, v162
  v_mul_f32 v173, s101, v163
  v_cvt_pk_bf16_f32 v174, v172, v173
  v_lshlrev_b32 v172, 16, v174
  v_and_b32 v173, 0xffff0000, v174
  v_add_f32 v176, v176, v172
  v_add_f32 v177, v177, v173
  v_cvt_pk_bf16_f32 v174, v176, v177
  v_lshlrev_b32 v176, 16, v174
  v_and_b32 v177, 0xffff0000, v174
  v_mul_f32 v172, s100, v163
  v_mul_f32 v173, s100, v164
  v_cvt_pk_bf16_f32 v174, v172, v173
  v_lshlrev_b32 v172, 16, v174
  v_and_b32 v173, 0xffff0000, v174
  v_add_f32 v176, v176, v172
  v_add_f32 v177, v177, v173
  v_cvt_pk_bf16_f32 v174, v176, v177
  v_lshlrev_b32 v176, 16, v174
  v_and_b32 v177, 0xffff0000, v174
  v_and_b32 v172, 0xffff0000, v61
  v_mul_f32 v172, v172, v176
  v_and_b32 v173, 0xffff0000, v65
  v_mul_f32 v173, v173, v177
  v_cvt_pk_bf16_f32 v107, v173, v172
  v_mul_f32 v172, s69, v162
  v_mul_f32 v173, s69, v163
  v_cvt_pk_bf16_f32 v174, v172, v173
  v_lshlrev_b32 v176, 16, v174
  v_and_b32 v177, 0xffff0000, v174
  v_mul_f32 v172, s68, v163
  v_mul_f32 v173, s68, v164
  v_cvt_pk_bf16_f32 v174, v172, v173
  v_lshlrev_b32 v172, 16, v174
  v_and_b32 v173, 0xffff0000, v174
  v_add_f32 v176, v176, v172
  v_add_f32 v177, v177, v173
  v_cvt_pk_bf16_f32 v174, v176, v177
  v_lshlrev_b32 v176, 16, v174
  v_and_b32 v177, 0xffff0000, v174
  v_mul_f32 v172, s101, v164
  v_mul_f32 v173, s101, v165
  v_cvt_pk_bf16_f32 v174, v172, v173
  v_lshlrev_b32 v172, 16, v174
  v_and_b32 v173, 0xffff0000, v174
  v_add_f32 v176, v176, v172
  v_add_f32 v177, v177, v173
  v_cvt_pk_bf16_f32 v174, v176, v177
  v_lshlrev_b32 v176, 16, v174
  v_and_b32 v177, 0xffff0000, v174
  v_mul_f32 v172, s100, v165
  v_mul_f32 v173, s100, v166
  v_cvt_pk_bf16_f32 v174, v172, v173
  v_lshlrev_b32 v172, 16, v174
  v_and_b32 v173, 0xffff0000, v174
  v_add_f32 v176, v176, v172
  v_add_f32 v177, v177, v173
  v_cvt_pk_bf16_f32 v174, v176, v177
  v_lshlrev_b32 v176, 16, v174
  v_and_b32 v177, 0xffff0000, v174
  v_and_b32 v172, 0xffff0000, v69
  v_mul_f32 v172, v172, v176
  v_and_b32 v173, 0xffff0000, v73
  v_mul_f32 v173, v173, v177
  v_cvt_pk_bf16_f32 v106, v173, v172
  v_mul_f32 v172, s69, v164
  v_mul_f32 v173, s69, v165
  v_cvt_pk_bf16_f32 v174, v172, v173
  v_lshlrev_b32 v176, 16, v174
  v_and_b32 v177, 0xffff0000, v174
  v_mul_f32 v172, s68, v165
  v_mul_f32 v173, s68, v166
  v_cvt_pk_bf16_f32 v174, v172, v173
  v_lshlrev_b32 v172, 16, v174
  v_and_b32 v173, 0xffff0000, v174
  v_add_f32 v176, v176, v172
  v_add_f32 v177, v177, v173
  v_cvt_pk_bf16_f32 v174, v176, v177
  v_lshlrev_b32 v176, 16, v174
  v_and_b32 v177, 0xffff0000, v174
  v_mul_f32 v172, s101, v166
  v_mul_f32 v173, s101, v167
  v_cvt_pk_bf16_f32 v174, v172, v173
  v_lshlrev_b32 v172, 16, v174
  v_and_b32 v173, 0xffff0000, v174
  v_add_f32 v176, v176, v172
  v_add_f32 v177, v177, v173
  v_cvt_pk_bf16_f32 v174, v176, v177
  v_lshlrev_b32 v176, 16, v174
  v_and_b32 v177, 0xffff0000, v174
  v_mul_f32 v172, s100, v167
  v_mul_f32 v173, s100, v168
  v_cvt_pk_bf16_f32 v174, v172, v173
  v_lshlrev_b32 v172, 16, v174
  v_and_b32 v173, 0xffff0000, v174
  v_add_f32 v176, v176, v172
  v_add_f32 v177, v177, v173
  v_cvt_pk_bf16_f32 v174, v176, v177
  v_lshlrev_b32 v176, 16, v174
  v_and_b32 v177, 0xffff0000, v174
  v_and_b32 v172, 0xffff0000, v77
  v_mul_f32 v172, v172, v176
  v_and_b32 v173, 0xffff0000, v81
  v_mul_f32 v173, v173, v177
  v_cvt_pk_bf16_f32 v105, v173, v172
  v_mul_f32 v172, s69, v166
  v_mul_f32 v173, s69, v167
  v_cvt_pk_bf16_f32 v174, v172, v173
  v_lshlrev_b32 v176, 16, v174
  v_and_b32 v177, 0xffff0000, v174
  v_mul_f32 v172, s68, v167
  v_mul_f32 v173, s68, v168
  v_cvt_pk_bf16_f32 v174, v172, v173
  v_lshlrev_b32 v172, 16, v174
  v_and_b32 v173, 0xffff0000, v174
  v_add_f32 v176, v176, v172
  v_add_f32 v177, v177, v173
  v_cvt_pk_bf16_f32 v174, v176, v177
  v_lshlrev_b32 v176, 16, v174
  v_and_b32 v177, 0xffff0000, v174
  v_mul_f32 v172, s101, v168
  v_mul_f32 v173, s101, v169
  v_cvt_pk_bf16_f32 v174, v172, v173
  v_lshlrev_b32 v172, 16, v174
  v_and_b32 v173, 0xffff0000, v174
  v_add_f32 v176, v176, v172
  v_add_f32 v177, v177, v173
  v_cvt_pk_bf16_f32 v174, v176, v177
  v_lshlrev_b32 v176, 16, v174
  v_and_b32 v177, 0xffff0000, v174
  v_mul_f32 v172, s100, v169
  v_mul_f32 v173, s100, v170
  v_cvt_pk_bf16_f32 v174, v172, v173
  v_lshlrev_b32 v172, 16, v174
  v_and_b32 v173, 0xffff0000, v174
  v_add_f32 v176, v176, v172
  v_add_f32 v177, v177, v173
  v_cvt_pk_bf16_f32 v174, v176, v177
  v_lshlrev_b32 v176, 16, v174
  v_and_b32 v177, 0xffff0000, v174
  v_and_b32 v172, 0xffff0000, v85
  v_mul_f32 v172, v172, v176
  v_and_b32 v173, 0xffff0000, v89
  v_mul_f32 v173, v173, v177
  v_cvt_pk_bf16_f32 v104, v173, v172
  ds_write_b128 v9, v[104:107] offset:13824
  v_lshlrev_b32 v160, 16, v18
  v_lshlrev_b32 v161, 16, v22
  v_lshlrev_b32 v162, 16, v26
  v_lshlrev_b32 v163, 16, v30
  v_lshlrev_b32 v164, 16, v34
  v_lshlrev_b32 v165, 16, v38
  v_lshlrev_b32 v166, 16, v42
  v_lshlrev_b32 v167, 16, v46
  v_lshlrev_b32 v168, 16, v50
  v_lshlrev_b32 v169, 16, v54
  v_lshlrev_b32 v170, 16, v58
  s_lshl_b32 s100, s88, 16
  s_and_b32 s101, s88, 0xffff0000
  s_lshl_b32 s68, s89, 16
  s_and_b32 s69, s89, 0xffff0000
  v_mul_f32 v172, s69, v160
  v_mul_f32 v173, s69, v161
  v_cvt_pk_bf16_f32 v174, v172, v173
  v_lshlrev_b32 v176, 16, v174
  v_and_b32 v177, 0xffff0000, v174
  v_mul_f32 v172, s68, v161
  v_mul_f32 v173, s68, v162
  v_cvt_pk_bf16_f32 v174, v172, v173
  v_lshlrev_b32 v172, 16, v174
  v_and_b32 v173, 0xffff0000, v174
  v_add_f32 v176, v176, v172
  v_add_f32 v177, v177, v173
  v_cvt_pk_bf16_f32 v174, v176, v177
  v_lshlrev_b32 v176, 16, v174
  v_and_b32 v177, 0xffff0000, v174
  v_mul_f32 v172, s101, v162
  v_mul_f32 v173, s101, v163
  v_cvt_pk_bf16_f32 v174, v172, v173
  v_lshlrev_b32 v172, 16, v174
  v_and_b32 v173, 0xffff0000, v174
  v_add_f32 v176, v176, v172
  v_add_f32 v177, v177, v173
  v_cvt_pk_bf16_f32 v174, v176, v177
  v_lshlrev_b32 v176, 16, v174
  v_and_b32 v177, 0xffff0000, v174
  v_mul_f32 v172, s100, v163
  v_mul_f32 v173, s100, v164
  v_cvt_pk_bf16_f32 v174, v172, v173
  v_lshlrev_b32 v172, 16, v174
  v_and_b32 v173, 0xffff0000, v174
  v_add_f32 v176, v176, v172
  v_add_f32 v177, v177, v173
  v_cvt_pk_bf16_f32 v174, v176, v177
  v_lshlrev_b32 v176, 16, v174
  v_and_b32 v177, 0xffff0000, v174
  v_lshlrev_b32 v172, 16, v62
  v_mul_f32 v172, v172, v176
  v_lshlrev_b32 v173, 16, v66
  v_mul_f32 v173, v173, v177
  v_cvt_pk_bf16_f32 v111, v173, v172
  v_mul_f32 v172, s69, v162
  v_mul_f32 v173, s69, v163
  v_cvt_pk_bf16_f32 v174, v172, v173
  v_lshlrev_b32 v176, 16, v174
  v_and_b32 v177, 0xffff0000, v174
  v_mul_f32 v172, s68, v163
  v_mul_f32 v173, s68, v164
  v_cvt_pk_bf16_f32 v174, v172, v173
  v_lshlrev_b32 v172, 16, v174
  v_and_b32 v173, 0xffff0000, v174
  v_add_f32 v176, v176, v172
  v_add_f32 v177, v177, v173
  v_cvt_pk_bf16_f32 v174, v176, v177
  v_lshlrev_b32 v176, 16, v174
  v_and_b32 v177, 0xffff0000, v174
  v_mul_f32 v172, s101, v164
  v_mul_f32 v173, s101, v165
  v_cvt_pk_bf16_f32 v174, v172, v173
  v_lshlrev_b32 v172, 16, v174
  v_and_b32 v173, 0xffff0000, v174
  v_add_f32 v176, v176, v172
  v_add_f32 v177, v177, v173
  v_cvt_pk_bf16_f32 v174, v176, v177
  v_lshlrev_b32 v176, 16, v174
  v_and_b32 v177, 0xffff0000, v174
  v_mul_f32 v172, s100, v165
  v_mul_f32 v173, s100, v166
  v_cvt_pk_bf16_f32 v174, v172, v173
  v_lshlrev_b32 v172, 16, v174
  v_and_b32 v173, 0xffff0000, v174
  v_add_f32 v176, v176, v172
  v_add_f32 v177, v177, v173
  v_cvt_pk_bf16_f32 v174, v176, v177
  v_lshlrev_b32 v176, 16, v174
  v_and_b32 v177, 0xffff0000, v174
  v_lshlrev_b32 v172, 16, v70
  v_mul_f32 v172, v172, v176
  v_lshlrev_b32 v173, 16, v74
  v_mul_f32 v173, v173, v177
  v_cvt_pk_bf16_f32 v110, v173, v172
  v_mul_f32 v172, s69, v164
  v_mul_f32 v173, s69, v165
  v_cvt_pk_bf16_f32 v174, v172, v173
  v_lshlrev_b32 v176, 16, v174
  v_and_b32 v177, 0xffff0000, v174
  v_mul_f32 v172, s68, v165
  v_mul_f32 v173, s68, v166
  v_cvt_pk_bf16_f32 v174, v172, v173
  v_lshlrev_b32 v172, 16, v174
  v_and_b32 v173, 0xffff0000, v174
  v_add_f32 v176, v176, v172
  v_add_f32 v177, v177, v173
  v_cvt_pk_bf16_f32 v174, v176, v177
  v_lshlrev_b32 v176, 16, v174
  v_and_b32 v177, 0xffff0000, v174
  v_mul_f32 v172, s101, v166
  v_mul_f32 v173, s101, v167
  v_cvt_pk_bf16_f32 v174, v172, v173
  v_lshlrev_b32 v172, 16, v174
  v_and_b32 v173, 0xffff0000, v174
  v_add_f32 v176, v176, v172
  v_add_f32 v177, v177, v173
  v_cvt_pk_bf16_f32 v174, v176, v177
  v_lshlrev_b32 v176, 16, v174
  v_and_b32 v177, 0xffff0000, v174
  v_mul_f32 v172, s100, v167
  v_mul_f32 v173, s100, v168
  v_cvt_pk_bf16_f32 v174, v172, v173
  v_lshlrev_b32 v172, 16, v174
  v_and_b32 v173, 0xffff0000, v174
  v_add_f32 v176, v176, v172
  v_add_f32 v177, v177, v173
  v_cvt_pk_bf16_f32 v174, v176, v177
  v_lshlrev_b32 v176, 16, v174
  v_and_b32 v177, 0xffff0000, v174
  v_lshlrev_b32 v172, 16, v78
  v_mul_f32 v172, v172, v176
  v_lshlrev_b32 v173, 16, v82
  v_mul_f32 v173, v173, v177
  v_cvt_pk_bf16_f32 v109, v173, v172
  v_mul_f32 v172, s69, v166
  v_mul_f32 v173, s69, v167
  v_cvt_pk_bf16_f32 v174, v172, v173
  v_lshlrev_b32 v176, 16, v174
  v_and_b32 v177, 0xffff0000, v174
  v_mul_f32 v172, s68, v167
  v_mul_f32 v173, s68, v168
  v_cvt_pk_bf16_f32 v174, v172, v173
  v_lshlrev_b32 v172, 16, v174
  v_and_b32 v173, 0xffff0000, v174
  v_add_f32 v176, v176, v172
  v_add_f32 v177, v177, v173
  v_cvt_pk_bf16_f32 v174, v176, v177
  v_lshlrev_b32 v176, 16, v174
  v_and_b32 v177, 0xffff0000, v174
  v_mul_f32 v172, s101, v168
  v_mul_f32 v173, s101, v169
  v_cvt_pk_bf16_f32 v174, v172, v173
  v_lshlrev_b32 v172, 16, v174
  v_and_b32 v173, 0xffff0000, v174
  v_add_f32 v176, v176, v172
  v_add_f32 v177, v177, v173
  v_cvt_pk_bf16_f32 v174, v176, v177
  v_lshlrev_b32 v176, 16, v174
  v_and_b32 v177, 0xffff0000, v174
  v_mul_f32 v172, s100, v169
  v_mul_f32 v173, s100, v170
  v_cvt_pk_bf16_f32 v174, v172, v173
  v_lshlrev_b32 v172, 16, v174
  v_and_b32 v173, 0xffff0000, v174
  v_add_f32 v176, v176, v172
  v_add_f32 v177, v177, v173
  v_cvt_pk_bf16_f32 v174, v176, v177
  v_lshlrev_b32 v176, 16, v174
  v_and_b32 v177, 0xffff0000, v174
  v_lshlrev_b32 v172, 16, v86
  v_mul_f32 v172, v172, v176
  v_lshlrev_b32 v173, 16, v90
  v_mul_f32 v173, v173, v177
  v_cvt_pk_bf16_f32 v108, v173, v172
  ds_write_b128 v9, v[108:111] offset:18432
  v_and_b32 v160, 0xffff0000, v18
  v_and_b32 v161, 0xffff0000, v22
  v_and_b32 v162, 0xffff0000, v26
  v_and_b32 v163, 0xffff0000, v30
  v_and_b32 v164, 0xffff0000, v34
  v_and_b32 v165, 0xffff0000, v38
  v_and_b32 v166, 0xffff0000, v42
  v_and_b32 v167, 0xffff0000, v46
  v_and_b32 v168, 0xffff0000, v50
  v_and_b32 v169, 0xffff0000, v54
  v_and_b32 v170, 0xffff0000, v58
  s_lshl_b32 s100, s90, 16
  s_and_b32 s101, s90, 0xffff0000
  s_lshl_b32 s68, s91, 16
  s_and_b32 s69, s91, 0xffff0000
  v_mul_f32 v172, s69, v160
  v_mul_f32 v173, s69, v161
  v_cvt_pk_bf16_f32 v174, v172, v173
  v_lshlrev_b32 v176, 16, v174
  v_and_b32 v177, 0xffff0000, v174
  v_mul_f32 v172, s68, v161
  v_mul_f32 v173, s68, v162
  v_cvt_pk_bf16_f32 v174, v172, v173
  v_lshlrev_b32 v172, 16, v174
  v_and_b32 v173, 0xffff0000, v174
  v_add_f32 v176, v176, v172
  v_add_f32 v177, v177, v173
  v_cvt_pk_bf16_f32 v174, v176, v177
  v_lshlrev_b32 v176, 16, v174
  v_and_b32 v177, 0xffff0000, v174
  v_mul_f32 v172, s101, v162
  v_mul_f32 v173, s101, v163
  v_cvt_pk_bf16_f32 v174, v172, v173
  v_lshlrev_b32 v172, 16, v174
  v_and_b32 v173, 0xffff0000, v174
  v_add_f32 v176, v176, v172
  v_add_f32 v177, v177, v173
  v_cvt_pk_bf16_f32 v174, v176, v177
  v_lshlrev_b32 v176, 16, v174
  v_and_b32 v177, 0xffff0000, v174
  v_mul_f32 v172, s100, v163
  v_mul_f32 v173, s100, v164
  v_cvt_pk_bf16_f32 v174, v172, v173
  v_lshlrev_b32 v172, 16, v174
  v_and_b32 v173, 0xffff0000, v174
  v_add_f32 v176, v176, v172
  v_add_f32 v177, v177, v173
  v_cvt_pk_bf16_f32 v174, v176, v177
  v_lshlrev_b32 v176, 16, v174
  v_and_b32 v177, 0xffff0000, v174
  v_and_b32 v172, 0xffff0000, v62
  v_mul_f32 v172, v172, v176
  v_and_b32 v173, 0xffff0000, v66
  v_mul_f32 v173, v173, v177
  v_cvt_pk_bf16_f32 v115, v173, v172
  v_mul_f32 v172, s69, v162
  v_mul_f32 v173, s69, v163
  v_cvt_pk_bf16_f32 v174, v172, v173
  v_lshlrev_b32 v176, 16, v174
  v_and_b32 v177, 0xffff0000, v174
  v_mul_f32 v172, s68, v163
  v_mul_f32 v173, s68, v164
  v_cvt_pk_bf16_f32 v174, v172, v173
  v_lshlrev_b32 v172, 16, v174
  v_and_b32 v173, 0xffff0000, v174
  v_add_f32 v176, v176, v172
  v_add_f32 v177, v177, v173
  v_cvt_pk_bf16_f32 v174, v176, v177
  v_lshlrev_b32 v176, 16, v174
  v_and_b32 v177, 0xffff0000, v174
  v_mul_f32 v172, s101, v164
  v_mul_f32 v173, s101, v165
  v_cvt_pk_bf16_f32 v174, v172, v173
  v_lshlrev_b32 v172, 16, v174
  v_and_b32 v173, 0xffff0000, v174
  v_add_f32 v176, v176, v172
  v_add_f32 v177, v177, v173
  v_cvt_pk_bf16_f32 v174, v176, v177
  v_lshlrev_b32 v176, 16, v174
  v_and_b32 v177, 0xffff0000, v174
  v_mul_f32 v172, s100, v165
  v_mul_f32 v173, s100, v166
  v_cvt_pk_bf16_f32 v174, v172, v173
  v_lshlrev_b32 v172, 16, v174
  v_and_b32 v173, 0xffff0000, v174
  v_add_f32 v176, v176, v172
  v_add_f32 v177, v177, v173
  v_cvt_pk_bf16_f32 v174, v176, v177
  v_lshlrev_b32 v176, 16, v174
  v_and_b32 v177, 0xffff0000, v174
  v_and_b32 v172, 0xffff0000, v70
  v_mul_f32 v172, v172, v176
  v_and_b32 v173, 0xffff0000, v74
  v_mul_f32 v173, v173, v177
  v_cvt_pk_bf16_f32 v114, v173, v172
  v_mul_f32 v172, s69, v164
  v_mul_f32 v173, s69, v165
  v_cvt_pk_bf16_f32 v174, v172, v173
  v_lshlrev_b32 v176, 16, v174
  v_and_b32 v177, 0xffff0000, v174
  v_mul_f32 v172, s68, v165
  v_mul_f32 v173, s68, v166
  v_cvt_pk_bf16_f32 v174, v172, v173
  v_lshlrev_b32 v172, 16, v174
  v_and_b32 v173, 0xffff0000, v174
  v_add_f32 v176, v176, v172
  v_add_f32 v177, v177, v173
  v_cvt_pk_bf16_f32 v174, v176, v177
  v_lshlrev_b32 v176, 16, v174
  v_and_b32 v177, 0xffff0000, v174
  v_mul_f32 v172, s101, v166
  v_mul_f32 v173, s101, v167
  v_cvt_pk_bf16_f32 v174, v172, v173
  v_lshlrev_b32 v172, 16, v174
  v_and_b32 v173, 0xffff0000, v174
  v_add_f32 v176, v176, v172
  v_add_f32 v177, v177, v173
  v_cvt_pk_bf16_f32 v174, v176, v177
  v_lshlrev_b32 v176, 16, v174
  v_and_b32 v177, 0xffff0000, v174
  v_mul_f32 v172, s100, v167
  v_mul_f32 v173, s100, v168
  v_cvt_pk_bf16_f32 v174, v172, v173
  v_lshlrev_b32 v172, 16, v174
  v_and_b32 v173, 0xffff0000, v174
  v_add_f32 v176, v176, v172
  v_add_f32 v177, v177, v173
  v_cvt_pk_bf16_f32 v174, v176, v177
  v_lshlrev_b32 v176, 16, v174
  v_and_b32 v177, 0xffff0000, v174
  v_and_b32 v172, 0xffff0000, v78
  v_mul_f32 v172, v172, v176
  v_and_b32 v173, 0xffff0000, v82
  v_mul_f32 v173, v173, v177
  v_cvt_pk_bf16_f32 v113, v173, v172
  v_mul_f32 v172, s69, v166
  v_mul_f32 v173, s69, v167
  v_cvt_pk_bf16_f32 v174, v172, v173
  v_lshlrev_b32 v176, 16, v174
  v_and_b32 v177, 0xffff0000, v174
  v_mul_f32 v172, s68, v167
  v_mul_f32 v173, s68, v168
  v_cvt_pk_bf16_f32 v174, v172, v173
  v_lshlrev_b32 v172, 16, v174
  v_and_b32 v173, 0xffff0000, v174
  v_add_f32 v176, v176, v172
  v_add_f32 v177, v177, v173
  v_cvt_pk_bf16_f32 v174, v176, v177
  v_lshlrev_b32 v176, 16, v174
  v_and_b32 v177, 0xffff0000, v174
  v_mul_f32 v172, s101, v168
  v_mul_f32 v173, s101, v169
  v_cvt_pk_bf16_f32 v174, v172, v173
  v_lshlrev_b32 v172, 16, v174
  v_and_b32 v173, 0xffff0000, v174
  v_add_f32 v176, v176, v172
  v_add_f32 v177, v177, v173
  v_cvt_pk_bf16_f32 v174, v176, v177
  v_lshlrev_b32 v176, 16, v174
  v_and_b32 v177, 0xffff0000, v174
  v_mul_f32 v172, s100, v169
  v_mul_f32 v173, s100, v170
  v_cvt_pk_bf16_f32 v174, v172, v173
  v_lshlrev_b32 v172, 16, v174
  v_and_b32 v173, 0xffff0000, v174
  v_add_f32 v176, v176, v172
  v_add_f32 v177, v177, v173
  v_cvt_pk_bf16_f32 v174, v176, v177
  v_lshlrev_b32 v176, 16, v174
  v_and_b32 v177, 0xffff0000, v174
  v_and_b32 v172, 0xffff0000, v86
  v_mul_f32 v172, v172, v176
  v_and_b32 v173, 0xffff0000, v90
  v_mul_f32 v173, v173, v177
  v_cvt_pk_bf16_f32 v112, v173, v172
  ds_write_b128 v9, v[112:115] offset:23040
  v_lshlrev_b32 v160, 16, v19
  v_lshlrev_b32 v161, 16, v23
  v_lshlrev_b32 v162, 16, v27
  v_lshlrev_b32 v163, 16, v31
  v_lshlrev_b32 v164, 16, v35
  v_lshlrev_b32 v165, 16, v39
  v_lshlrev_b32 v166, 16, v43
  v_lshlrev_b32 v167, 16, v47
  v_lshlrev_b32 v168, 16, v51
  v_lshlrev_b32 v169, 16, v55
  v_lshlrev_b32 v170, 16, v59
  s_lshl_b32 s100, s92, 16
  s_and_b32 s101, s92, 0xffff0000
  s_lshl_b32 s68, s93, 16
  s_and_b32 s69, s93, 0xffff0000
  v_mul_f32 v172, s69, v160
  v_mul_f32 v173, s69, v161
  v_cvt_pk_bf16_f32 v174, v172, v173
  v_lshlrev_b32 v176, 16, v174
  v_and_b32 v177, 0xffff0000, v174
  v_mul_f32 v172, s68, v161
  v_mul_f32 v173, s68, v162
  v_cvt_pk_bf16_f32 v174, v172, v173
  v_lshlrev_b32 v172, 16, v174
  v_and_b32 v173, 0xffff0000, v174
  v_add_f32 v176, v176, v172
  v_add_f32 v177, v177, v173
  v_cvt_pk_bf16_f32 v174, v176, v177
  v_lshlrev_b32 v176, 16, v174
  v_and_b32 v177, 0xffff0000, v174
  v_mul_f32 v172, s101, v162
  v_mul_f32 v173, s101, v163
  v_cvt_pk_bf16_f32 v174, v172, v173
  v_lshlrev_b32 v172, 16, v174
  v_and_b32 v173, 0xffff0000, v174
  v_add_f32 v176, v176, v172
  v_add_f32 v177, v177, v173
  v_cvt_pk_bf16_f32 v174, v176, v177
  v_lshlrev_b32 v176, 16, v174
  v_and_b32 v177, 0xffff0000, v174
  v_mul_f32 v172, s100, v163
  v_mul_f32 v173, s100, v164
  v_cvt_pk_bf16_f32 v174, v172, v173
  v_lshlrev_b32 v172, 16, v174
  v_and_b32 v173, 0xffff0000, v174
  v_add_f32 v176, v176, v172
  v_add_f32 v177, v177, v173
  v_cvt_pk_bf16_f32 v174, v176, v177
  v_lshlrev_b32 v176, 16, v174
  v_and_b32 v177, 0xffff0000, v174
  v_lshlrev_b32 v172, 16, v63
  v_mul_f32 v172, v172, v176
  v_lshlrev_b32 v173, 16, v67
  v_mul_f32 v173, v173, v177
  v_cvt_pk_bf16_f32 v119, v173, v172
  v_mul_f32 v172, s69, v162
  v_mul_f32 v173, s69, v163
  v_cvt_pk_bf16_f32 v174, v172, v173
  v_lshlrev_b32 v176, 16, v174
  v_and_b32 v177, 0xffff0000, v174
  v_mul_f32 v172, s68, v163
  v_mul_f32 v173, s68, v164
  v_cvt_pk_bf16_f32 v174, v172, v173
  v_lshlrev_b32 v172, 16, v174
  v_and_b32 v173, 0xffff0000, v174
  v_add_f32 v176, v176, v172
  v_add_f32 v177, v177, v173
  v_cvt_pk_bf16_f32 v174, v176, v177
  v_lshlrev_b32 v176, 16, v174
  v_and_b32 v177, 0xffff0000, v174
  v_mul_f32 v172, s101, v164
  v_mul_f32 v173, s101, v165
  v_cvt_pk_bf16_f32 v174, v172, v173
  v_lshlrev_b32 v172, 16, v174
  v_and_b32 v173, 0xffff0000, v174
  v_add_f32 v176, v176, v172
  v_add_f32 v177, v177, v173
  v_cvt_pk_bf16_f32 v174, v176, v177
  v_lshlrev_b32 v176, 16, v174
  v_and_b32 v177, 0xffff0000, v174
  v_mul_f32 v172, s100, v165
  v_mul_f32 v173, s100, v166
  v_cvt_pk_bf16_f32 v174, v172, v173
  v_lshlrev_b32 v172, 16, v174
  v_and_b32 v173, 0xffff0000, v174
  v_add_f32 v176, v176, v172
  v_add_f32 v177, v177, v173
  v_cvt_pk_bf16_f32 v174, v176, v177
  v_lshlrev_b32 v176, 16, v174
  v_and_b32 v177, 0xffff0000, v174
  v_lshlrev_b32 v172, 16, v71
  v_mul_f32 v172, v172, v176
  v_lshlrev_b32 v173, 16, v75
  v_mul_f32 v173, v173, v177
  v_cvt_pk_bf16_f32 v118, v173, v172
  v_mul_f32 v172, s69, v164
  v_mul_f32 v173, s69, v165
  v_cvt_pk_bf16_f32 v174, v172, v173
  v_lshlrev_b32 v176, 16, v174
  v_and_b32 v177, 0xffff0000, v174
  v_mul_f32 v172, s68, v165
  v_mul_f32 v173, s68, v166
  v_cvt_pk_bf16_f32 v174, v172, v173
  v_lshlrev_b32 v172, 16, v174
  v_and_b32 v173, 0xffff0000, v174
  v_add_f32 v176, v176, v172
  v_add_f32 v177, v177, v173
  v_cvt_pk_bf16_f32 v174, v176, v177
  v_lshlrev_b32 v176, 16, v174
  v_and_b32 v177, 0xffff0000, v174
  v_mul_f32 v172, s101, v166
  v_mul_f32 v173, s101, v167
  v_cvt_pk_bf16_f32 v174, v172, v173
  v_lshlrev_b32 v172, 16, v174
  v_and_b32 v173, 0xffff0000, v174
  v_add_f32 v176, v176, v172
  v_add_f32 v177, v177, v173
  v_cvt_pk_bf16_f32 v174, v176, v177
  v_lshlrev_b32 v176, 16, v174
  v_and_b32 v177, 0xffff0000, v174
  v_mul_f32 v172, s100, v167
  v_mul_f32 v173, s100, v168
  v_cvt_pk_bf16_f32 v174, v172, v173
  v_lshlrev_b32 v172, 16, v174
  v_and_b32 v173, 0xffff0000, v174
  v_add_f32 v176, v176, v172
  v_add_f32 v177, v177, v173
  v_cvt_pk_bf16_f32 v174, v176, v177
  v_lshlrev_b32 v176, 16, v174
  v_and_b32 v177, 0xffff0000, v174
  v_lshlrev_b32 v172, 16, v79
  v_mul_f32 v172, v172, v176
  v_lshlrev_b32 v173, 16, v83
  v_mul_f32 v173, v173, v177
  v_cvt_pk_bf16_f32 v117, v173, v172
  v_mul_f32 v172, s69, v166
  v_mul_f32 v173, s69, v167
  v_cvt_pk_bf16_f32 v174, v172, v173
  v_lshlrev_b32 v176, 16, v174
  v_and_b32 v177, 0xffff0000, v174
  v_mul_f32 v172, s68, v167
  v_mul_f32 v173, s68, v168
  v_cvt_pk_bf16_f32 v174, v172, v173
  v_lshlrev_b32 v172, 16, v174
  v_and_b32 v173, 0xffff0000, v174
  v_add_f32 v176, v176, v172
  v_add_f32 v177, v177, v173
  v_cvt_pk_bf16_f32 v174, v176, v177
  v_lshlrev_b32 v176, 16, v174
  v_and_b32 v177, 0xffff0000, v174
  v_mul_f32 v172, s101, v168
  v_mul_f32 v173, s101, v169
  v_cvt_pk_bf16_f32 v174, v172, v173
  v_lshlrev_b32 v172, 16, v174
  v_and_b32 v173, 0xffff0000, v174
  v_add_f32 v176, v176, v172
  v_add_f32 v177, v177, v173
  v_cvt_pk_bf16_f32 v174, v176, v177
  v_lshlrev_b32 v176, 16, v174
  v_and_b32 v177, 0xffff0000, v174
  v_mul_f32 v172, s100, v169
  v_mul_f32 v173, s100, v170
  v_cvt_pk_bf16_f32 v174, v172, v173
  v_lshlrev_b32 v172, 16, v174
  v_and_b32 v173, 0xffff0000, v174
  v_add_f32 v176, v176, v172
  v_add_f32 v177, v177, v173
  v_cvt_pk_bf16_f32 v174, v176, v177
  v_lshlrev_b32 v176, 16, v174
  v_and_b32 v177, 0xffff0000, v174
  v_lshlrev_b32 v172, 16, v87
  v_mul_f32 v172, v172, v176
  v_lshlrev_b32 v173, 16, v91
  v_mul_f32 v173, v173, v177
  v_cvt_pk_bf16_f32 v116, v173, v172
  ds_write_b128 v9, v[116:119] offset:27648
  v_and_b32 v160, 0xffff0000, v19
  v_and_b32 v161, 0xffff0000, v23
  v_and_b32 v162, 0xffff0000, v27
  v_and_b32 v163, 0xffff0000, v31
  v_and_b32 v164, 0xffff0000, v35
  v_and_b32 v165, 0xffff0000, v39
  v_and_b32 v166, 0xffff0000, v43
  v_and_b32 v167, 0xffff0000, v47
  v_and_b32 v168, 0xffff0000, v51
  v_and_b32 v169, 0xffff0000, v55
  v_and_b32 v170, 0xffff0000, v59
  s_lshl_b32 s100, s94, 16
  s_and_b32 s101, s94, 0xffff0000
  s_lshl_b32 s68, s95, 16
  s_and_b32 s69, s95, 0xffff0000
  v_mul_f32 v172, s69, v160
  v_mul_f32 v173, s69, v161
  v_cvt_pk_bf16_f32 v174, v172, v173
  v_lshlrev_b32 v176, 16, v174
  v_and_b32 v177, 0xffff0000, v174
  v_mul_f32 v172, s68, v161
  v_mul_f32 v173, s68, v162
  v_cvt_pk_bf16_f32 v174, v172, v173
  v_lshlrev_b32 v172, 16, v174
  v_and_b32 v173, 0xffff0000, v174
  v_add_f32 v176, v176, v172
  v_add_f32 v177, v177, v173
  v_cvt_pk_bf16_f32 v174, v176, v177
  v_lshlrev_b32 v176, 16, v174
  v_and_b32 v177, 0xffff0000, v174
  v_mul_f32 v172, s101, v162
  v_mul_f32 v173, s101, v163
  v_cvt_pk_bf16_f32 v174, v172, v173
  v_lshlrev_b32 v172, 16, v174
  v_and_b32 v173, 0xffff0000, v174
  v_add_f32 v176, v176, v172
  v_add_f32 v177, v177, v173
  v_cvt_pk_bf16_f32 v174, v176, v177
  v_lshlrev_b32 v176, 16, v174
  v_and_b32 v177, 0xffff0000, v174
  v_mul_f32 v172, s100, v163
  v_mul_f32 v173, s100, v164
  v_cvt_pk_bf16_f32 v174, v172, v173
  v_lshlrev_b32 v172, 16, v174
  v_and_b32 v173, 0xffff0000, v174
  v_add_f32 v176, v176, v172
  v_add_f32 v177, v177, v173
  v_cvt_pk_bf16_f32 v174, v176, v177
  v_lshlrev_b32 v176, 16, v174
  v_and_b32 v177, 0xffff0000, v174
  v_and_b32 v172, 0xffff0000, v63
  v_mul_f32 v172, v172, v176
  v_and_b32 v173, 0xffff0000, v67
  v_mul_f32 v173, v173, v177
  v_cvt_pk_bf16_f32 v123, v173, v172
  v_mul_f32 v172, s69, v162
  v_mul_f32 v173, s69, v163
  v_cvt_pk_bf16_f32 v174, v172, v173
  v_lshlrev_b32 v176, 16, v174
  v_and_b32 v177, 0xffff0000, v174
  v_mul_f32 v172, s68, v163
  v_mul_f32 v173, s68, v164
  v_cvt_pk_bf16_f32 v174, v172, v173
  v_lshlrev_b32 v172, 16, v174
  v_and_b32 v173, 0xffff0000, v174
  v_add_f32 v176, v176, v172
  v_add_f32 v177, v177, v173
  v_cvt_pk_bf16_f32 v174, v176, v177
  v_lshlrev_b32 v176, 16, v174
  v_and_b32 v177, 0xffff0000, v174
  v_mul_f32 v172, s101, v164
  v_mul_f32 v173, s101, v165
  v_cvt_pk_bf16_f32 v174, v172, v173
  v_lshlrev_b32 v172, 16, v174
  v_and_b32 v173, 0xffff0000, v174
  v_add_f32 v176, v176, v172
  v_add_f32 v177, v177, v173
  v_cvt_pk_bf16_f32 v174, v176, v177
  v_lshlrev_b32 v176, 16, v174
  v_and_b32 v177, 0xffff0000, v174
  v_mul_f32 v172, s100, v165
  v_mul_f32 v173, s100, v166
  v_cvt_pk_bf16_f32 v174, v172, v173
  v_lshlrev_b32 v172, 16, v174
  v_and_b32 v173, 0xffff0000, v174
  v_add_f32 v176, v176, v172
  v_add_f32 v177, v177, v173
  v_cvt_pk_bf16_f32 v174, v176, v177
  v_lshlrev_b32 v176, 16, v174
  v_and_b32 v177, 0xffff0000, v174
  v_and_b32 v172, 0xffff0000, v71
  v_mul_f32 v172, v172, v176
  v_and_b32 v173, 0xffff0000, v75
  v_mul_f32 v173, v173, v177
  v_cvt_pk_bf16_f32 v122, v173, v172
  v_mul_f32 v172, s69, v164
  v_mul_f32 v173, s69, v165
  v_cvt_pk_bf16_f32 v174, v172, v173
  v_lshlrev_b32 v176, 16, v174
  v_and_b32 v177, 0xffff0000, v174
  v_mul_f32 v172, s68, v165
  v_mul_f32 v173, s68, v166
  v_cvt_pk_bf16_f32 v174, v172, v173
  v_lshlrev_b32 v172, 16, v174
  v_and_b32 v173, 0xffff0000, v174
  v_add_f32 v176, v176, v172
  v_add_f32 v177, v177, v173
  v_cvt_pk_bf16_f32 v174, v176, v177
  v_lshlrev_b32 v176, 16, v174
  v_and_b32 v177, 0xffff0000, v174
  v_mul_f32 v172, s101, v166
  v_mul_f32 v173, s101, v167
  v_cvt_pk_bf16_f32 v174, v172, v173
  v_lshlrev_b32 v172, 16, v174
  v_and_b32 v173, 0xffff0000, v174
  v_add_f32 v176, v176, v172
  v_add_f32 v177, v177, v173
  v_cvt_pk_bf16_f32 v174, v176, v177
  v_lshlrev_b32 v176, 16, v174
  v_and_b32 v177, 0xffff0000, v174
  v_mul_f32 v172, s100, v167
  v_mul_f32 v173, s100, v168
  v_cvt_pk_bf16_f32 v174, v172, v173
  v_lshlrev_b32 v172, 16, v174
  v_and_b32 v173, 0xffff0000, v174
  v_add_f32 v176, v176, v172
  v_add_f32 v177, v177, v173
  v_cvt_pk_bf16_f32 v174, v176, v177
  v_lshlrev_b32 v176, 16, v174
  v_and_b32 v177, 0xffff0000, v174
  v_and_b32 v172, 0xffff0000, v79
  v_mul_f32 v172, v172, v176
  v_and_b32 v173, 0xffff0000, v83
  v_mul_f32 v173, v173, v177
  v_cvt_pk_bf16_f32 v121, v173, v172
  v_mul_f32 v172, s69, v166
  v_mul_f32 v173, s69, v167
  v_cvt_pk_bf16_f32 v174, v172, v173
  v_lshlrev_b32 v176, 16, v174
  v_and_b32 v177, 0xffff0000, v174
  v_mul_f32 v172, s68, v167
  v_mul_f32 v173, s68, v168
  v_cvt_pk_bf16_f32 v174, v172, v173
  v_lshlrev_b32 v172, 16, v174
  v_and_b32 v173, 0xffff0000, v174
  v_add_f32 v176, v176, v172
  v_add_f32 v177, v177, v173
  v_cvt_pk_bf16_f32 v174, v176, v177
  v_lshlrev_b32 v176, 16, v174
  v_and_b32 v177, 0xffff0000, v174
  v_mul_f32 v172, s101, v168
  v_mul_f32 v173, s101, v169
  v_cvt_pk_bf16_f32 v174, v172, v173
  v_lshlrev_b32 v172, 16, v174
  v_and_b32 v173, 0xffff0000, v174
  v_add_f32 v176, v176, v172
  v_add_f32 v177, v177, v173
  v_cvt_pk_bf16_f32 v174, v176, v177
  v_lshlrev_b32 v176, 16, v174
  v_and_b32 v177, 0xffff0000, v174
  v_mul_f32 v172, s100, v169
  v_mul_f32 v173, s100, v170
  v_cvt_pk_bf16_f32 v174, v172, v173
  v_lshlrev_b32 v172, 16, v174
  v_and_b32 v173, 0xffff0000, v174
  v_add_f32 v176, v176, v172
  v_add_f32 v177, v177, v173
  v_cvt_pk_bf16_f32 v174, v176, v177
  v_lshlrev_b32 v176, 16, v174
  v_and_b32 v177, 0xffff0000, v174
  v_and_b32 v172, 0xffff0000, v87
  v_mul_f32 v172, v172, v176
  v_and_b32 v173, 0xffff0000, v91
  v_mul_f32 v173, v173, v177
  v_cvt_pk_bf16_f32 v120, v173, v172
  ds_write_b128 v9, v[120:123] offset:32256
  s_waitcnt lgkmcnt(0)
  s_barrier
  v_lshlrev_b32 v10, 3, v4
  v_sub_u32 v10, v3, v10
  v_lshlrev_b32 v10, 1, v10
  s_mul_i32 s38, s11, 8320
  s_add_u32 s38, s38, 36946
  v_add_u32 v10, s38, v10
  v_lshl_add_u32 v11, v3, 1, v4
  v_lshlrev_b32 v11, 4, v11
  s_mul_i32 s38, s11, 9216
  s_add_u32 s38, s38, 480
  v_add_u32 v11, s38, v11
  v_lshlrev_b32 v12, 5, v3
  v_lshl_add_u32 v12, v4, 3, v12
  s_lshl_b32 s38, s11, 13
  s_add_u32 s38, s38, 70144
  v_add_u32 v12, s38, v12
  s_mov_b32 s38, 0
Cch:
  v_mov_b32 v160, 0
  v_mov_b32 v161, 0
  v_mov_b32 v162, 0
  v_mov_b32 v163, 0
  v_mov_b32 v164, 0
  v_mov_b32 v165, 0
  v_mov_b32 v166, 0
  v_mov_b32 v167, 0
  v_mov_b32 v168, 0
  v_mov_b32 v169, 0
  v_mov_b32 v170, 0
  v_mov_b32 v171, 0
  v_mov_b32 v172, 0
  v_mov_b32 v173, 0
  v_mov_b32 v174, 0
  v_mov_b32 v175, 0
  v_mov_b32 v176, 0
  v_mov_b32 v177, 0
  v_mov_b32 v178, 0
  v_mov_b32 v179, 0
  v_mov_b32 v180, 0
  v_mov_b32 v181, 0
  v_mov_b32 v182, 0
  v_mov_b32 v183, 0
  v_mov_b32 v184, 0
  v_mov_b32 v185, 0
  v_mov_b32 v186, 0
  v_mov_b32 v187, 0
  v_mov_b32 v188, 0
  v_mov_b32 v189, 0
  v_mov_b32 v190, 0
  v_mov_b32 v191, 0
  s_mov_b32 s39, 0
Crho:
  ds_read_b128 v[48:51], v11 offset:0
  ds_read_b128 v[52:55], v11 offset:512
  ds_read_b128 v[56:59], v11 offset:1024
  ds_read_b128 v[60:63], v11 offset:1536
  ds_read_b128 v[64:67], v11 offset:2048
  ds_read_b128 v[68:71], v11 offset:2560
  ds_read_b128 v[72:75], v11 offset:3072
  ds_read_b128 v[76:79], v11 offset:3584
  s_waitcnt lgkmcnt(4)
  ds_read_b128 v[16:19], v10 offset:0
  ds_read_b128 v[20:23], v10 offset:512
  ds_read_b128 v[24:27], v10 offset:1024
  ds_read_b128 v[28:31], v10 offset:1536
  ds_read_b128 v[32:35], v10 offset:2048
  ds_read_b128 v[36:39], v10 offset:2560
  ds_read_b128 v[40:43], v10 offset:3072
  ds_read_b128 v[44:47], v10 offset:3584
  s_waitcnt lgkmcnt(7)
  v_mfma_f32_16x16x32_bf16 v[160:163], v[16:19], v[48:51], v[160:163]
  v_mfma_f32_16x16x32_bf16 v[164:167], v[16:19], v[52:55], v[164:167]
  v_mfma_f32_16x16x32_bf16 v[168:171], v[16:19], v[56:59], v[168:171]
  v_mfma_f32_16x16x32_bf16 v[172:175], v[16:19], v[60:63], v[172:175]
  v_mfma_f32_16x16x32_bf16 v[176:179], v[16:19], v[64:67], v[176:179]
  v_mfma_f32_16x16x32_bf16 v[180:183], v[16:19], v[68:71], v[180:183]
  v_mfma_f32_16x16x32_bf16 v[184:187], v[16:19], v[72:75], v[184:187]
  v_mfma_f32_16x16x32_bf16 v[188:191], v[16:19], v[76:79], v[188:191]
  s_waitcnt lgkmcnt(6)
  v_mfma_f32_16x16x32_bf16 v[164:167], v[20:23], v[48:51], v[164:167]
  v_mfma_f32_16x16x32_bf16 v[168:171], v[20:23], v[52:55], v[168:171]
  v_mfma_f32_16x16x32_bf16 v[172:175], v[20:23], v[56:59], v[172:175]
  v_mfma_f32_16x16x32_bf16 v[176:179], v[20:23], v[60:63], v[176:179]
  v_mfma_f32_16x16x32_bf16 v[180:183], v[20:23], v[64:67], v[180:183]
  v_mfma_f32_16x16x32_bf16 v[184:187], v[20:23], v[68:71], v[184:187]
  v_mfma_f32_16x16x32_bf16 v[188:191], v[20:23], v[72:75], v[188:191]
  s_waitcnt lgkmcnt(5)
  v_mfma_f32_16x16x32_bf16 v[168:171], v[24:27], v[48:51], v[168:171]
  v_mfma_f32_16x16x32_bf16 v[172:175], v[24:27], v[52:55], v[172:175]
  v_mfma_f32_16x16x32_bf16 v[176:179], v[24:27], v[56:59], v[176:179]
  v_mfma_f32_16x16x32_bf16 v[180:183], v[24:27], v[60:63], v[180:183]
  v_mfma_f32_16x16x32_bf16 v[184:187], v[24:27], v[64:67], v[184:187]
  v_mfma_f32_16x16x32_bf16 v[188:191], v[24:27], v[68:71], v[188:191]
  s_waitcnt lgkmcnt(4)
  v_mfma_f32_16x16x32_bf16 v[172:175], v[28:31], v[48:51], v[172:175]
  v_mfma_f32_16x16x32_bf16 v[176:179], v[28:31], v[52:55], v[176:179]
  v_mfma_f32_16x16x32_bf16 v[180:183], v[28:31], v[56:59], v[180:183]
  v_mfma_f32_16x16x32_bf16 v[184:187], v[28:31], v[60:63], v[184:187]
  v_mfma_f32_16x16x32_bf16 v[188:191], v[28:31], v[64:67], v[188:191]
  s_waitcnt lgkmcnt(3)
  v_mfma_f32_16x16x32_bf16 v[176:179], v[32:35], v[48:51], v[176:179]
  v_mfma_f32_16x16x32_bf16 v[180:183], v[32:35], v[52:55], v[180:183]
  v_mfma_f32_16x16x32_bf16 v[184:187], v[32:35], v[56:59], v[184:187]
  v_mfma_f32_16x16x32_bf16 v[188:191], v[32:35], v[60:63], v[188:191]
  s_waitcnt lgkmcnt(2)
  v_mfma_f32_16x16x32_bf16 v[180:183], v[36:39], v[48:51], v[180:183]
  v_mfma_f32_16x16x32_bf16 v[184:187], v[36:39], v[52:55], v[184:187]
  v_mfma_f32_16x16x32_bf16 v[188:191], v[36:39], v[56:59], v[188:191]
  s_waitcnt lgkmcnt(1)
  v_mfma_f32_16x16x32_bf16 v[184:187], v[40:43], v[48:51], v[184:187]
  v_mfma_f32_16x16x32_bf16 v[188:191], v[40:43], v[52:55], v[188:191]
  s_waitcnt lgkmcnt(0)
  v_mfma_f32_16x16x32_bf16 v[188:191], v[44:47], v[48:51], v[188:191]
  v_add_u32 v10, 64, v10
  v_subrev_u32 v11, 64, v11
  s_add_u32 s39, s39, 1
  s_cmp_lt_u32 s39, 8
  s_cbranch_scc1 Crho
  s_nop 4
  v_cvt_pk_bf16_f32 v16, v160, v161
  v_cvt_pk_bf16_f32 v17, v162, v163
  ds_write_b64 v12, v[16:17] offset:0
  v_cvt_pk_bf16_f32 v18, v164, v165
  v_cvt_pk_bf16_f32 v19, v166, v167
  ds_write_b64 v12, v[18:19] offset:512
  v_cvt_pk_bf16_f32 v20, v168, v169
  v_cvt_pk_bf16_f32 v21, v170, v171
  ds_write_b64 v12, v[20:21] offset:1024
  v_cvt_pk_bf16_f32 v22, v172, v173
  v_cvt_pk_bf16_f32 v23, v174, v175
  ds_write_b64 v12, v[22:23] offset:1536
  v_cvt_pk_bf16_f32 v24, v176, v177
  v_cvt_pk_bf16_f32 v25, v178, v179
  ds_write_b64 v12, v[24:25] offset:2048
  v_cvt_pk_bf16_f32 v26, v180, v181
  v_cvt_pk_bf16_f32 v27, v182, v183
  ds_write_b64 v12, v[26:27] offset:2560
  v_cvt_pk_bf16_f32 v28, v184, v185
  v_cvt_pk_bf16_f32 v29, v186, v187
  ds_write_b64 v12, v[28:29] offset:3072
  v_cvt_pk_bf16_f32 v30, v188, v189
  v_cvt_pk_bf16_f32 v31, v190, v191
  ds_write_b64 v12, v[30:31] offset:3584
  v_add_u32 v10, 3648, v10
  v_add_u32 v11, 5120, v11
  v_add_u32 v12, 4096, v12
  s_waitcnt lgkmcnt(0)
  s_add_u32 s38, s38, 1
  s_cmp_lt_u32 s38, 2
  s_cbranch_scc1 Cch
  s_barrier
  v_lshlrev_b32 v9, 4, v0
  v_add_u32 v9, 70144, v9
  ds_read_b128 v[16:19], v9 offset:0
  ds_read_b128 v[20:23], v9 offset:4096
  ds_read_b128 v[24:27], v9 offset:8192
  ds_read_b128 v[28:31], v9 offset:12288
  ds_read_b128 v[32:35], v9 offset:16384
  ds_read_b128 v[36:39], v9 offset:20480
  ds_read_b128 v[40:43], v9 offset:24576
  ds_read_b128 v[44:47], v9 offset:28672
  s_waitcnt lgkmcnt(0) vmcnt(0)
  s_lshl_b32 s100, s96, 16
  s_and_b32 s101, s96, 0xffff0000
  v_and_b32 v172, 0xffff0000, v95
  v_mul_f32 v172, s100, v172
  v_and_b32 v173, 0xffff0000, v99
  v_mul_f32 v173, s101, v173
  v_cvt_pk_bf16_f32 v174, v172, v173
  v_lshlrev_b32 v172, 16, v174
  v_and_b32 v173, 0xffff0000, v174
  v_lshlrev_b32 v176, 16, v16
  v_add_f32 v172, v172, v176
  v_lshlrev_b32 v177, 16, v20
  v_add_f32 v173, v173, v177
  v_cvt_pk_bf16_f32 v174, v172, v173
  v_lshlrev_b32 v172, 16, v174
  v_and_b32 v173, 0xffff0000, v174
  v_lshlrev_b32 v176, 16, v128
  v_and_b32 v177, 0xffff0000, v128
  v_mul_f32 v172, v172, v176
  v_mul_f32 v173, v173, v177
  v_cvt_pk_bf16_f32 v48, v172, v173
  v_lshlrev_b32 v172, 16, v95
  v_mul_f32 v172, s100, v172
  v_lshlrev_b32 v173, 16, v99
  v_mul_f32 v173, s101, v173
  v_cvt_pk_bf16_f32 v174, v172, v173
  v_lshlrev_b32 v172, 16, v174
  v_and_b32 v173, 0xffff0000, v174
  v_and_b32 v176, 0xffff0000, v16
  v_add_f32 v172, v172, v176
  v_and_b32 v177, 0xffff0000, v20
  v_add_f32 v173, v173, v177
  v_cvt_pk_bf16_f32 v174, v172, v173
  v_lshlrev_b32 v172, 16, v174
  v_and_b32 v173, 0xffff0000, v174
  v_lshlrev_b32 v176, 16, v132
  v_and_b32 v177, 0xffff0000, v132
  v_mul_f32 v172, v172, v176
  v_mul_f32 v173, v173, v177
  v_cvt_pk_bf16_f32 v52, v172, v173
  v_and_b32 v172, 0xffff0000, v94
  v_mul_f32 v172, s100, v172
  v_and_b32 v173, 0xffff0000, v98
  v_mul_f32 v173, s101, v173
  v_cvt_pk_bf16_f32 v174, v172, v173
  v_lshlrev_b32 v172, 16, v174
  v_and_b32 v173, 0xffff0000, v174
  v_lshlrev_b32 v176, 16, v17
  v_add_f32 v172, v172, v176
  v_lshlrev_b32 v177, 16, v21
  v_add_f32 v173, v173, v177
  v_cvt_pk_bf16_f32 v174, v172, v173
  v_lshlrev_b32 v172, 16, v174
  v_and_b32 v173, 0xffff0000, v174
  v_lshlrev_b32 v176, 16, v136
  v_and_b32 v177, 0xffff0000, v136
  v_mul_f32 v172, v172, v176
  v_mul_f32 v173, v173, v177
  v_cvt_pk_bf16_f32 v56, v172, v173
  v_lshlrev_b32 v172, 16, v94
  v_mul_f32 v172, s100, v172
  v_lshlrev_b32 v173, 16, v98
  v_mul_f32 v173, s101, v173
  v_cvt_pk_bf16_f32 v174, v172, v173
  v_lshlrev_b32 v172, 16, v174
  v_and_b32 v173, 0xffff0000, v174
  v_and_b32 v176, 0xffff0000, v17
  v_add_f32 v172, v172, v176
  v_and_b32 v177, 0xffff0000, v21
  v_add_f32 v173, v173, v177
  v_cvt_pk_bf16_f32 v174, v172, v173
  v_lshlrev_b32 v172, 16, v174
  v_and_b32 v173, 0xffff0000, v174
  v_lshlrev_b32 v176, 16, v140
  v_and_b32 v177, 0xffff0000, v140
  v_mul_f32 v172, v172, v176
  v_mul_f32 v173, v173, v177
  v_cvt_pk_bf16_f32 v60, v172, v173
  v_and_b32 v172, 0xffff0000, v93
  v_mul_f32 v172, s100, v172
  v_and_b32 v173, 0xffff0000, v97
  v_mul_f32 v173, s101, v173
  v_cvt_pk_bf16_f32 v174, v172, v173
  v_lshlrev_b32 v172, 16, v174
  v_and_b32 v173, 0xffff0000, v174
  v_lshlrev_b32 v176, 16, v18
  v_add_f32 v172, v172, v176
  v_lshlrev_b32 v177, 16, v22
  v_add_f32 v173, v173, v177
  v_cvt_pk_bf16_f32 v174, v172, v173
  v_lshlrev_b32 v172, 16, v174
  v_and_b32 v173, 0xffff0000, v174
  v_lshlrev_b32 v176, 16, v144
  v_and_b32 v177, 0xffff0000, v144
  v_mul_f32 v172, v172, v176
  v_mul_f32 v173, v173, v177
  v_cvt_pk_bf16_f32 v64, v172, v173
  v_lshlrev_b32 v172, 16, v93
  v_mul_f32 v172, s100, v172
  v_lshlrev_b32 v173, 16, v97
  v_mul_f32 v173, s101, v173
  v_cvt_pk_bf16_f32 v174, v172, v173
  v_lshlrev_b32 v172, 16, v174
  v_and_b32 v173, 0xffff0000, v174
  v_and_b32 v176, 0xffff0000, v18
  v_add_f32 v172, v172, v176
  v_and_b32 v177, 0xffff0000, v22
  v_add_f32 v173, v173, v177
  v_cvt_pk_bf16_f32 v174, v172, v173
  v_lshlrev_b32 v172, 16, v174
  v_and_b32 v173, 0xffff0000, v174
  v_lshlrev_b32 v176, 16, v148
  v_and_b32 v177, 0xffff0000, v148
  v_mul_f32 v172, v172, v176
  v_mul_f32 v173, v173, v177
  v_cvt_pk_bf16_f32 v68, v172, v173
  v_and_b32 v172, 0xffff0000, v92
  v_mul_f32 v172, s100, v172
  v_and_b32 v173, 0xffff0000, v96
  v_mul_f32 v173, s101, v173
  v_cvt_pk_bf16_f32 v174, v172, v173
  v_lshlrev_b32 v172, 16, v174
  v_and_b32 v173, 0xffff0000, v174
  v_lshlrev_b32 v176, 16, v19
  v_add_f32 v172, v172, v176
  v_lshlrev_b32 v177, 16, v23
  v_add_f32 v173, v173, v177
  v_cvt_pk_bf16_f32 v174, v172, v173
  v_lshlrev_b32 v172, 16, v174
  v_and_b32 v173, 0xffff0000, v174
  v_lshlrev_b32 v176, 16, v152
  v_and_b32 v177, 0xffff0000, v152
  v_mul_f32 v172, v172, v176
  v_mul_f32 v173, v173, v177
  v_cvt_pk_bf16_f32 v72, v172, v173
  v_lshlrev_b32 v172, 16, v92
  v_mul_f32 v172, s100, v172
  v_lshlrev_b32 v173, 16, v96
  v_mul_f32 v173, s101, v173
  v_cvt_pk_bf16_f32 v174, v172, v173
  v_lshlrev_b32 v172, 16, v174
  v_and_b32 v173, 0xffff0000, v174
  v_and_b32 v176, 0xffff0000, v19
  v_add_f32 v172, v172, v176
  v_and_b32 v177, 0xffff0000, v23
  v_add_f32 v173, v173, v177
  v_cvt_pk_bf16_f32 v174, v172, v173
  v_lshlrev_b32 v172, 16, v174
  v_and_b32 v173, 0xffff0000, v174
  v_lshlrev_b32 v176, 16, v156
  v_and_b32 v177, 0xffff0000, v156
  v_mul_f32 v172, v172, v176
  v_mul_f32 v173, v173, v177
  v_cvt_pk_bf16_f32 v76, v172, v173
  s_lshl_b32 s100, s97, 16
  s_and_b32 s101, s97, 0xffff0000
  v_and_b32 v172, 0xffff0000, v103
  v_mul_f32 v172, s100, v172
  v_and_b32 v173, 0xffff0000, v107
  v_mul_f32 v173, s101, v173
  v_cvt_pk_bf16_f32 v174, v172, v173
  v_lshlrev_b32 v172, 16, v174
  v_and_b32 v173, 0xffff0000, v174
  v_lshlrev_b32 v176, 16, v24
  v_add_f32 v172, v172, v176
  v_lshlrev_b32 v177, 16, v28
  v_add_f32 v173, v173, v177
  v_cvt_pk_bf16_f32 v174, v172, v173
  v_lshlrev_b32 v172, 16, v174
  v_and_b32 v173, 0xffff0000, v174
  v_lshlrev_b32 v176, 16, v129
  v_and_b32 v177, 0xffff0000, v129
  v_mul_f32 v172, v172, v176
  v_mul_f32 v173, v173, v177
  v_cvt_pk_bf16_f32 v49, v172, v173
  v_lshlrev_b32 v172, 16, v103
  v_mul_f32 v172, s100, v172
  v_lshlrev_b32 v173, 16, v107
  v_mul_f32 v173, s101, v173
  v_cvt_pk_bf16_f32 v174, v172, v173
  v_lshlrev_b32 v172, 16, v174
  v_and_b32 v173, 0xffff0000, v174
  v_and_b32 v176, 0xffff0000, v24
  v_add_f32 v172, v172, v176
  v_and_b32 v177, 0xffff0000, v28
  v_add_f32 v173, v173, v177
  v_cvt_pk_bf16_f32 v174, v172, v173
  v_lshlrev_b32 v172, 16, v174
  v_and_b32 v173, 0xffff0000, v174
  v_lshlrev_b32 v176, 16, v133
  v_and_b32 v177, 0xffff0000, v133
  v_mul_f32 v172, v172, v176
  v_mul_f32 v173, v173, v177
  v_cvt_pk_bf16_f32 v53, v172, v173
  v_and_b32 v172, 0xffff0000, v102
  v_mul_f32 v172, s100, v172
  v_and_b32 v173, 0xffff0000, v106
  v_mul_f32 v173, s101, v173
  v_cvt_pk_bf16_f32 v174, v172, v173
  v_lshlrev_b32 v172, 16, v174
  v_and_b32 v173, 0xffff0000, v174
  v_lshlrev_b32 v176, 16, v25
  v_add_f32 v172, v172, v176
  v_lshlrev_b32 v177, 16, v29
  v_add_f32 v173, v173, v177
  v_cvt_pk_bf16_f32 v174, v172, v173
  v_lshlrev_b32 v172, 16, v174
  v_and_b32 v173, 0xffff0000, v174
  v_lshlrev_b32 v176, 16, v137
  v_and_b32 v177, 0xffff0000, v137
  v_mul_f32 v172, v172, v176
  v_mul_f32 v173, v173, v177
  v_cvt_pk_bf16_f32 v57, v172, v173
  v_lshlrev_b32 v172, 16, v102
  v_mul_f32 v172, s100, v172
  v_lshlrev_b32 v173, 16, v106
  v_mul_f32 v173, s101, v173
  v_cvt_pk_bf16_f32 v174, v172, v173
  v_lshlrev_b32 v172, 16, v174
  v_and_b32 v173, 0xffff0000, v174
  v_and_b32 v176, 0xffff0000, v25
  v_add_f32 v172, v172, v176
  v_and_b32 v177, 0xffff0000, v29
  v_add_f32 v173, v173, v177
  v_cvt_pk_bf16_f32 v174, v172, v173
  v_lshlrev_b32 v172, 16, v174
  v_and_b32 v173, 0xffff0000, v174
  v_lshlrev_b32 v176, 16, v141
  v_and_b32 v177, 0xffff0000, v141
  v_mul_f32 v172, v172, v176
  v_mul_f32 v173, v173, v177
  v_cvt_pk_bf16_f32 v61, v172, v173
  v_and_b32 v172, 0xffff0000, v101
  v_mul_f32 v172, s100, v172
  v_and_b32 v173, 0xffff0000, v105
  v_mul_f32 v173, s101, v173
  v_cvt_pk_bf16_f32 v174, v172, v173
  v_lshlrev_b32 v172, 16, v174
  v_and_b32 v173, 0xffff0000, v174
  v_lshlrev_b32 v176, 16, v26
  v_add_f32 v172, v172, v176
  v_lshlrev_b32 v177, 16, v30
  v_add_f32 v173, v173, v177
  v_cvt_pk_bf16_f32 v174, v172, v173
  v_lshlrev_b32 v172, 16, v174
  v_and_b32 v173, 0xffff0000, v174
  v_lshlrev_b32 v176, 16, v145
  v_and_b32 v177, 0xffff0000, v145
  v_mul_f32 v172, v172, v176
  v_mul_f32 v173, v173, v177
  v_cvt_pk_bf16_f32 v65, v172, v173
  v_lshlrev_b32 v172, 16, v101
  v_mul_f32 v172, s100, v172
  v_lshlrev_b32 v173, 16, v105
  v_mul_f32 v173, s101, v173
  v_cvt_pk_bf16_f32 v174, v172, v173
  v_lshlrev_b32 v172, 16, v174
  v_and_b32 v173, 0xffff0000, v174
  v_and_b32 v176, 0xffff0000, v26
  v_add_f32 v172, v172, v176
  v_and_b32 v177, 0xffff0000, v30
  v_add_f32 v173, v173, v177
  v_cvt_pk_bf16_f32 v174, v172, v173
  v_lshlrev_b32 v172, 16, v174
  v_and_b32 v173, 0xffff0000, v174
  v_lshlrev_b32 v176, 16, v149
  v_and_b32 v177, 0xffff0000, v149
  v_mul_f32 v172, v172, v176
  v_mul_f32 v173, v173, v177
  v_cvt_pk_bf16_f32 v69, v172, v173
  v_and_b32 v172, 0xffff0000, v100
  v_mul_f32 v172, s100, v172
  v_and_b32 v173, 0xffff0000, v104
  v_mul_f32 v173, s101, v173
  v_cvt_pk_bf16_f32 v174, v172, v173
  v_lshlrev_b32 v172, 16, v174
  v_and_b32 v173, 0xffff0000, v174
  v_lshlrev_b32 v176, 16, v27
  v_add_f32 v172, v172, v176
  v_lshlrev_b32 v177, 16, v31
  v_add_f32 v173, v173, v177
  v_cvt_pk_bf16_f32 v174, v172, v173
  v_lshlrev_b32 v172, 16, v174
  v_and_b32 v173, 0xffff0000, v174
  v_lshlrev_b32 v176, 16, v153
  v_and_b32 v177, 0xffff0000, v153
  v_mul_f32 v172, v172, v176
  v_mul_f32 v173, v173, v177
  v_cvt_pk_bf16_f32 v73, v172, v173
  v_lshlrev_b32 v172, 16, v100
  v_mul_f32 v172, s100, v172
  v_lshlrev_b32 v173, 16, v104
  v_mul_f32 v173, s101, v173
  v_cvt_pk_bf16_f32 v174, v172, v173
  v_lshlrev_b32 v172, 16, v174
  v_and_b32 v173, 0xffff0000, v174
  v_and_b32 v176, 0xffff0000, v27
  v_add_f32 v172, v172, v176
  v_and_b32 v177, 0xffff0000, v31
  v_add_f32 v173, v173, v177
  v_cvt_pk_bf16_f32 v174, v172, v173
  v_lshlrev_b32 v172, 16, v174
  v_and_b32 v173, 0xffff0000, v174
  v_lshlrev_b32 v176, 16, v157
  v_and_b32 v177, 0xffff0000, v157
  v_mul_f32 v172, v172, v176
  v_mul_f32 v173, v173, v177
  v_cvt_pk_bf16_f32 v77, v172, v173
  s_lshl_b32 s100, s98, 16
  s_and_b32 s101, s98, 0xffff0000
  v_and_b32 v172, 0xffff0000, v111
  v_mul_f32 v172, s100, v172
  v_and_b32 v173, 0xffff0000, v115
  v_mul_f32 v173, s101, v173
  v_cvt_pk_bf16_f32 v174, v172, v173
  v_lshlrev_b32 v172, 16, v174
  v_and_b32 v173, 0xffff0000, v174
  v_lshlrev_b32 v176, 16, v32
  v_add_f32 v172, v172, v176
  v_lshlrev_b32 v177, 16, v36
  v_add_f32 v173, v173, v177
  v_cvt_pk_bf16_f32 v174, v172, v173
  v_lshlrev_b32 v172, 16, v174
  v_and_b32 v173, 0xffff0000, v174
  v_lshlrev_b32 v176, 16, v130
  v_and_b32 v177, 0xffff0000, v130
  v_mul_f32 v172, v172, v176
  v_mul_f32 v173, v173, v177
  v_cvt_pk_bf16_f32 v50, v172, v173
  v_lshlrev_b32 v172, 16, v111
  v_mul_f32 v172, s100, v172
  v_lshlrev_b32 v173, 16, v115
  v_mul_f32 v173, s101, v173
  v_cvt_pk_bf16_f32 v174, v172, v173
  v_lshlrev_b32 v172, 16, v174
  v_and_b32 v173, 0xffff0000, v174
  v_and_b32 v176, 0xffff0000, v32
  v_add_f32 v172, v172, v176
  v_and_b32 v177, 0xffff0000, v36
  v_add_f32 v173, v173, v177
  v_cvt_pk_bf16_f32 v174, v172, v173
  v_lshlrev_b32 v172, 16, v174
  v_and_b32 v173, 0xffff0000, v174
  v_lshlrev_b32 v176, 16, v134
  v_and_b32 v177, 0xffff0000, v134
  v_mul_f32 v172, v172, v176
  v_mul_f32 v173, v173, v177
  v_cvt_pk_bf16_f32 v54, v172, v173
  v_and_b32 v172, 0xffff0000, v110
  v_mul_f32 v172, s100, v172
  v_and_b32 v173, 0xffff0000, v114
  v_mul_f32 v173, s101, v173
  v_cvt_pk_bf16_f32 v174, v172, v173
  v_lshlrev_b32 v172, 16, v174
  v_and_b32 v173, 0xffff0000, v174
  v_lshlrev_b32 v176, 16, v33
  v_add_f32 v172, v172, v176
  v_lshlrev_b32 v177, 16, v37
  v_add_f32 v173, v173, v177
  v_cvt_pk_bf16_f32 v174, v172, v173
  v_lshlrev_b32 v172, 16, v174
  v_and_b32 v173, 0xffff0000, v174
  v_lshlrev_b32 v176, 16, v138
  v_and_b32 v177, 0xffff0000, v138
  v_mul_f32 v172, v172, v176
  v_mul_f32 v173, v173, v177
  v_cvt_pk_bf16_f32 v58, v172, v173
  v_lshlrev_b32 v172, 16, v110
  v_mul_f32 v172, s100, v172
  v_lshlrev_b32 v173, 16, v114
  v_mul_f32 v173, s101, v173
  v_cvt_pk_bf16_f32 v174, v172, v173
  v_lshlrev_b32 v172, 16, v174
  v_and_b32 v173, 0xffff0000, v174
  v_and_b32 v176, 0xffff0000, v33
  v_add_f32 v172, v172, v176
  v_and_b32 v177, 0xffff0000, v37
  v_add_f32 v173, v173, v177
  v_cvt_pk_bf16_f32 v174, v172, v173
  v_lshlrev_b32 v172, 16, v174
  v_and_b32 v173, 0xffff0000, v174
  v_lshlrev_b32 v176, 16, v142
  v_and_b32 v177, 0xffff0000, v142
  v_mul_f32 v172, v172, v176
  v_mul_f32 v173, v173, v177
  v_cvt_pk_bf16_f32 v62, v172, v173
  v_and_b32 v172, 0xffff0000, v109
  v_mul_f32 v172, s100, v172
  v_and_b32 v173, 0xffff0000, v113
  v_mul_f32 v173, s101, v173
  v_cvt_pk_bf16_f32 v174, v172, v173
  v_lshlrev_b32 v172, 16, v174
  v_and_b32 v173, 0xffff0000, v174
  v_lshlrev_b32 v176, 16, v34
  v_add_f32 v172, v172, v176
  v_lshlrev_b32 v177, 16, v38
  v_add_f32 v173, v173, v177
  v_cvt_pk_bf16_f32 v174, v172, v173
  v_lshlrev_b32 v172, 16, v174
  v_and_b32 v173, 0xffff0000, v174
  v_lshlrev_b32 v176, 16, v146
  v_and_b32 v177, 0xffff0000, v146
  v_mul_f32 v172, v172, v176
  v_mul_f32 v173, v173, v177
  v_cvt_pk_bf16_f32 v66, v172, v173
  v_lshlrev_b32 v172, 16, v109
  v_mul_f32 v172, s100, v172
  v_lshlrev_b32 v173, 16, v113
  v_mul_f32 v173, s101, v173
  v_cvt_pk_bf16_f32 v174, v172, v173
  v_lshlrev_b32 v172, 16, v174
  v_and_b32 v173, 0xffff0000, v174
  v_and_b32 v176, 0xffff0000, v34
  v_add_f32 v172, v172, v176
  v_and_b32 v177, 0xffff0000, v38
  v_add_f32 v173, v173, v177
  v_cvt_pk_bf16_f32 v174, v172, v173
  v_lshlrev_b32 v172, 16, v174
  v_and_b32 v173, 0xffff0000, v174
  v_lshlrev_b32 v176, 16, v150
  v_and_b32 v177, 0xffff0000, v150
  v_mul_f32 v172, v172, v176
  v_mul_f32 v173, v173, v177
  v_cvt_pk_bf16_f32 v70, v172, v173
  v_and_b32 v172, 0xffff0000, v108
  v_mul_f32 v172, s100, v172
  v_and_b32 v173, 0xffff0000, v112
  v_mul_f32 v173, s101, v173
  v_cvt_pk_bf16_f32 v174, v172, v173
  v_lshlrev_b32 v172, 16, v174
  v_and_b32 v173, 0xffff0000, v174
  v_lshlrev_b32 v176, 16, v35
  v_add_f32 v172, v172, v176
  v_lshlrev_b32 v177, 16, v39
  v_add_f32 v173, v173, v177
  v_cvt_pk_bf16_f32 v174, v172, v173
  v_lshlrev_b32 v172, 16, v174
  v_and_b32 v173, 0xffff0000, v174
  v_lshlrev_b32 v176, 16, v154
  v_and_b32 v177, 0xffff0000, v154
  v_mul_f32 v172, v172, v176
  v_mul_f32 v173, v173, v177
  v_cvt_pk_bf16_f32 v74, v172, v173
  v_lshlrev_b32 v172, 16, v108
  v_mul_f32 v172, s100, v172
  v_lshlrev_b32 v173, 16, v112
  v_mul_f32 v173, s101, v173
  v_cvt_pk_bf16_f32 v174, v172, v173
  v_lshlrev_b32 v172, 16, v174
  v_and_b32 v173, 0xffff0000, v174
  v_and_b32 v176, 0xffff0000, v35
  v_add_f32 v172, v172, v176
  v_and_b32 v177, 0xffff0000, v39
  v_add_f32 v173, v173, v177
  v_cvt_pk_bf16_f32 v174, v172, v173
  v_lshlrev_b32 v172, 16, v174
  v_and_b32 v173, 0xffff0000, v174
  v_lshlrev_b32 v176, 16, v158
  v_and_b32 v177, 0xffff0000, v158
  v_mul_f32 v172, v172, v176
  v_mul_f32 v173, v173, v177
  v_cvt_pk_bf16_f32 v78, v172, v173
  s_lshl_b32 s100, s99, 16
  s_and_b32 s101, s99, 0xffff0000
  v_and_b32 v172, 0xffff0000, v119
  v_mul_f32 v172, s100, v172
  v_and_b32 v173, 0xffff0000, v123
  v_mul_f32 v173, s101, v173
  v_cvt_pk_bf16_f32 v174, v172, v173
  v_lshlrev_b32 v172, 16, v174
  v_and_b32 v173, 0xffff0000, v174
  v_lshlrev_b32 v176, 16, v40
  v_add_f32 v172, v172, v176
  v_lshlrev_b32 v177, 16, v44
  v_add_f32 v173, v173, v177
  v_cvt_pk_bf16_f32 v174, v172, v173
  v_lshlrev_b32 v172, 16, v174
  v_and_b32 v173, 0xffff0000, v174
  v_lshlrev_b32 v176, 16, v131
  v_and_b32 v177, 0xffff0000, v131
  v_mul_f32 v172, v172, v176
  v_mul_f32 v173, v173, v177
  v_cvt_pk_bf16_f32 v51, v172, v173
  v_lshlrev_b32 v172, 16, v119
  v_mul_f32 v172, s100, v172
  v_lshlrev_b32 v173, 16, v123
  v_mul_f32 v173, s101, v173
  v_cvt_pk_bf16_f32 v174, v172, v173
  v_lshlrev_b32 v172, 16, v174
  v_and_b32 v173, 0xffff0000, v174
  v_and_b32 v176, 0xffff0000, v40
  v_add_f32 v172, v172, v176
  v_and_b32 v177, 0xffff0000, v44
  v_add_f32 v173, v173, v177
  v_cvt_pk_bf16_f32 v174, v172, v173
  v_lshlrev_b32 v172, 16, v174
  v_and_b32 v173, 0xffff0000, v174
  v_lshlrev_b32 v176, 16, v135
  v_and_b32 v177, 0xffff0000, v135
  v_mul_f32 v172, v172, v176
  v_mul_f32 v173, v173, v177
  v_cvt_pk_bf16_f32 v55, v172, v173
  v_and_b32 v172, 0xffff0000, v118
  v_mul_f32 v172, s100, v172
  v_and_b32 v173, 0xffff0000, v122
  v_mul_f32 v173, s101, v173
  v_cvt_pk_bf16_f32 v174, v172, v173
  v_lshlrev_b32 v172, 16, v174
  v_and_b32 v173, 0xffff0000, v174
  v_lshlrev_b32 v176, 16, v41
  v_add_f32 v172, v172, v176
  v_lshlrev_b32 v177, 16, v45
  v_add_f32 v173, v173, v177
  v_cvt_pk_bf16_f32 v174, v172, v173
  v_lshlrev_b32 v172, 16, v174
  v_and_b32 v173, 0xffff0000, v174
  v_lshlrev_b32 v176, 16, v139
  v_and_b32 v177, 0xffff0000, v139
  v_mul_f32 v172, v172, v176
  v_mul_f32 v173, v173, v177
  v_cvt_pk_bf16_f32 v59, v172, v173
  v_lshlrev_b32 v172, 16, v118
  v_mul_f32 v172, s100, v172
  v_lshlrev_b32 v173, 16, v122
  v_mul_f32 v173, s101, v173
  v_cvt_pk_bf16_f32 v174, v172, v173
  v_lshlrev_b32 v172, 16, v174
  v_and_b32 v173, 0xffff0000, v174
  v_and_b32 v176, 0xffff0000, v41
  v_add_f32 v172, v172, v176
  v_and_b32 v177, 0xffff0000, v45
  v_add_f32 v173, v173, v177
  v_cvt_pk_bf16_f32 v174, v172, v173
  v_lshlrev_b32 v172, 16, v174
  v_and_b32 v173, 0xffff0000, v174
  v_lshlrev_b32 v176, 16, v143
  v_and_b32 v177, 0xffff0000, v143
  v_mul_f32 v172, v172, v176
  v_mul_f32 v173, v173, v177
  v_cvt_pk_bf16_f32 v63, v172, v173
  v_and_b32 v172, 0xffff0000, v117
  v_mul_f32 v172, s100, v172
  v_and_b32 v173, 0xffff0000, v121
  v_mul_f32 v173, s101, v173
  v_cvt_pk_bf16_f32 v174, v172, v173
  v_lshlrev_b32 v172, 16, v174
  v_and_b32 v173, 0xffff0000, v174
  v_lshlrev_b32 v176, 16, v42
  v_add_f32 v172, v172, v176
  v_lshlrev_b32 v177, 16, v46
  v_add_f32 v173, v173, v177
  v_cvt_pk_bf16_f32 v174, v172, v173
  v_lshlrev_b32 v172, 16, v174
  v_and_b32 v173, 0xffff0000, v174
  v_lshlrev_b32 v176, 16, v147
  v_and_b32 v177, 0xffff0000, v147
  v_mul_f32 v172, v172, v176
  v_mul_f32 v173, v173, v177
  v_cvt_pk_bf16_f32 v67, v172, v173
  v_lshlrev_b32 v172, 16, v117
  v_mul_f32 v172, s100, v172
  v_lshlrev_b32 v173, 16, v121
  v_mul_f32 v173, s101, v173
  v_cvt_pk_bf16_f32 v174, v172, v173
  v_lshlrev_b32 v172, 16, v174
  v_and_b32 v173, 0xffff0000, v174
  v_and_b32 v176, 0xffff0000, v42
  v_add_f32 v172, v172, v176
  v_and_b32 v177, 0xffff0000, v46
  v_add_f32 v173, v173, v177
  v_cvt_pk_bf16_f32 v174, v172, v173
  v_lshlrev_b32 v172, 16, v174
  v_and_b32 v173, 0xffff0000, v174
  v_lshlrev_b32 v176, 16, v151
  v_and_b32 v177, 0xffff0000, v151
  v_mul_f32 v172, v172, v176
  v_mul_f32 v173, v173, v177
  v_cvt_pk_bf16_f32 v71, v172, v173
  v_and_b32 v172, 0xffff0000, v116
  v_mul_f32 v172, s100, v172
  v_and_b32 v173, 0xffff0000, v120
  v_mul_f32 v173, s101, v173
  v_cvt_pk_bf16_f32 v174, v172, v173
  v_lshlrev_b32 v172, 16, v174
  v_and_b32 v173, 0xffff0000, v174
  v_lshlrev_b32 v176, 16, v43
  v_add_f32 v172, v172, v176
  v_lshlrev_b32 v177, 16, v47
  v_add_f32 v173, v173, v177
  v_cvt_pk_bf16_f32 v174, v172, v173
  v_lshlrev_b32 v172, 16, v174
  v_and_b32 v173, 0xffff0000, v174
  v_lshlrev_b32 v176, 16, v155
  v_and_b32 v177, 0xffff0000, v155
  v_mul_f32 v172, v172, v176
  v_mul_f32 v173, v173, v177
  v_cvt_pk_bf16_f32 v75, v172, v173
  v_lshlrev_b32 v172, 16, v116
  v_mul_f32 v172, s100, v172
  v_lshlrev_b32 v173, 16, v120
  v_mul_f32 v173, s101, v173
  v_cvt_pk_bf16_f32 v174, v172, v173
  v_lshlrev_b32 v172, 16, v174
  v_and_b32 v173, 0xffff0000, v174
  v_and_b32 v176, 0xffff0000, v43
  v_add_f32 v172, v172, v176
  v_and_b32 v177, 0xffff0000, v47
  v_add_f32 v173, v173, v177
  v_cvt_pk_bf16_f32 v174, v172, v173
  v_lshlrev_b32 v172, 16, v174
  v_and_b32 v173, 0xffff0000, v174
  v_lshlrev_b32 v176, 16, v159
  v_and_b32 v177, 0xffff0000, v159
  v_mul_f32 v172, v172, v176
  v_mul_f32 v173, v173, v177
  v_cvt_pk_bf16_f32 v79, v172, v173
  s_lshl_b32 s38, s12, 17
  s_lshl_b32 s39, s13, 15
  s_add_u32 s38, s38, s39
  s_add_u32 s38, s38, 67108864
  v_lshlrev_b32 v9, 4, v0
  buffer_store_dwordx4 v[48:51], v9, s[4:7], s38 offen sc1
  s_add_u32 s38, s38, 4096
  buffer_store_dwordx4 v[52:55], v9, s[4:7], s38 offen sc1
  s_add_u32 s38, s38, 4096
  buffer_store_dwordx4 v[56:59], v9, s[4:7], s38 offen sc1
  s_add_u32 s38, s38, 4096
  buffer_store_dwordx4 v[60:63], v9, s[4:7], s38 offen sc1
  s_add_u32 s38, s38, 4096
  buffer_store_dwordx4 v[64:67], v9, s[4:7], s38 offen sc1
  s_add_u32 s38, s38, 4096
  buffer_store_dwordx4 v[68:71], v9, s[4:7], s38 offen sc1
  s_add_u32 s38, s38, 4096
  buffer_store_dwordx4 v[72:75], v9, s[4:7], s38 offen sc1
  s_add_u32 s38, s38, 4096
  buffer_store_dwordx4 v[76:79], v9, s[4:7], s38 offen sc1
  s_add_u32 s38, s38, 4096
  s_waitcnt vmcnt(0)
  s_barrier
  s_cmp_lg_u32 s11, 0
  s_cbranch_scc1 Cnf
  v_mov_b32 v9, 36
  v_mov_b32 v10, 1
  s_mov_b64 exec, 1
  global_atomic_add v9, v10, s[8:9]
  s_mov_b64 exec, -1
Cnf:
  s_mov_b32 s28, s62
  s_mov_b32 s29, s63
  s_mov_b32 s30, 4194304
  v_lshrrev_b32 v5, 2, v2
  v_lshlrev_b32 v5, 10, v5
  v_and_b32 v6, 3, v2
  v_lshl_add_u32 v5, v6, 4, v5
  s_lshl_b32 s36, s11, 20
  s_lshl_b32 s37, s12, 6
  s_add_u32 s36, s36, s37
  v_add_u32 v10, s36, v5
  s_lshl_b32 s38, s11, 15
  v_lshrrev_b32 v5, 2, v3
  v_lshl_add_u32 v5, v4, 3, v5
  v_lshlrev_b32 v5, 6, v5
  v_lshl_add_u32 v5, v6, 4, v5
  v_add_u32 v12, s38, v5
  s_add_u32 m0, s38, 0
  s_mov_b32 s37, 0
  buffer_load_dwordx4 v10, s[28:31], s37 offen lds
  s_add_u32 m0, s38, 1024
  s_mov_b32 s37, 16384
  buffer_load_dwordx4 v10, s[28:31], s37 offen lds
  s_add_u32 m0, s38, 2048
  s_mov_b32 s37, 32768
  buffer_load_dwordx4 v10, s[28:31], s37 offen lds
  s_add_u32 m0, s38, 3072
  s_mov_b32 s37, 49152
  buffer_load_dwordx4 v10, s[28:31], s37 offen lds
  s_add_u32 m0, s38, 4096
  s_mov_b32 s37, 65536
  buffer_load_dwordx4 v10, s[28:31], s37 offen lds
  s_add_u32 m0, s38, 5120
  s_mov_b32 s37, 81920
  buffer_load_dwordx4 v10, s[28:31], s37 offen lds
  s_add_u32 m0, s38, 6144
  s_mov_b32 s37, 98304
  buffer_load_dwordx4 v10, s[28:31], s37 offen lds
  s_add_u32 m0, s38, 7168
  s_mov_b32 s37, 114688
  buffer_load_dwordx4 v10, s[28:31], s37 offen lds
  s_add_u32 m0, s38, 8192
  s_mov_b32 s37, 131072
  buffer_load_dwordx4 v10, s[28:31], s37 offen lds
  s_add_u32 m0, s38, 9216
  s_mov_b32 s37, 147456
  buffer_load_dwordx4 v10, s[28:31], s37 offen lds
  s_add_u32 m0, s38, 10240
  s_mov_b32 s37, 163840
  buffer_load_dwordx4 v10, s[28:31], s37 offen lds
  s_add_u32 m0, s38, 11264
  s_mov_b32 s37, 180224
  buffer_load_dwordx4 v10, s[28:31], s37 offen lds
  s_add_u32 m0, s38, 12288
  s_mov_b32 s37, 196608
  buffer_load_dwordx4 v10, s[28:31], s37 offen lds
  s_add_u32 m0, s38, 13312
  s_mov_b32 s37, 212992
  buffer_load_dwordx4 v10, s[28:31], s37 offen lds
  s_add_u32 m0, s38, 14336
  s_mov_b32 s37, 229376
  buffer_load_dwordx4 v10, s[28:31], s37 offen lds
  s_add_u32 m0, s38, 15360
  s_mov_b32 s37, 245760
  buffer_load_dwordx4 v10, s[28:31], s37 offen lds
  s_add_u32 m0, s38, 16384
  s_mov_b32 s37, 262144
  buffer_load_dwordx4 v10, s[28:31], s37 offen lds
  s_add_u32 m0, s38, 17408
  s_mov_b32 s37, 278528
  buffer_load_dwordx4 v10, s[28:31], s37 offen lds
  s_add_u32 m0, s38, 18432
  s_mov_b32 s37, 294912
  buffer_load_dwordx4 v10, s[28:31], s37 offen lds
  s_add_u32 m0, s38, 19456
  s_mov_b32 s37, 311296
  buffer_load_dwordx4 v10, s[28:31], s37 offen lds
  s_add_u32 m0, s38, 20480
  s_mov_b32 s37, 327680
  buffer_load_dwordx4 v10, s[28:31], s37 offen lds
  s_add_u32 m0, s38, 21504
  s_mov_b32 s37, 344064
  buffer_load_dwordx4 v10, s[28:31], s37 offen lds
  s_add_u32 m0, s38, 22528
  s_mov_b32 s37, 360448
  buffer_load_dwordx4 v10, s[28:31], s37 offen lds
  s_add_u32 m0, s38, 23552
  s_mov_b32 s37, 376832
  buffer_load_dwordx4 v10, s[28:31], s37 offen lds
  s_add_u32 m0, s38, 24576
  s_mov_b32 s37, 393216
  buffer_load_dwordx4 v10, s[28:31], s37 offen lds
  s_add_u32 m0, s38, 25600
  s_mov_b32 s37, 409600
  buffer_load_dwordx4 v10, s[28:31], s37 offen lds
  s_add_u32 m0, s38, 26624
  s_mov_b32 s37, 425984
  buffer_load_dwordx4 v10, s[28:31], s37 offen lds
  s_add_u32 m0, s38, 27648
  s_mov_b32 s37, 442368
  buffer_load_dwordx4 v10, s[28:31], s37 offen lds
  s_add_u32 m0, s38, 28672
  s_mov_b32 s37, 458752
  buffer_load_dwordx4 v10, s[28:31], s37 offen lds
  s_add_u32 m0, s38, 29696
  s_mov_b32 s37, 475136
  buffer_load_dwordx4 v10, s[28:31], s37 offen lds
  s_add_u32 m0, s38, 30720
  s_mov_b32 s37, 491520
  buffer_load_dwordx4 v10, s[28:31], s37 offen lds
  s_add_u32 m0, s38, 31744
  s_mov_b32 s37, 507904
  buffer_load_dwordx4 v10, s[28:31], s37 offen lds
  s_waitcnt vmcnt(28)
  ds_read_b64_tr_b16 a[0:1], v12 offset:0
  ds_read_b64_tr_b16 a[2:3], v12 offset:256
  ds_read_b64_tr_b16 a[4:5], v12 offset:8
  ds_read_b64_tr_b16 a[6:7], v12 offset:264
  ds_read_b64_tr_b16 a[8:9], v12 offset:2048
  ds_read_b64_tr_b16 a[10:11], v12 offset:2304
  ds_read_b64_tr_b16 a[12:13], v12 offset:2056
  ds_read_b64_tr_b16 a[14:15], v12 offset:2312
  s_waitcnt lgkmcnt(0)
  s_add_u32 m0, s38, 0
  s_mov_b32 s37, 524288
  buffer_load_dwordx4 v10, s[28:31], s37 offen lds
  s_add_u32 m0, s38, 1024
  s_mov_b32 s37, 540672
  buffer_load_dwordx4 v10, s[28:31], s37 offen lds
  s_add_u32 m0, s38, 2048
  s_mov_b32 s37, 557056
  buffer_load_dwordx4 v10, s[28:31], s37 offen lds
  s_add_u32 m0, s38, 3072
  s_mov_b32 s37, 573440
  buffer_load_dwordx4 v10, s[28:31], s37 offen lds
  s_waitcnt vmcnt(28)
  ds_read_b64_tr_b16 a[16:17], v12 offset:4096
  ds_read_b64_tr_b16 a[18:19], v12 offset:4352
  ds_read_b64_tr_b16 a[20:21], v12 offset:4104
  ds_read_b64_tr_b16 a[22:23], v12 offset:4360
  ds_read_b64_tr_b16 a[24:25], v12 offset:6144
  ds_read_b64_tr_b16 a[26:27], v12 offset:6400
  ds_read_b64_tr_b16 a[28:29], v12 offset:6152
  ds_read_b64_tr_b16 a[30:31], v12 offset:6408
  s_waitcnt lgkmcnt(0)
  s_add_u32 m0, s38, 4096
  s_mov_b32 s37, 589824
  buffer_load_dwordx4 v10, s[28:31], s37 offen lds
  s_add_u32 m0, s38, 5120
  s_mov_b32 s37, 606208
  buffer_load_dwordx4 v10, s[28:31], s37 offen lds
  s_add_u32 m0, s38, 6144
  s_mov_b32 s37, 622592
  buffer_load_dwordx4 v10, s[28:31], s37 offen lds
  s_add_u32 m0, s38, 7168
  s_mov_b32 s37, 638976
  buffer_load_dwordx4 v10, s[28:31], s37 offen lds
  s_waitcnt vmcnt(28)
  ds_read_b64_tr_b16 a[32:33], v12 offset:8192
  ds_read_b64_tr_b16 a[34:35], v12 offset:8448
  ds_read_b64_tr_b16 a[36:37], v12 offset:8200
  ds_read_b64_tr_b16 a[38:39], v12 offset:8456
  ds_read_b64_tr_b16 a[40:41], v12 offset:10240
  ds_read_b64_tr_b16 a[42:43], v12 offset:10496
  ds_read_b64_tr_b16 a[44:45], v12 offset:10248
  ds_read_b64_tr_b16 a[46:47], v12 offset:10504
  s_waitcnt lgkmcnt(0)
  s_add_u32 m0, s38, 8192
  s_mov_b32 s37, 655360
  buffer_load_dwordx4 v10, s[28:31], s37 offen lds
  s_add_u32 m0, s38, 9216
  s_mov_b32 s37, 671744
  buffer_load_dwordx4 v10, s[28:31], s37 offen lds
  s_add_u32 m0, s38, 10240
  s_mov_b32 s37, 688128
  buffer_load_dwordx4 v10, s[28:31], s37 offen lds
  s_add_u32 m0, s38, 11264
  s_mov_b32 s37, 704512
  buffer_load_dwordx4 v10, s[28:31], s37 offen lds
  s_waitcnt vmcnt(28)
  ds_read_b64_tr_b16 a[48:49], v12 offset:12288
  ds_read_b64_tr_b16 a[50:51], v12 offset:12544
  ds_read_b64_tr_b16 a[52:53], v12 offset:12296
  ds_read_b64_tr_b16 a[54:55], v12 offset:12552
  ds_read_b64_tr_b16 a[56:57], v12 offset:14336
  ds_read_b64_tr_b16 a[58:59], v12 offset:14592
  ds_read_b64_tr_b16 a[60:61], v12 offset:14344
  ds_read_b64_tr_b16 a[62:63], v12 offset:14600
  s_waitcnt lgkmcnt(0)
  s_add_u32 m0, s38, 12288
  s_mov_b32 s37, 720896
  buffer_load_dwordx4 v10, s[28:31], s37 offen lds
  s_add_u32 m0, s38, 13312
  s_mov_b32 s37, 737280
  buffer_load_dwordx4 v10, s[28:31], s37 offen lds
  s_add_u32 m0, s38, 14336
  s_mov_b32 s37, 753664
  buffer_load_dwordx4 v10, s[28:31], s37 offen lds
  s_add_u32 m0, s38, 15360
  s_mov_b32 s37, 770048
  buffer_load_dwordx4 v10, s[28:31], s37 offen lds
  s_waitcnt vmcnt(28)
  ds_read_b64_tr_b16 a[64:65], v12 offset:16384
  ds_read_b64_tr_b16 a[66:67], v12 offset:16640
  ds_read_b64_tr_b16 a[68:69], v12 offset:16392
  ds_read_b64_tr_b16 a[70:71], v12 offset:16648
  ds_read_b64_tr_b16 a[72:73], v12 offset:18432
  ds_read_b64_tr_b16 a[74:75], v12 offset:18688
  ds_read_b64_tr_b16 a[76:77], v12 offset:18440
  ds_read_b64_tr_b16 a[78:79], v12 offset:18696
  s_waitcnt lgkmcnt(0)
  s_add_u32 m0, s38, 16384
  s_mov_b32 s37, 786432
  buffer_load_dwordx4 v10, s[28:31], s37 offen lds
  s_add_u32 m0, s38, 17408
  s_mov_b32 s37, 802816
  buffer_load_dwordx4 v10, s[28:31], s37 offen lds
  s_add_u32 m0, s38, 18432
  s_mov_b32 s37, 819200
  buffer_load_dwordx4 v10, s[28:31], s37 offen lds
  s_add_u32 m0, s38, 19456
  s_mov_b32 s37, 835584
  buffer_load_dwordx4 v10, s[28:31], s37 offen lds
  s_waitcnt vmcnt(28)
  ds_read_b64_tr_b16 a[80:81], v12 offset:20480
  ds_read_b64_tr_b16 a[82:83], v12 offset:20736
  ds_read_b64_tr_b16 a[84:85], v12 offset:20488
  ds_read_b64_tr_b16 a[86:87], v12 offset:20744
  ds_read_b64_tr_b16 a[88:89], v12 offset:22528
  ds_read_b64_tr_b16 a[90:91], v12 offset:22784
  ds_read_b64_tr_b16 a[92:93], v12 offset:22536
  ds_read_b64_tr_b16 a[94:95], v12 offset:22792
  s_waitcnt lgkmcnt(0)
  s_add_u32 m0, s38, 20480
  s_mov_b32 s37, 851968
  buffer_load_dwordx4 v10, s[28:31], s37 offen lds
  s_add_u32 m0, s38, 21504
  s_mov_b32 s37, 868352
  buffer_load_dwordx4 v10, s[28:31], s37 offen lds
  s_add_u32 m0, s38, 22528
  s_mov_b32 s37, 884736
  buffer_load_dwordx4 v10, s[28:31], s37 offen lds
  s_add_u32 m0, s38, 23552
  s_mov_b32 s37, 901120
  buffer_load_dwordx4 v10, s[28:31], s37 offen lds
  s_waitcnt vmcnt(28)
  ds_read_b64_tr_b16 a[96:97], v12 offset:24576
  ds_read_b64_tr_b16 a[98:99], v12 offset:24832
  ds_read_b64_tr_b16 a[100:101], v12 offset:24584
  ds_read_b64_tr_b16 a[102:103], v12 offset:24840
  ds_read_b64_tr_b16 a[104:105], v12 offset:26624
  ds_read_b64_tr_b16 a[106:107], v12 offset:26880
  ds_read_b64_tr_b16 a[108:109], v12 offset:26632
  ds_read_b64_tr_b16 a[110:111], v12 offset:26888
  s_waitcnt lgkmcnt(0)
  s_add_u32 m0, s38, 24576
  s_mov_b32 s37, 917504
  buffer_load_dwordx4 v10, s[28:31], s37 offen lds
  s_add_u32 m0, s38, 25600
  s_mov_b32 s37, 933888
  buffer_load_dwordx4 v10, s[28:31], s37 offen lds
  s_add_u32 m0, s38, 26624
  s_mov_b32 s37, 950272
  buffer_load_dwordx4 v10, s[28:31], s37 offen lds
  s_add_u32 m0, s38, 27648
  s_mov_b32 s37, 966656
  buffer_load_dwordx4 v10, s[28:31], s37 offen lds
  s_waitcnt vmcnt(28)
  ds_read_b64_tr_b16 a[112:113], v12 offset:28672
  ds_read_b64_tr_b16 a[114:115], v12 offset:28928
  ds_read_b64_tr_b16 a[116:117], v12 offset:28680
  ds_read_b64_tr_b16 a[118:119], v12 offset:28936
  ds_read_b64_tr_b16 a[120:121], v12 offset:30720
  ds_read_b64_tr_b16 a[122:123], v12 offset:30976
  ds_read_b64_tr_b16 a[124:125], v12 offset:30728
  ds_read_b64_tr_b16 a[126:127], v12 offset:30984
  s_waitcnt lgkmcnt(0)
  s_add_u32 m0, s38, 28672
  s_mov_b32 s37, 983040
  buffer_load_dwordx4 v10, s[28:31], s37 offen lds
  s_add_u32 m0, s38, 29696
  s_mov_b32 s37, 999424
  buffer_load_dwordx4 v10, s[28:31], s37 offen lds
  s_add_u32 m0, s38, 30720
  s_mov_b32 s37, 1015808
  buffer_load_dwordx4 v10, s[28:31], s37 offen lds
  s_add_u32 m0, s38, 31744
  s_mov_b32 s37, 1032192
  buffer_load_dwordx4 v10, s[28:31], s37 offen lds
  s_waitcnt vmcnt(28)
  ds_read_b64_tr_b16 a[128:129], v12 offset:0
  ds_read_b64_tr_b16 a[130:131], v12 offset:256
  ds_read_b64_tr_b16 a[132:133], v12 offset:8
  ds_read_b64_tr_b16 a[134:135], v12 offset:264
  ds_read_b64_tr_b16 a[136:137], v12 offset:2048
  ds_read_b64_tr_b16 a[138:139], v12 offset:2304
  ds_read_b64_tr_b16 a[140:141], v12 offset:2056
  ds_read_b64_tr_b16 a[142:143], v12 offset:2312
  s_waitcnt lgkmcnt(0)
  s_waitcnt vmcnt(24)
  ds_read_b64_tr_b16 a[144:145], v12 offset:4096
  ds_read_b64_tr_b16 a[146:147], v12 offset:4352
  ds_read_b64_tr_b16 a[148:149], v12 offset:4104
  ds_read_b64_tr_b16 a[150:151], v12 offset:4360
  ds_read_b64_tr_b16 a[152:153], v12 offset:6144
  ds_read_b64_tr_b16 a[154:155], v12 offset:6400
  ds_read_b64_tr_b16 a[156:157], v12 offset:6152
  ds_read_b64_tr_b16 a[158:159], v12 offset:6408
  s_waitcnt lgkmcnt(0)
  s_waitcnt vmcnt(20)
  ds_read_b64_tr_b16 a[160:161], v12 offset:8192
  ds_read_b64_tr_b16 a[162:163], v12 offset:8448
  ds_read_b64_tr_b16 a[164:165], v12 offset:8200
  ds_read_b64_tr_b16 a[166:167], v12 offset:8456
  ds_read_b64_tr_b16 a[168:169], v12 offset:10240
  ds_read_b64_tr_b16 a[170:171], v12 offset:10496
  ds_read_b64_tr_b16 a[172:173], v12 offset:10248
  ds_read_b64_tr_b16 a[174:175], v12 offset:10504
  s_waitcnt lgkmcnt(0)
  s_waitcnt vmcnt(16)
  ds_read_b64_tr_b16 a[176:177], v12 offset:12288
  ds_read_b64_tr_b16 a[178:179], v12 offset:12544
  ds_read_b64_tr_b16 a[180:181], v12 offset:12296
  ds_read_b64_tr_b16 a[182:183], v12 offset:12552
  ds_read_b64_tr_b16 a[184:185], v12 offset:14336
  ds_read_b64_tr_b16 a[186:187], v12 offset:14592
  ds_read_b64_tr_b16 a[188:189], v12 offset:14344
  ds_read_b64_tr_b16 a[190:191], v12 offset:14600
  s_waitcnt lgkmcnt(0)
  s_waitcnt vmcnt(12)
  ds_read_b64_tr_b16 a[192:193], v12 offset:16384
  ds_read_b64_tr_b16 a[194:195], v12 offset:16640
  ds_read_b64_tr_b16 a[196:197], v12 offset:16392
  ds_read_b64_tr_b16 a[198:199], v12 offset:16648
  ds_read_b64_tr_b16 a[200:201], v12 offset:18432
  ds_read_b64_tr_b16 a[202:203], v12 offset:18688
  ds_read_b64_tr_b16 a[204:205], v12 offset:18440
  ds_read_b64_tr_b16 a[206:207], v12 offset:18696
  s_waitcnt lgkmcnt(0)
  s_waitcnt vmcnt(8)
  ds_read_b64_tr_b16 a[208:209], v12 offset:20480
  ds_read_b64_tr_b16 a[210:211], v12 offset:20736
  ds_read_b64_tr_b16 a[212:213], v12 offset:20488
  ds_read_b64_tr_b16 a[214:215], v12 offset:20744
  ds_read_b64_tr_b16 a[216:217], v12 offset:22528
  ds_read_b64_tr_b16 a[218:219], v12 offset:22784
  ds_read_b64_tr_b16 a[220:221], v12 offset:22536
  ds_read_b64_tr_b16 a[222:223], v12 offset:22792
  s_waitcnt lgkmcnt(0)
  s_waitcnt vmcnt(4)
  ds_read_b64_tr_b16 a[224:225], v12 offset:24576
  ds_read_b64_tr_b16 a[226:227], v12 offset:24832
  ds_read_b64_tr_b16 a[228:229], v12 offset:24584
  ds_read_b64_tr_b16 a[230:231], v12 offset:24840
  ds_read_b64_tr_b16 a[232:233], v12 offset:26624
  ds_read_b64_tr_b16 a[234:235], v12 offset:26880
  ds_read_b64_tr_b16 a[236:237], v12 offset:26632
  ds_read_b64_tr_b16 a[238:239], v12 offset:26888
  s_waitcnt lgkmcnt(0)
  s_waitcnt vmcnt(0)
  ds_read_b64_tr_b16 a[240:241], v12 offset:28672
  ds_read_b64_tr_b16 a[242:243], v12 offset:28928
  ds_read_b64_tr_b16 a[244:245], v12 offset:28680
  ds_read_b64_tr_b16 a[246:247], v12 offset:28936
  ds_read_b64_tr_b16 a[248:249], v12 offset:30720
  ds_read_b64_tr_b16 a[250:251], v12 offset:30976
  ds_read_b64_tr_b16 a[252:253], v12 offset:30728
  ds_read_b64_tr_b16 a[254:255], v12 offset:30984
  s_waitcnt lgkmcnt(0)
  v_mov_b32 v9, 36
Ocw:
  global_load_dwordx2 v[14:15], v9, s[8:9] sc1
  s_sub_u32 s18, s18, 1
  s_cbranch_scc1 Ocg
  s_waitcnt vmcnt(0)
  v_readfirstlane_b32 s36, v14
  v_readfirstlane_b32 s37, v15
  s_add_u32 s36, s36, s37
  s_cmp_ge_u32 s36, 192
  s_cbranch_scc1 Ocd
  s_sleep 32
  s_branch Ocw
Ocg:
  s_mov_b32 s18, 0
Ocd:
  s_barrier
  s_and_b32 s36, s13, 1
  s_lshl_b32 s36, s36, 2
  v_lshrrev_b32 v5, 2, v3
  v_lshlrev_b32 v5, 3, v5
  v_add_u32 v5, v5, v6
  v_add_u32 v5, s36, v5
  v_lshlrev_b32 v7, 2, v5
  s_and_b32 s36, s11, 1
  s_lshl_b32 s36, s36, 3
  v_lshlrev_b32 v8, 4, v4
  v_add_u32 v8, s36, v8
  v_and_b32 v9, 7, v5
  v_lshlrev_b32 v9, 12, v9
  v_lshl_add_u32 v9, v4, 15, v9
  v_lshrrev_b32 v14, 3, v5
  v_lshl_add_u32 v9, v14, 4, v9
  v_add_u32 v9, s36, v9
  v_lshl_add_u32 v8, v5, 10, v8
  s_lshl_b32 s36, s12, 6
  v_add_u32 v8, s36, v8
  s_lshl_b32 s36, s11, 12
  v_add_u32 v10, s36, v1
  s_and_b32 s36, s11, 1
  s_lshl_b32 s36, s36, 10
  v_add_u32 v11, s36, v1
  v_and_b32 v13, 7, v2
  s_lshl_b32 s36, s11, 3
  v_add_lshl_u32 v13, s36, v13, 7
  s_lshr_b32 s14, s13, 1
  s_and_b32 s13, s13, 1
  s_lshl_b32 s13, s13, 10
  s_lshl_b32 s36, s11, 16
  s_add_u32 s13, s13, s36
  s_add_u32 s13, s13, 50331648
  v_mov_b32 v14, 1
  s_lshl_b32 s39, s14, 7
  s_add_u32 s37, s39, 71303168
  s_mul_i32 s39, s14, 4096
  s_add_u32 s39, s39, 78643200
  buffer_load_dword v250, v7, s[4:7], s37 offen sc1
  s_lshl_b32 s37, s14, 6
  s_lshl_b32 s38, s12, 17
  s_add_u32 s37, s37, s38
  s_add_u32 s37, s37, 67108864
  buffer_load_dwordx2 v[248:249], v9, s[4:7], s37 offen sc1
  s_mov_b64 exec, 0xff
  buffer_load_dword v14, v13, s[4:7], s39 offen sc1
  s_mov_b64 exec, -1
  s_waitcnt vmcnt(0)
Otop:
  v_cmp_eq_u32 vcc, 0, v14
  v_mov_b64 v[240:241], v[248:249]
  v_mov_b32 v242, v250
  s_cbranch_vccz Ogo
Opoll:
  s_mov_b64 exec, vcc
  buffer_load_dword v14, v13, s[4:7], s39 offen sc1
  s_mov_b64 exec, -1
  s_sub_u32 s18, s18, 1
  s_cbranch_scc1 Ogv
  s_waitcnt vmcnt(0)
  v_cmp_eq_u32 vcc, 0, v14
  s_cbranch_vccz Ogo
  s_sleep 2
  s_branch Opoll
Ogv:
  s_mov_b32 s18, 0
  s_waitcnt vmcnt(0)
Ogo:
  s_lshl_b32 s36, s14, 18
  s_add_u32 s36, s36, s13
  buffer_load_dwordx4 v[32:35], v1, s[4:7], s36 offen offset:0 sc1
  buffer_load_dwordx4 v[36:39], v1, s[4:7], s36 offen offset:2048 sc1
  s_add_u32 s36, s36, 4096
  buffer_load_dwordx4 v[40:43], v1, s[4:7], s36 offen offset:0 sc1
  buffer_load_dwordx4 v[44:47], v1, s[4:7], s36 offen offset:2048 sc1
  s_add_u32 s36, s36, 4096
  buffer_load_dwordx4 v[48:51], v1, s[4:7], s36 offen offset:0 sc1
  buffer_load_dwordx4 v[52:55], v1, s[4:7], s36 offen offset:2048 sc1
  s_add_u32 s36, s36, 4096
  buffer_load_dwordx4 v[56:59], v1, s[4:7], s36 offen offset:0 sc1
  buffer_load_dwordx4 v[60:63], v1, s[4:7], s36 offen offset:2048 sc1
  s_add_u32 s36, s36, 4096
  buffer_load_dwordx4 v[64:67], v1, s[4:7], s36 offen offset:0 sc1
  buffer_load_dwordx4 v[68:71], v1, s[4:7], s36 offen offset:2048 sc1
  s_add_u32 s36, s36, 4096
  buffer_load_dwordx4 v[72:75], v1, s[4:7], s36 offen offset:0 sc1
  buffer_load_dwordx4 v[76:79], v1, s[4:7], s36 offen offset:2048 sc1
  s_add_u32 s36, s36, 4096
  buffer_load_dwordx4 v[80:83], v1, s[4:7], s36 offen offset:0 sc1
  buffer_load_dwordx4 v[84:87], v1, s[4:7], s36 offen offset:2048 sc1
  s_waitcnt vmcnt(13)
  v_mfma_f32_16x16x32_bf16 v[16:19], a[0:3], v[32:35], 0
  v_mfma_f32_16x16x32_bf16 v[20:23], a[4:7], v[32:35], 0
  s_add_u32 s36, s36, 4096
  buffer_load_dwordx4 v[88:91], v1, s[4:7], s36 offen offset:0 sc1
  s_waitcnt vmcnt(13)
  v_mfma_f32_16x16x32_bf16 v[16:19], a[8:11], v[36:39], v[16:19]
  v_mfma_f32_16x16x32_bf16 v[20:23], a[12:15], v[36:39], v[20:23]
  buffer_load_dwordx4 v[92:95], v1, s[4:7], s36 offen offset:2048 sc1
  s_waitcnt vmcnt(13)
  v_mfma_f32_16x16x32_bf16 v[16:19], a[16:19], v[40:43], v[16:19]
  v_mfma_f32_16x16x32_bf16 v[20:23], a[20:23], v[40:43], v[20:23]
  s_add_u32 s36, s36, 4096
  buffer_load_dwordx4 v[96:99], v1, s[4:7], s36 offen offset:0 sc1
  s_waitcnt vmcnt(13)
  v_mfma_f32_16x16x32_bf16 v[16:19], a[24:27], v[44:47], v[16:19]
  v_mfma_f32_16x16x32_bf16 v[20:23], a[28:31], v[44:47], v[20:23]
  buffer_load_dwordx4 v[100:103], v1, s[4:7], s36 offen offset:2048 sc1
  s_waitcnt vmcnt(13)
  v_mfma_f32_16x16x32_bf16 v[16:19], a[32:35], v[48:51], v[16:19]
  v_mfma_f32_16x16x32_bf16 v[20:23], a[36:39], v[48:51], v[20:23]
  s_add_u32 s36, s36, 4096
  buffer_load_dwordx4 v[104:107], v1, s[4:7], s36 offen offset:0 sc1
  s_waitcnt vmcnt(13)
  v_mfma_f32_16x16x32_bf16 v[16:19], a[40:43], v[52:55], v[16:19]
  v_mfma_f32_16x16x32_bf16 v[20:23], a[44:47], v[52:55], v[20:23]
  buffer_load_dwordx4 v[108:111], v1, s[4:7], s36 offen offset:2048 sc1
  s_waitcnt vmcnt(13)
  v_mfma_f32_16x16x32_bf16 v[16:19], a[48:51], v[56:59], v[16:19]
  v_mfma_f32_16x16x32_bf16 v[20:23], a[52:55], v[56:59], v[20:23]
  s_add_u32 s36, s36, 4096
  buffer_load_dwordx4 v[112:115], v1, s[4:7], s36 offen offset:0 sc1
  s_waitcnt vmcnt(13)
  v_mfma_f32_16x16x32_bf16 v[16:19], a[56:59], v[60:63], v[16:19]
  v_mfma_f32_16x16x32_bf16 v[20:23], a[60:63], v[60:63], v[20:23]
  buffer_load_dwordx4 v[116:119], v1, s[4:7], s36 offen offset:2048 sc1
  s_waitcnt vmcnt(13)
  v_mfma_f32_16x16x32_bf16 v[16:19], a[64:67], v[64:67], v[16:19]
  v_mfma_f32_16x16x32_bf16 v[20:23], a[68:71], v[64:67], v[20:23]
  s_add_u32 s36, s36, 4096
  buffer_load_dwordx4 v[120:123], v1, s[4:7], s36 offen offset:0 sc1
  s_waitcnt vmcnt(13)
  v_mfma_f32_16x16x32_bf16 v[16:19], a[72:75], v[68:71], v[16:19]
  v_mfma_f32_16x16x32_bf16 v[20:23], a[76:79], v[68:71], v[20:23]
  buffer_load_dwordx4 v[124:127], v1, s[4:7], s36 offen offset:2048 sc1
  s_waitcnt vmcnt(13)
  v_mfma_f32_16x16x32_bf16 v[16:19], a[80:83], v[72:75], v[16:19]
  v_mfma_f32_16x16x32_bf16 v[20:23], a[84:87], v[72:75], v[20:23]
  s_add_u32 s36, s36, 4096
  buffer_load_dwordx4 v[128:131], v1, s[4:7], s36 offen offset:0 sc1
  s_waitcnt vmcnt(13)
  v_mfma_f32_16x16x32_bf16 v[16:19], a[88:91], v[76:79], v[16:19]
  v_mfma_f32_16x16x32_bf16 v[20:23], a[92:95], v[76:79], v[20:23]
  buffer_load_dwordx4 v[132:135], v1, s[4:7], s36 offen offset:2048 sc1
  s_waitcnt vmcnt(13)
  v_mfma_f32_16x16x32_bf16 v[16:19], a[96:99], v[80:83], v[16:19]
  v_mfma_f32_16x16x32_bf16 v[20:23], a[100:103], v[80:83], v[20:23]
  s_add_u32 s36, s36, 4096
  buffer_load_dwordx4 v[136:139], v1, s[4:7], s36 offen offset:0 sc1
  s_waitcnt vmcnt(13)
  v_mfma_f32_16x16x32_bf16 v[16:19], a[104:107], v[84:87], v[16:19]
  v_mfma_f32_16x16x32_bf16 v[20:23], a[108:111], v[84:87], v[20:23]
  buffer_load_dwordx4 v[140:143], v1, s[4:7], s36 offen offset:2048 sc1
  s_waitcnt vmcnt(13)
  v_mfma_f32_16x16x32_bf16 v[16:19], a[112:115], v[88:91], v[16:19]
  v_mfma_f32_16x16x32_bf16 v[20:23], a[116:119], v[88:91], v[20:23]
  s_add_u32 s36, s36, 4096
  buffer_load_dwordx4 v[144:147], v1, s[4:7], s36 offen offset:0 sc1
  s_waitcnt vmcnt(13)
  v_mfma_f32_16x16x32_bf16 v[16:19], a[120:123], v[92:95], v[16:19]
  v_mfma_f32_16x16x32_bf16 v[20:23], a[124:127], v[92:95], v[20:23]
  buffer_load_dwordx4 v[148:151], v1, s[4:7], s36 offen offset:2048 sc1
  s_waitcnt vmcnt(13)
  v_mfma_f32_16x16x32_bf16 v[16:19], a[128:131], v[96:99], v[16:19]
  v_mfma_f32_16x16x32_bf16 v[20:23], a[132:135], v[96:99], v[20:23]
  s_add_u32 s36, s36, 4096
  buffer_load_dwordx4 v[152:155], v1, s[4:7], s36 offen offset:0 sc1
  s_waitcnt vmcnt(13)
  v_mfma_f32_16x16x32_bf16 v[16:19], a[136:139], v[100:103], v[16:19]
  v_mfma_f32_16x16x32_bf16 v[20:23], a[140:143], v[100:103], v[20:23]
  buffer_load_dwordx4 v[156:159], v1, s[4:7], s36 offen offset:2048 sc1
  s_waitcnt vmcnt(13)
  v_mfma_f32_16x16x32_bf16 v[16:19], a[144:147], v[104:107], v[16:19]
  v_mfma_f32_16x16x32_bf16 v[20:23], a[148:151], v[104:107], v[20:23]
  s_add_u32 s40, s14, 2
  s_min_u32 s40, s40, 63
  s_lshl_b32 s39, s40, 7
  s_add_u32 s37, s39, 71303168
  s_mul_i32 s39, s40, 4096
  s_add_u32 s39, s39, 78643200
  buffer_load_dword v250, v7, s[4:7], s37 offen sc1
  s_lshl_b32 s37, s40, 6
  s_lshl_b32 s38, s12, 17
  s_add_u32 s37, s37, s38
  s_add_u32 s37, s37, 67108864
  buffer_load_dwordx2 v[248:249], v9, s[4:7], s37 offen sc1
  s_mov_b64 exec, 0xff
  buffer_load_dword v14, v13, s[4:7], s39 offen sc1
  s_mov_b64 exec, -1
  s_waitcnt vmcnt(15)
  v_mfma_f32_16x16x32_bf16 v[16:19], a[152:155], v[108:111], v[16:19]
  v_mfma_f32_16x16x32_bf16 v[20:23], a[156:159], v[108:111], v[20:23]
  s_waitcnt vmcnt(14)
  v_mfma_f32_16x16x32_bf16 v[16:19], a[160:163], v[112:115], v[16:19]
  v_mfma_f32_16x16x32_bf16 v[20:23], a[164:167], v[112:115], v[20:23]
  s_waitcnt vmcnt(13)
  v_mfma_f32_16x16x32_bf16 v[16:19], a[168:171], v[116:119], v[16:19]
  v_mfma_f32_16x16x32_bf16 v[20:23], a[172:175], v[116:119], v[20:23]
  s_waitcnt vmcnt(12)
  v_mfma_f32_16x16x32_bf16 v[16:19], a[176:179], v[120:123], v[16:19]
  v_mfma_f32_16x16x32_bf16 v[20:23], a[180:183], v[120:123], v[20:23]
  s_waitcnt vmcnt(11)
  v_mfma_f32_16x16x32_bf16 v[16:19], a[184:187], v[124:127], v[16:19]
  v_mfma_f32_16x16x32_bf16 v[20:23], a[188:191], v[124:127], v[20:23]
  s_waitcnt vmcnt(10)
  v_mfma_f32_16x16x32_bf16 v[16:19], a[192:195], v[128:131], v[16:19]
  v_mfma_f32_16x16x32_bf16 v[20:23], a[196:199], v[128:131], v[20:23]
  s_waitcnt vmcnt(9)
  v_mfma_f32_16x16x32_bf16 v[16:19], a[200:203], v[132:135], v[16:19]
  v_mfma_f32_16x16x32_bf16 v[20:23], a[204:207], v[132:135], v[20:23]
  s_waitcnt vmcnt(8)
  v_mfma_f32_16x16x32_bf16 v[16:19], a[208:211], v[136:139], v[16:19]
  v_mfma_f32_16x16x32_bf16 v[20:23], a[212:215], v[136:139], v[20:23]
  s_waitcnt vmcnt(7)
  v_mfma_f32_16x16x32_bf16 v[16:19], a[216:219], v[140:143], v[16:19]
  v_mfma_f32_16x16x32_bf16 v[20:23], a[220:223], v[140:143], v[20:23]
  s_waitcnt vmcnt(6)
  v_mfma_f32_16x16x32_bf16 v[16:19], a[224:227], v[144:147], v[16:19]
  v_mfma_f32_16x16x32_bf16 v[20:23], a[228:231], v[144:147], v[20:23]
  s_waitcnt vmcnt(5)
  v_mfma_f32_16x16x32_bf16 v[16:19], a[232:235], v[148:151], v[16:19]
  v_mfma_f32_16x16x32_bf16 v[20:23], a[236:239], v[148:151], v[20:23]
  s_waitcnt vmcnt(4)
  v_mfma_f32_16x16x32_bf16 v[16:19], a[240:243], v[152:155], v[16:19]
  v_mfma_f32_16x16x32_bf16 v[20:23], a[244:247], v[152:155], v[20:23]
  s_waitcnt vmcnt(3)
  v_mfma_f32_16x16x32_bf16 v[16:19], a[248:251], v[156:159], v[16:19]
  v_mfma_f32_16x16x32_bf16 v[20:23], a[252:255], v[156:159], v[20:23]
  s_nop 7
  ds_write_b128 v10, v[16:19] offset:0
  ds_write_b128 v10, v[20:23] offset:1024
  s_waitcnt lgkmcnt(0)
  s_barrier
  ds_read_b128 v[224:227], v11 offset:0
  ds_read_b128 v[228:231], v11 offset:4096
  ds_read_b128 v[232:235], v11 offset:8192
  ds_read_b128 v[236:239], v11 offset:12288
  v_sub_f32 v243, 1.0, v242
  v_cvt_pk_bf16_f32 v243, v243, v243
  v_and_b32 v243, 0xffff0000, v243
  v_lshlrev_b32 v244, 16, v240
  v_and_b32 v245, 0xffff0000, v240
  v_lshlrev_b32 v246, 16, v241
  v_and_b32 v247, 0xffff0000, v241
  v_mul_f32 v244, v244, v243
  v_mul_f32 v245, v245, v243
  v_mul_f32 v246, v246, v243
  v_mul_f32 v247, v247, v243
  v_cvt_pk_bf16_f32 v240, v244, v245
  v_cvt_pk_bf16_f32 v241, v246, v247
  v_lshlrev_b32 v244, 16, v240
  v_and_b32 v245, 0xffff0000, v240
  v_lshlrev_b32 v246, 16, v241
  v_and_b32 v247, 0xffff0000, v241
  s_waitcnt lgkmcnt(0)
  s_barrier
  v_add_f32 v224, v224, v228
  v_add_f32 v232, v232, v236
  v_add_f32 v225, v225, v229
  v_add_f32 v233, v233, v237
  v_add_f32 v226, v226, v230
  v_add_f32 v234, v234, v238
  v_add_f32 v227, v227, v231
  v_add_f32 v235, v235, v239
  v_add_f32 v224, v224, v232
  v_add_f32 v225, v225, v233
  v_add_f32 v226, v226, v234
  v_add_f32 v227, v227, v235
  v_cvt_pk_bf16_f32 v228, v224, v225
  v_cvt_pk_bf16_f32 v229, v226, v227
  v_lshlrev_b32 v224, 16, v228
  v_and_b32 v225, 0xffff0000, v228
  v_lshlrev_b32 v226, 16, v229
  v_and_b32 v227, 0xffff0000, v229
  v_mul_f32 v224, v224, v242
  v_mul_f32 v225, v225, v242
  v_mul_f32 v226, v226, v242
  v_mul_f32 v227, v227, v242
  v_cvt_pk_bf16_f32 v228, v224, v225
  v_cvt_pk_bf16_f32 v229, v226, v227
  v_lshlrev_b32 v224, 16, v228
  v_and_b32 v225, 0xffff0000, v228
  v_lshlrev_b32 v226, 16, v229
  v_and_b32 v227, 0xffff0000, v229
  v_add_f32 v224, v224, v244
  v_add_f32 v225, v225, v245
  v_add_f32 v226, v226, v246
  v_add_f32 v227, v227, v247
  v_cvt_pk_bf16_f32 v228, v224, v225
  v_cvt_pk_bf16_f32 v229, v226, v227
  s_lshl_b32 s36, s14, 15
  s_waitcnt vmcnt(0)
  s_cmp_ge_u32 s11, 2
  s_cbranch_scc1 Onst
  buffer_store_dwordx2 v[228:229], v8, s[64:67], s36 offen
Onst:
  s_add_u32 s14, s14, 2
  s_cmp_lt_u32 s14, 64
  s_cbranch_scc1 Otop
  s_branch Lend
Rchain:
  s_getpc_b64 s[40:41]
LpcC:
  v_lshlrev_b32 v255, 7, v0
  v_add_u32 v255, 0, v255
  v_min_u32 v255, Lend2-LpcC-4, v255
  global_load_dword v254, v255, s[40:41]
  v_lshrrev_b32 v1, 6, v0
  v_and_b32 v2, 63, v0
  v_readfirstlane_b32 s11, v1
  v_and_b32 v3, 15, v2
  v_lshrrev_b32 v4, 4, v2
  s_mov_b32 s30, 4194304
  s_mov_b32 s31, 0x00020000
  v_lshrrev_b32 v5, 1, v4
  v_and_b32 v7, 1, v4
  v_lshl_add_u32 v6, v5, 3, v7
  v_lshlrev_b32 v6, 13, v6
  v_lshlrev_b32 v8, 2, v4
  v_xor_b32 v8, v8, v3
  v_lshl_add_u32 v6, v8, 4, v6
  s_lshl_b32 s36, s10, 8
  v_add_u32 v0, s36, v6
  s_lshl_b32 s32, s11, 18
  s_lshl_b32 s33, s11, 13
  s_lshl_b32 s34, s11, 12
  s_waitcnt lgkmcnt(0)
  s_load_dwordx2 s[4:5], s[0:1], 128
  s_load_dwordx2 s[56:57], s[0:1], 8
  s_mov_b32 s28, s48
  s_mov_b32 s29, s49
  s_add_u32 m0, s33, 16384
  s_add_u32 s37, s32, 0
  buffer_load_dwordx4 v0, s[28:31], s37 offen nt lds
  s_add_u32 m0, s33, 17408
  s_add_u32 s37, s32, 16384
  buffer_load_dwordx4 v0, s[28:31], s37 offen nt lds
  s_add_u32 m0, s33, 18432
  s_add_u32 s37, s32, 32768
  buffer_load_dwordx4 v0, s[28:31], s37 offen nt lds
  s_add_u32 m0, s33, 19456
  s_add_u32 s37, s32, 49152
  buffer_load_dwordx4 v0, s[28:31], s37 offen nt lds
  s_add_u32 m0, s33, 20480
  s_add_u32 s37, s32, 131072
  buffer_load_dwordx4 v0, s[28:31], s37 offen nt lds
  s_add_u32 m0, s33, 21504
  s_add_u32 s37, s32, 147456
  buffer_load_dwordx4 v0, s[28:31], s37 offen nt lds
  s_add_u32 m0, s33, 22528
  s_add_u32 s37, s32, 163840
  buffer_load_dwordx4 v0, s[28:31], s37 offen nt lds
  s_add_u32 m0, s33, 23552
  s_add_u32 s37, s32, 180224
  buffer_load_dwordx4 v0, s[28:31], s37 offen nt lds
  s_add_u32 m0, s33, 49152
  s_add_u32 s37, s32, 1048576
  buffer_load_dwordx4 v0, s[28:31], s37 offen nt lds
  s_add_u32 m0, s33, 50176
  s_add_u32 s37, s32, 1064960
  buffer_load_dwordx4 v0, s[28:31], s37 offen nt lds
  s_add_u32 m0, s33, 51200
  s_add_u32 s37, s32, 1081344
  buffer_load_dwordx4 v0, s[28:31], s37 offen nt lds
  s_add_u32 m0, s33, 52224
  s_add_u32 s37, s32, 1097728
  buffer_load_dwordx4 v0, s[28:31], s37 offen nt lds
  s_add_u32 m0, s33, 53248
  s_add_u32 s37, s32, 1179648
  buffer_load_dwordx4 v0, s[28:31], s37 offen nt lds
  s_add_u32 m0, s33, 54272
  s_add_u32 s37, s32, 1196032
  buffer_load_dwordx4 v0, s[28:31], s37 offen nt lds
  s_add_u32 m0, s33, 55296
  s_add_u32 s37, s32, 1212416
  buffer_load_dwordx4 v0, s[28:31], s37 offen nt lds
  s_add_u32 m0, s33, 56320
  s_add_u32 s37, s32, 1228800
  buffer_load_dwordx4 v0, s[28:31], s37 offen nt lds
  s_add_u32 m0, s33, 81920
  s_add_u32 s37, s32, 2097152
  buffer_load_dwordx4 v0, s[28:31], s37 offen nt lds
  s_add_u32 m0, s33, 82944
  s_add_u32 s37, s32, 2113536
  buffer_load_dwordx4 v0, s[28:31], s37 offen nt lds
  s_add_u32 m0, s33, 83968
  s_add_u32 s37, s32, 2129920
  buffer_load_dwordx4 v0, s[28:31], s37 offen nt lds
  s_add_u32 m0, s33, 84992
  s_add_u32 s37, s32, 2146304
  buffer_load_dwordx4 v0, s[28:31], s37 offen nt lds
  s_add_u32 m0, s33, 86016
  s_add_u32 s37, s32, 2228224
  buffer_load_dwordx4 v0, s[28:31], s37 offen nt lds
  s_add_u32 m0, s33, 87040
  s_add_u32 s37, s32, 2244608
  buffer_load_dwordx4 v0, s[28:31], s37 offen nt lds
  s_add_u32 m0, s33, 88064
  s_add_u32 s37, s32, 2260992
  buffer_load_dwordx4 v0, s[28:31], s37 offen nt lds
  s_add_u32 m0, s33, 89088
  s_add_u32 s37, s32, 2277376
  buffer_load_dwordx4 v0, s[28:31], s37 offen nt lds
  v_lshrrev_b32 v6, 3, v2
  v_lshlrev_b32 v6, 10, v6
  v_and_b32 v8, 7, v2
  v_lshl_add_u32 v6, v8, 4, v6
  s_lshl_b32 s36, s10, 17
  s_lshl_b32 s37, s11, 8
  s_add_u32 s36, s36, s37
  v_add_u32 v1, s36, v6
  s_mov_b32 s28, s54
  s_mov_b32 s29, s55
  s_xor_b32 s36, s11, 2
  s_lshl_b32 s36, s36, 15
  s_add_u32 m0, s34, 147456
  s_add_u32 s37, s36, 128
  buffer_load_dwordx4 v1, s[28:31], s37 offen nt lds
  s_add_u32 m0, s34, 148480
  s_add_u32 s37, s36, 8320
  buffer_load_dwordx4 v1, s[28:31], s37 offen nt lds
  s_add_u32 m0, s34, 149504
  s_add_u32 s37, s36, 16512
  buffer_load_dwordx4 v1, s[28:31], s37 offen nt lds
  s_add_u32 m0, s34, 150528
  s_add_u32 s37, s36, 24704
  buffer_load_dwordx4 v1, s[28:31], s37 offen nt lds
  s_xor_b32 s36, s11, 3
  s_lshl_b32 s36, s36, 15
  s_add_u32 m0, s34, 0
  s_add_u32 s37, s36, 128
  buffer_load_dwordx4 v1, s[28:31], s37 offen nt lds
  s_add_u32 m0, s34, 1024
  s_add_u32 s37, s36, 8320
  buffer_load_dwordx4 v1, s[28:31], s37 offen nt lds
  s_add_u32 m0, s34, 2048
  s_add_u32 s37, s36, 16512
  buffer_load_dwordx4 v1, s[28:31], s37 offen nt lds
  s_add_u32 m0, s34, 3072
  s_add_u32 s37, s36, 24704
  buffer_load_dwordx4 v1, s[28:31], s37 offen nt lds
  v_lshlrev_b32 v15, 4, v2
  s_mov_b32 s6, 268435456
  s_mov_b32 s7, 0x00020000
  v_mov_b32 v5, 0x4444
  v_mov_b32 v6, 0xeeee
  v_cmp_gt_u32 vcc, 8, v3
  s_nop 1
  v_cndmask_b32 v128, v6, v5, vcc
  v_lshrrev_b32 v5, 1, v4
  v_lshlrev_b32 v5, 2, v5
  v_lshrrev_b32 v6, 3, v3
  v_lshl_add_u32 v5, v6, 1, v5
  v_and_b32 v6, 1, v4
  v_add_u32 v5, v5, v6
  s_lshl_b32 s36, s11, 3
  v_add_u32 v5, s36, v5
  v_lshlrev_b32 v5, 11, v5
  v_and_b32 v8, 7, v3
  v_lshl_add_u32 v5, v8, 3, v5
  s_lshl_b32 s37, s10, 6
  v_add_u32 v130, s37, v5
  s_lshl_b32 s36, s11, 5
  s_add_u32 s36, s36, s10
  s_lshl_b32 s38, s36, 11
  v_add_u32 v131, s38, v15
  s_lshl_b32 s36, s36, 6
  s_add_u32 s36, s36, 262144
  v_and_b32 v5, 3, v3
  v_lshlrev_b32 v5, 2, v5
  v_lshl_add_u32 v5, v4, 4, v5
  v_add_u32 v132, s36, v5
  v_lshrrev_b32 v5, 2, v3
  v_lshl_add_u32 v132, v5, 29, v132
  s_lshl_b32 s36, s11, 11
  v_add_u32 v133, s36, v15
  v_xor_b32 v134, 2048, v133
  v_xor_b32 v135, 4096, v133
  v_xor_b32 v136, 6144, v133
  v_and_b32 v5, 31, v2
  v_lshlrev_b32 v137, 4, v5
  v_lshrrev_b32 v7, 3, v3
  s_lshr_b32 s36, s11, 1
  s_lshl_b32 s36, s36, 11
  s_and_b32 s37, s11, 1
  s_lshl_b32 s37, s37, 3
  s_add_u32 s36, s36, s37
  v_mov_b32 v138, 1
  v_xor_b32 v5, 32, v2
  v_lshlrev_b32 v5, 4, v5
  v_add_u32 v129, s36, v5
  s_add_u32 s38, s33, 16384
  v_add_u32 v139, s38, v15
  v_mov_b32 v140, -1
  v_mov_b32 v6, 0x3f80
  v_and_b32 v5, 4, v3
  v_lshlrev_b32 v5, 2, v5
  v_lshlrev_b32 v9, v5, v6
  v_and_b32 v5, 1, v8
  v_lshlrev_b32 v5, 4, v5
  v_lshlrev_b32 v5, v5, v6
  v_and_b32 v6, 3, v3
  v_lshl_add_u32 v6, v6, 1, v7
  v_cmp_eq_u32 vcc, 0, v6
  s_nop 1
  v_cndmask_b32 v124, 0, v9, vcc
  v_cmp_eq_u32 vcc, 1, v6
  s_nop 1
  v_cndmask_b32 v125, 0, v9, vcc
  v_cmp_eq_u32 vcc, 2, v6
  s_nop 1
  v_cndmask_b32 v126, 0, v9, vcc
  v_cmp_eq_u32 vcc, 3, v6
  s_nop 1
  v_cndmask_b32 v127, 0, v9, vcc
  v_lshrrev_b32 v6, 1, v3
  v_and_b32 v6, 1, v6
  v_lshl_add_u32 v6, v7, 1, v6
  v_lshrrev_b32 v9, 2, v3
  v_xor_b32 v9, v9, v4
  v_and_b32 v9, 1, v9
  v_lshl_add_u32 v6, v9, 3, v6
  v_cmp_eq_u32 vcc, 0, v6
  s_nop 1
  v_cndmask_b32 v120, 0, v5, vcc
  v_cmp_eq_u32 vcc, 1, v6
  s_nop 1
  v_cndmask_b32 v121, 0, v5, vcc
  v_cmp_eq_u32 vcc, 2, v6
  s_nop 1
  v_cndmask_b32 v122, 0, v5, vcc
  v_cmp_eq_u32 vcc, 3, v6
  s_nop 1
  v_cndmask_b32 v123, 0, v5, vcc
  s_mov_b32 s60, 0x000f001f
  s_mov_b32 s61, 0x000f000f
  s_mov_b32 s35, 0xffffff7f
  s_mul_i32 s63, s11, 6144
  s_add_u32 s22, s10, s11
  s_mov_b32 s23, 77324160
  s_mov_b32 s15, 75759616
  s_mov_b32 s26, 1040356334
  s_mov_b32 s58, 0x3f803f80
  s_mov_b32 s59, 0x3e803e80
  s_mov_b32 s12, 75497472
  s_mov_b32 s13, 75771904
  s_mov_b32 s14, 76046336
  s_mov_b32 s20, 77332480
  s_lshl_b32 s16, s10, 3
  s_add_u32 s16, s16, s11
  s_lshl_b32 s16, s16, 11
  s_mov_b32 s17, 0
  s_mov_b32 s18, 262144
  v_lshrrev_b32 v5, 1, v4
  v_and_b32 v7, 1, v4
  v_lshrrev_b32 v9, 2, v3
  v_and_b32 v6, 3, v3
  v_lshl_add_u32 v12, v4, 3, v9
  v_lshlrev_b32 v12, 8, v12
  v_xor_b32 v10, s11, v9
  v_lshl_add_u32 v10, v10, 2, v6
  v_lshl_add_u32 v12, v10, 4, v12
  v_lshrrev_b32 v8, 3, v3
  v_and_b32 v9, 1, v9
  v_lshlrev_b32 v13, 3, v5
  v_lshl_add_u32 v13, v7, 2, v13
  v_add_u32 v13, v13, v9
  v_lshlrev_b32 v13, 7, v13
  v_lshl_add_u32 v13, v8, 5, v13
  v_lshl_add_u32 v13, v6, 3, v13
  v_and_b32 v14, 7, v3
  v_lshlrev_b32 v14, 10, v14
  v_lshl_add_u32 v14, v5, 8, v14
  v_lshl_add_u32 v14, v7, 5, v14
  v_lshl_add_u32 v14, v8, 4, v14
  s_lshr_b32 s36, s32, 12
  v_add_u32 v4, s36, v14
  v_mul_u32_u24 v5, 8320, v2
  v_mov_b32 v2, v12
  v_mov_b32 v3, v13
  s_waitcnt lgkmcnt(0)
  v_mov_b64 v[8:9], -1
  v_mov_b64 v[10:11], -1
  buffer_store_dwordx4 v[8:11], v131, s[4:7], s12 offen
  buffer_store_dwordx4 v[8:11], v131, s[4:7], s12 offen offset:1024
  buffer_store_dword v140, v132, s[4:7], s12 offen
  buffer_store_dwordx4 v[8:11], v131, s[4:7], s13 offen
  buffer_store_dwordx4 v[8:11], v131, s[4:7], s13 offen offset:1024
  buffer_store_dword v140, v132, s[4:7], s13 offen
  buffer_store_dwordx4 v[8:11], v131, s[4:7], s14 offen
  buffer_store_dwordx4 v[8:11], v131, s[4:7], s14 offen offset:1024
  buffer_store_dword v140, v132, s[4:7], s14 offen
  s_mov_b32 s36, 77815040
  buffer_store_dword v140, v132, s[4:7], s36 offen sc1
  s_mov_b32 s36, 77823360
  buffer_store_dword v140, v132, s[4:7], s36 offen sc1
  s_mov_b32 s36, 77831680
  buffer_store_dword v140, v132, s[4:7], s36 offen sc1
  s_mov_b32 s36, 77840000
  buffer_store_dword v140, v132, s[4:7], s36 offen sc1
  s_mov_b32 s36, 77848320
  buffer_store_dword v140, v132, s[4:7], s36 offen sc1
  s_mov_b32 s36, 77856640
  buffer_store_dword v140, v132, s[4:7], s36 offen sc1
  s_cmp_lg_u32 s22, 0
  s_cbranch_scc1 Lnofl
  s_mov_b32 s36, 77611136
  buffer_store_dword v140, v5, s[4:7], s36 offen sc1
  s_mov_b64 exec, 16
  v_mov_b32 v132, 270336
  s_mov_b64 exec, -1
Lnofl:
  s_sub_u32 s36, 131072, s34
  v_add_u32 v141, 65536, v139
  v_add_u32 v142, s36, v139
  s_lshl_b32 s62, s10, 7
  s_add_u32 s62, s62, 78905344
  s_mov_b32 s21, 1
  s_waitcnt vmcnt(39)
  s_barrier
  s_mov_b32 s28, s48
  s_mov_b32 s29, s49
  s_add_u32 m0, s33, 114688
  s_add_u32 s37, s32, 3145728
  buffer_load_dwordx4 v0, s[28:31], s37 offen nt lds
  s_add_u32 m0, s33, 115712
  s_add_u32 s37, s32, 3162112
  buffer_load_dwordx4 v0, s[28:31], s37 offen nt lds
  s_add_u32 m0, s33, 116736
  s_add_u32 s37, s32, 3178496
  buffer_load_dwordx4 v0, s[28:31], s37 offen nt lds
  s_add_u32 m0, s33, 117760
  s_add_u32 s37, s32, 3194880
  buffer_load_dwordx4 v0, s[28:31], s37 offen nt lds
  s_add_u32 m0, s33, 118784
  s_add_u32 s37, s32, 3276800
  buffer_load_dwordx4 v0, s[28:31], s37 offen nt lds
  s_add_u32 m0, s33, 119808
  s_add_u32 s37, s32, 3293184
  buffer_load_dwordx4 v0, s[28:31], s37 offen nt lds
  s_add_u32 m0, s33, 120832
  s_add_u32 s37, s32, 3309568
  buffer_load_dwordx4 v0, s[28:31], s37 offen nt lds
  s_add_u32 m0, s33, 121856
  s_add_u32 s37, s32, 3325952
  buffer_load_dwordx4 v0, s[28:31], s37 offen nt lds
  s_xor_b32 s36, s11, 0
  s_lshl_b32 s36, s36, 13
  s_add_u32 s36, s36, 16384
  v_add_u32 v5, s36, v2
  ds_read_b64_tr_b16 a[0:1], v5 offset:0
  ds_read_b64_tr_b16 a[2:3], v5 offset:1024
  ds_read_b64_tr_b16 a[8:9], v5 offset:8
  ds_read_b64_tr_b16 a[10:11], v5 offset:1032
  s_xor_b32 s36, s11, 1
  s_lshl_b32 s36, s36, 13
  s_add_u32 s36, s36, 16384
  v_add_u32 v6, s36, v2
  ds_read_b64_tr_b16 v[8:9], v6 offset:0
  ds_read_b64_tr_b16 v[10:11], v6 offset:1024
  ds_read_b64_tr_b16 v[16:17], v6 offset:8
  ds_read_b64_tr_b16 v[18:19], v6 offset:1032
  s_waitcnt lgkmcnt(0)
  s_xor_b32 s36, s11, 2
  s_lshl_b32 s36, s36, 13
  s_add_u32 s36, s36, 16384
  v_add_u32 v5, s36, v2
  ds_read_b64_tr_b16 a[32:33], v5 offset:0
  ds_read_b64_tr_b16 a[34:35], v5 offset:1024
  ds_read_b64_tr_b16 a[40:41], v5 offset:8
  ds_read_b64_tr_b16 a[42:43], v5 offset:1032
  s_xor_b32 s36, s11, 3
  s_lshl_b32 s36, s36, 13
  s_add_u32 s36, s36, 16384
  v_add_u32 v6, s36, v2
  ds_read_b64_tr_b16 a[64:65], v6 offset:0
  ds_read_b64_tr_b16 a[66:67], v6 offset:1024
  ds_read_b64_tr_b16 a[72:73], v6 offset:8
  ds_read_b64_tr_b16 a[74:75], v6 offset:1032
  s_waitcnt lgkmcnt(0)
  s_waitcnt vmcnt(39)
  s_barrier
  s_mov_b32 s28, s50
  s_mov_b32 s29, s51
  s_add_u32 m0, s33, 16384
  s_add_u32 s37, s32, 0
  buffer_load_dwordx4 v0, s[28:31], s37 offen nt lds
  s_add_u32 m0, s33, 17408
  s_add_u32 s37, s32, 16384
  buffer_load_dwordx4 v0, s[28:31], s37 offen nt lds
  s_add_u32 m0, s33, 18432
  s_add_u32 s37, s32, 32768
  buffer_load_dwordx4 v0, s[28:31], s37 offen nt lds
  s_add_u32 m0, s33, 19456
  s_add_u32 s37, s32, 49152
  buffer_load_dwordx4 v0, s[28:31], s37 offen nt lds
  s_add_u32 m0, s33, 20480
  s_add_u32 s37, s32, 131072
  buffer_load_dwordx4 v0, s[28:31], s37 offen nt lds
  s_add_u32 m0, s33, 21504
  s_add_u32 s37, s32, 147456
  buffer_load_dwordx4 v0, s[28:31], s37 offen nt lds
  s_add_u32 m0, s33, 22528
  s_add_u32 s37, s32, 163840
  buffer_load_dwordx4 v0, s[28:31], s37 offen nt lds
  s_add_u32 m0, s33, 23552
  s_add_u32 s37, s32, 180224
  buffer_load_dwordx4 v0, s[28:31], s37 offen nt lds
  s_xor_b32 s36, s11, 0
  s_lshl_b32 s36, s36, 13
  s_add_u32 s36, s36, 49152
  v_add_u32 v5, s36, v2
  ds_read_b64_tr_b16 a[4:5], v5 offset:0
  ds_read_b64_tr_b16 a[6:7], v5 offset:1024
  ds_read_b64_tr_b16 a[12:13], v5 offset:8
  ds_read_b64_tr_b16 a[14:15], v5 offset:1032
  s_xor_b32 s36, s11, 1
  s_lshl_b32 s36, s36, 13
  s_add_u32 s36, s36, 49152
  v_add_u32 v6, s36, v2
  ds_read_b64_tr_b16 v[12:13], v6 offset:0
  ds_read_b64_tr_b16 v[14:15], v6 offset:1024
  ds_read_b64_tr_b16 v[20:21], v6 offset:8
  ds_read_b64_tr_b16 v[22:23], v6 offset:1032
  s_waitcnt lgkmcnt(0)
  s_xor_b32 s36, s11, 2
  s_lshl_b32 s36, s36, 13
  s_add_u32 s36, s36, 49152
  v_add_u32 v5, s36, v2
  ds_read_b64_tr_b16 a[36:37], v5 offset:0
  ds_read_b64_tr_b16 a[38:39], v5 offset:1024
  ds_read_b64_tr_b16 a[44:45], v5 offset:8
  ds_read_b64_tr_b16 a[46:47], v5 offset:1032
  s_xor_b32 s36, s11, 3
  s_lshl_b32 s36, s36, 13
  s_add_u32 s36, s36, 49152
  v_add_u32 v6, s36, v2
  ds_read_b64_tr_b16 a[68:69], v6 offset:0
  ds_read_b64_tr_b16 a[70:71], v6 offset:1024
  ds_read_b64_tr_b16 a[76:77], v6 offset:8
  ds_read_b64_tr_b16 a[78:79], v6 offset:1032
  s_waitcnt lgkmcnt(0)
  s_waitcnt vmcnt(39)
  s_barrier
  s_add_u32 m0, s33, 49152
  s_add_u32 s37, s32, 1048576
  buffer_load_dwordx4 v0, s[28:31], s37 offen nt lds
  s_add_u32 m0, s33, 50176
  s_add_u32 s37, s32, 1064960
  buffer_load_dwordx4 v0, s[28:31], s37 offen nt lds
  s_add_u32 m0, s33, 51200
  s_add_u32 s37, s32, 1081344
  buffer_load_dwordx4 v0, s[28:31], s37 offen nt lds
  s_add_u32 m0, s33, 52224
  s_add_u32 s37, s32, 1097728
  buffer_load_dwordx4 v0, s[28:31], s37 offen nt lds
  s_add_u32 m0, s33, 53248
  s_add_u32 s37, s32, 1179648
  buffer_load_dwordx4 v0, s[28:31], s37 offen nt lds
  s_add_u32 m0, s33, 54272
  s_add_u32 s37, s32, 1196032
  buffer_load_dwordx4 v0, s[28:31], s37 offen nt lds
  s_add_u32 m0, s33, 55296
  s_add_u32 s37, s32, 1212416
  buffer_load_dwordx4 v0, s[28:31], s37 offen nt lds
  s_add_u32 m0, s33, 56320
  s_add_u32 s37, s32, 1228800
  buffer_load_dwordx4 v0, s[28:31], s37 offen nt lds
  s_xor_b32 s36, s11, 0
  s_lshl_b32 s36, s36, 13
  s_add_u32 s36, s36, 81920
  v_add_u32 v5, s36, v2
  ds_read_b64_tr_b16 a[16:17], v5 offset:0
  ds_read_b64_tr_b16 a[18:19], v5 offset:1024
  ds_read_b64_tr_b16 a[24:25], v5 offset:8
  ds_read_b64_tr_b16 a[26:27], v5 offset:1032
  s_xor_b32 s36, s11, 1
  s_lshl_b32 s36, s36, 13
  s_add_u32 s36, s36, 81920
  v_add_u32 v6, s36, v2
  ds_read_b64_tr_b16 v[24:25], v6 offset:0
  ds_read_b64_tr_b16 v[26:27], v6 offset:1024
  ds_read_b64_tr_b16 v[32:33], v6 offset:8
  ds_read_b64_tr_b16 v[34:35], v6 offset:1032
  s_waitcnt lgkmcnt(0)
  s_xor_b32 s36, s11, 2
  s_lshl_b32 s36, s36, 13
  s_add_u32 s36, s36, 81920
  v_add_u32 v5, s36, v2
  ds_read_b64_tr_b16 a[48:49], v5 offset:0
  ds_read_b64_tr_b16 a[50:51], v5 offset:1024
  ds_read_b64_tr_b16 a[56:57], v5 offset:8
  ds_read_b64_tr_b16 a[58:59], v5 offset:1032
  s_xor_b32 s36, s11, 3
  s_lshl_b32 s36, s36, 13
  s_add_u32 s36, s36, 81920
  v_add_u32 v6, s36, v2
  ds_read_b64_tr_b16 a[80:81], v6 offset:0
  ds_read_b64_tr_b16 a[82:83], v6 offset:1024
  ds_read_b64_tr_b16 a[88:89], v6 offset:8
  ds_read_b64_tr_b16 a[90:91], v6 offset:1032
  s_waitcnt lgkmcnt(0)
  s_waitcnt vmcnt(16)
  s_barrier
  s_cmp_lg_u32 s11, 0
  s_cbranch_scc1 Lann
  v_mov_b32 v5, 32
  s_mov_b64 exec, 1
  global_atomic_add v5, v138, s[8:9]
  s_mov_b64 exec, -1
Lann:
  s_add_u32 m0, s33, 81920
  s_add_u32 s37, s32, 2097152
  buffer_load_dwordx4 v0, s[28:31], s37 offen nt lds
  s_add_u32 m0, s33, 82944
  s_add_u32 s37, s32, 2113536
  buffer_load_dwordx4 v0, s[28:31], s37 offen nt lds
  s_add_u32 m0, s33, 83968
  s_add_u32 s37, s32, 2129920
  buffer_load_dwordx4 v0, s[28:31], s37 offen nt lds
  s_add_u32 m0, s33, 84992
  s_add_u32 s37, s32, 2146304
  buffer_load_dwordx4 v0, s[28:31], s37 offen nt lds
  s_add_u32 m0, s33, 86016
  s_add_u32 s37, s32, 2228224
  buffer_load_dwordx4 v0, s[28:31], s37 offen nt lds
  s_add_u32 m0, s33, 87040
  s_add_u32 s37, s32, 2244608
  buffer_load_dwordx4 v0, s[28:31], s37 offen nt lds
  s_add_u32 m0, s33, 88064
  s_add_u32 s37, s32, 2260992
  buffer_load_dwordx4 v0, s[28:31], s37 offen nt lds
  s_add_u32 m0, s33, 89088
  s_add_u32 s37, s32, 2277376
  buffer_load_dwordx4 v0, s[28:31], s37 offen nt lds
  s_add_u32 s36, s34, 147456
  v_add_u32 v5, s36, v3
  v_add_u32 v6, s34, v3
  ds_read_b64_tr_b16 v[88:89], v5 offset:0
  ds_read_b64_tr_b16 v[90:91], v5 offset:256
  ds_read_b64_tr_b16 v[92:93], v5 offset:2048
  ds_read_b64_tr_b16 v[94:95], v5 offset:2304
  ds_read_b64_tr_b16 v[96:97], v5 offset:64
  ds_read_b64_tr_b16 v[98:99], v5 offset:320
  ds_read_b64_tr_b16 v[100:101], v5 offset:2112
  ds_read_b64_tr_b16 v[102:103], v5 offset:2368
  s_waitcnt lgkmcnt(0)
  ds_write_b128 v142, v[88:91] offset:0
  ds_write_b128 v142, v[92:95] offset:1024
  ds_write_b128 v142, v[96:99] offset:2048
  ds_write_b128 v142, v[100:103] offset:3072
  ds_read_b64_tr_b16 v[104:105], v6 offset:0
  ds_read_b64_tr_b16 v[106:107], v6 offset:256
  ds_read_b64_tr_b16 v[108:109], v6 offset:2048
  ds_read_b64_tr_b16 v[110:111], v6 offset:2304
  ds_read_b64_tr_b16 v[112:113], v6 offset:64
  ds_read_b64_tr_b16 v[114:115], v6 offset:320
  ds_read_b64_tr_b16 v[116:117], v6 offset:2112
  ds_read_b64_tr_b16 v[118:119], v6 offset:2368
  s_waitcnt lgkmcnt(0)
  s_xor_b32 s36, s11, 0
  s_lshl_b32 s36, s36, 13
  s_add_u32 s36, s36, 114688
  v_add_u32 v5, s36, v2
  ds_read_b64_tr_b16 a[20:21], v5 offset:0
  ds_read_b64_tr_b16 a[22:23], v5 offset:1024
  ds_read_b64_tr_b16 a[28:29], v5 offset:8
  ds_read_b64_tr_b16 a[30:31], v5 offset:1032
  s_xor_b32 s36, s11, 1
  s_lshl_b32 s36, s36, 13
  s_add_u32 s36, s36, 114688
  v_add_u32 v6, s36, v2
  ds_read_b64_tr_b16 v[28:29], v6 offset:0
  ds_read_b64_tr_b16 v[30:31], v6 offset:1024
  ds_read_b64_tr_b16 v[36:37], v6 offset:8
  ds_read_b64_tr_b16 v[38:39], v6 offset:1032
  s_waitcnt lgkmcnt(0)
  s_xor_b32 s36, s11, 2
  s_lshl_b32 s36, s36, 13
  s_add_u32 s36, s36, 114688
  v_add_u32 v5, s36, v2
  ds_read_b64_tr_b16 a[52:53], v5 offset:0
  ds_read_b64_tr_b16 a[54:55], v5 offset:1024
  ds_read_b64_tr_b16 a[60:61], v5 offset:8
  ds_read_b64_tr_b16 a[62:63], v5 offset:1032
  s_xor_b32 s36, s11, 3
  s_lshl_b32 s36, s36, 13
  s_add_u32 s36, s36, 114688
  v_add_u32 v6, s36, v2
  ds_read_b64_tr_b16 a[84:85], v6 offset:0
  ds_read_b64_tr_b16 a[86:87], v6 offset:1024
  ds_read_b64_tr_b16 a[92:93], v6 offset:8
  ds_read_b64_tr_b16 a[94:95], v6 offset:1032
  s_waitcnt lgkmcnt(0)
  s_waitcnt vmcnt(16)
  s_barrier
  s_add_u32 m0, s33, 114688
  s_add_u32 s37, s32, 3145728
  buffer_load_dwordx4 v0, s[28:31], s37 offen nt lds
  s_add_u32 m0, s33, 115712
  s_add_u32 s37, s32, 3162112
  buffer_load_dwordx4 v0, s[28:31], s37 offen nt lds
  s_add_u32 m0, s33, 116736
  s_add_u32 s37, s32, 3178496
  buffer_load_dwordx4 v0, s[28:31], s37 offen nt lds
  s_add_u32 m0, s33, 117760
  s_add_u32 s37, s32, 3194880
  buffer_load_dwordx4 v0, s[28:31], s37 offen nt lds
  s_add_u32 m0, s33, 118784
  s_add_u32 s37, s32, 3276800
  buffer_load_dwordx4 v0, s[28:31], s37 offen nt lds
  s_add_u32 m0, s33, 119808
  s_add_u32 s37, s32, 3293184
  buffer_load_dwordx4 v0, s[28:31], s37 offen nt lds
  s_add_u32 m0, s33, 120832
  s_add_u32 s37, s32, 3309568
  buffer_load_dwordx4 v0, s[28:31], s37 offen nt lds
  s_add_u32 m0, s33, 121856
  s_add_u32 s37, s32, 3325952
  buffer_load_dwordx4 v0, s[28:31], s37 offen nt lds
  s_xor_b32 s36, s11, 0
  s_lshl_b32 s36, s36, 13
  s_add_u32 s36, s36, 16384
  v_add_u32 v5, s36, v2
  ds_read_b64_tr_b16 a[96:97], v5 offset:0
  ds_read_b64_tr_b16 a[98:99], v5 offset:1024
  ds_read_b64_tr_b16 a[104:105], v5 offset:8
  ds_read_b64_tr_b16 a[106:107], v5 offset:1032
  s_xor_b32 s36, s11, 1
  s_lshl_b32 s36, s36, 13
  s_add_u32 s36, s36, 16384
  v_add_u32 v6, s36, v2
  ds_read_b64_tr_b16 v[40:41], v6 offset:0
  ds_read_b64_tr_b16 v[42:43], v6 offset:1024
  ds_read_b64_tr_b16 v[48:49], v6 offset:8
  ds_read_b64_tr_b16 v[50:51], v6 offset:1032
  s_waitcnt lgkmcnt(0)
  s_xor_b32 s36, s11, 2
  s_lshl_b32 s36, s36, 13
  s_add_u32 s36, s36, 16384
  v_add_u32 v5, s36, v2
  ds_read_b64_tr_b16 a[144:145], v5 offset:0
  ds_read_b64_tr_b16 a[146:147], v5 offset:1024
  ds_read_b64_tr_b16 a[152:153], v5 offset:8
  ds_read_b64_tr_b16 a[154:155], v5 offset:1032
  s_xor_b32 s36, s11, 3
  s_lshl_b32 s36, s36, 13
  s_add_u32 s36, s36, 16384
  v_add_u32 v6, s36, v2
  ds_read_b64_tr_b16 v[56:57], v6 offset:0
  ds_read_b64_tr_b16 v[58:59], v6 offset:1024
  ds_read_b64_tr_b16 v[64:65], v6 offset:8
  ds_read_b64_tr_b16 v[66:67], v6 offset:1032
  s_waitcnt lgkmcnt(0)
  s_waitcnt vmcnt(16)
  s_barrier
  s_mov_b32 s28, s52
  s_mov_b32 s29, s53
  s_add_u32 m0, s33, 16384
  s_add_u32 s37, s32, 0
  buffer_load_dwordx4 v0, s[28:31], s37 offen nt lds
  s_add_u32 m0, s33, 17408
  s_add_u32 s37, s32, 16384
  buffer_load_dwordx4 v0, s[28:31], s37 offen nt lds
  s_add_u32 m0, s33, 18432
  s_add_u32 s37, s32, 32768
  buffer_load_dwordx4 v0, s[28:31], s37 offen nt lds
  s_add_u32 m0, s33, 19456
  s_add_u32 s37, s32, 49152
  buffer_load_dwordx4 v0, s[28:31], s37 offen nt lds
  s_add_u32 m0, s33, 20480
  s_add_u32 s37, s32, 131072
  buffer_load_dwordx4 v0, s[28:31], s37 offen nt lds
  s_add_u32 m0, s33, 21504
  s_add_u32 s37, s32, 147456
  buffer_load_dwordx4 v0, s[28:31], s37 offen nt lds
  s_add_u32 m0, s33, 22528
  s_add_u32 s37, s32, 163840
  buffer_load_dwordx4 v0, s[28:31], s37 offen nt lds
  s_add_u32 m0, s33, 23552
  s_add_u32 s37, s32, 180224
  buffer_load_dwordx4 v0, s[28:31], s37 offen nt lds
  s_xor_b32 s36, s11, 0
  s_lshl_b32 s36, s36, 13
  s_add_u32 s36, s36, 49152
  v_add_u32 v5, s36, v2
  ds_read_b64_tr_b16 a[100:101], v5 offset:0
  ds_read_b64_tr_b16 a[102:103], v5 offset:1024
  ds_read_b64_tr_b16 a[108:109], v5 offset:8
  ds_read_b64_tr_b16 a[110:111], v5 offset:1032
  s_xor_b32 s36, s11, 1
  s_lshl_b32 s36, s36, 13
  s_add_u32 s36, s36, 49152
  v_add_u32 v6, s36, v2
  ds_read_b64_tr_b16 v[44:45], v6 offset:0
  ds_read_b64_tr_b16 v[46:47], v6 offset:1024
  ds_read_b64_tr_b16 v[52:53], v6 offset:8
  ds_read_b64_tr_b16 v[54:55], v6 offset:1032
  s_waitcnt lgkmcnt(0)
  s_xor_b32 s36, s11, 2
  s_lshl_b32 s36, s36, 13
  s_add_u32 s36, s36, 49152
  v_add_u32 v5, s36, v2
  ds_read_b64_tr_b16 a[148:149], v5 offset:0
  ds_read_b64_tr_b16 a[150:151], v5 offset:1024
  ds_read_b64_tr_b16 a[156:157], v5 offset:8
  ds_read_b64_tr_b16 a[158:159], v5 offset:1032
  s_xor_b32 s36, s11, 3
  s_lshl_b32 s36, s36, 13
  s_add_u32 s36, s36, 49152
  v_add_u32 v6, s36, v2
  ds_read_b64_tr_b16 v[60:61], v6 offset:0
  ds_read_b64_tr_b16 v[62:63], v6 offset:1024
  ds_read_b64_tr_b16 v[68:69], v6 offset:8
  ds_read_b64_tr_b16 v[70:71], v6 offset:1032
  s_waitcnt lgkmcnt(0)
  s_waitcnt vmcnt(16)
  s_barrier
  s_add_u32 m0, s33, 49152
  s_add_u32 s37, s32, 1048576
  buffer_load_dwordx4 v0, s[28:31], s37 offen nt lds
  s_add_u32 m0, s33, 50176
  s_add_u32 s37, s32, 1064960
  buffer_load_dwordx4 v0, s[28:31], s37 offen nt lds
  s_add_u32 m0, s33, 51200
  s_add_u32 s37, s32, 1081344
  buffer_load_dwordx4 v0, s[28:31], s37 offen nt lds
  s_add_u32 m0, s33, 52224
  s_add_u32 s37, s32, 1097728
  buffer_load_dwordx4 v0, s[28:31], s37 offen nt lds
  s_add_u32 m0, s33, 53248
  s_add_u32 s37, s32, 1179648
  buffer_load_dwordx4 v0, s[28:31], s37 offen nt lds
  s_add_u32 m0, s33, 54272
  s_add_u32 s37, s32, 1196032
  buffer_load_dwordx4 v0, s[28:31], s37 offen nt lds
  s_add_u32 m0, s33, 55296
  s_add_u32 s37, s32, 1212416
  buffer_load_dwordx4 v0, s[28:31], s37 offen nt lds
  s_add_u32 m0, s33, 56320
  s_add_u32 s37, s32, 1228800
  buffer_load_dwordx4 v0, s[28:31], s37 offen nt lds
  s_xor_b32 s36, s11, 0
  s_lshl_b32 s36, s36, 13
  s_add_u32 s36, s36, 81920
  v_add_u32 v5, s36, v2
  ds_read_b64_tr_b16 a[112:113], v5 offset:0
  ds_read_b64_tr_b16 a[114:115], v5 offset:1024
  ds_read_b64_tr_b16 a[120:121], v5 offset:8
  ds_read_b64_tr_b16 a[122:123], v5 offset:1032
  s_xor_b32 s36, s11, 1
  s_lshl_b32 s36, s36, 13
  s_add_u32 s36, s36, 81920
  v_add_u32 v6, s36, v2
  ds_read_b64_tr_b16 a[128:129], v6 offset:0
  ds_read_b64_tr_b16 a[130:131], v6 offset:1024
  ds_read_b64_tr_b16 a[136:137], v6 offset:8
  ds_read_b64_tr_b16 a[138:139], v6 offset:1032
  s_waitcnt lgkmcnt(0)
  s_xor_b32 s36, s11, 2
  s_lshl_b32 s36, s36, 13
  s_add_u32 s36, s36, 81920
  v_add_u32 v5, s36, v2
  ds_read_b64_tr_b16 a[160:161], v5 offset:0
  ds_read_b64_tr_b16 a[162:163], v5 offset:1024
  ds_read_b64_tr_b16 a[168:169], v5 offset:8
  ds_read_b64_tr_b16 a[170:171], v5 offset:1032
  s_xor_b32 s36, s11, 3
  s_lshl_b32 s36, s36, 13
  s_add_u32 s36, s36, 81920
  v_add_u32 v6, s36, v2
  ds_read_b64_tr_b16 a[176:177], v6 offset:0
  ds_read_b64_tr_b16 a[178:179], v6 offset:1024
  ds_read_b64_tr_b16 a[184:185], v6 offset:8
  ds_read_b64_tr_b16 a[186:187], v6 offset:1032
  s_waitcnt lgkmcnt(0)
  s_waitcnt vmcnt(16)
  s_barrier
  s_add_u32 m0, s33, 81920
  s_add_u32 s37, s32, 2097152
  buffer_load_dwordx4 v0, s[28:31], s37 offen nt lds
  s_add_u32 m0, s33, 82944
  s_add_u32 s37, s32, 2113536
  buffer_load_dwordx4 v0, s[28:31], s37 offen nt lds
  s_add_u32 m0, s33, 83968
  s_add_u32 s37, s32, 2129920
  buffer_load_dwordx4 v0, s[28:31], s37 offen nt lds
  s_add_u32 m0, s33, 84992
  s_add_u32 s37, s32, 2146304
  buffer_load_dwordx4 v0, s[28:31], s37 offen nt lds
  s_add_u32 m0, s33, 86016
  s_add_u32 s37, s32, 2228224
  buffer_load_dwordx4 v0, s[28:31], s37 offen nt lds
  s_add_u32 m0, s33, 87040
  s_add_u32 s37, s32, 2244608
  buffer_load_dwordx4 v0, s[28:31], s37 offen nt lds
  s_add_u32 m0, s33, 88064
  s_add_u32 s37, s32, 2260992
  buffer_load_dwordx4 v0, s[28:31], s37 offen nt lds
  s_add_u32 m0, s33, 89088
  s_add_u32 s37, s32, 2277376
  buffer_load_dwordx4 v0, s[28:31], s37 offen nt lds
  s_xor_b32 s36, s11, 0
  s_lshl_b32 s36, s36, 13
  s_add_u32 s36, s36, 114688
  v_add_u32 v5, s36, v2
  ds_read_b64_tr_b16 a[116:117], v5 offset:0
  ds_read_b64_tr_b16 a[118:119], v5 offset:1024
  ds_read_b64_tr_b16 a[124:125], v5 offset:8
  ds_read_b64_tr_b16 a[126:127], v5 offset:1032
  s_xor_b32 s36, s11, 1
  s_lshl_b32 s36, s36, 13
  s_add_u32 s36, s36, 114688
  v_add_u32 v6, s36, v2
  ds_read_b64_tr_b16 a[132:133], v6 offset:0
  ds_read_b64_tr_b16 a[134:135], v6 offset:1024
  ds_read_b64_tr_b16 a[140:141], v6 offset:8
  ds_read_b64_tr_b16 a[142:143], v6 offset:1032
  s_waitcnt lgkmcnt(0)
  s_xor_b32 s36, s11, 2
  s_lshl_b32 s36, s36, 13
  s_add_u32 s36, s36, 114688
  v_add_u32 v5, s36, v2
  ds_read_b64_tr_b16 a[164:165], v5 offset:0
  ds_read_b64_tr_b16 a[166:167], v5 offset:1024
  ds_read_b64_tr_b16 a[172:173], v5 offset:8
  ds_read_b64_tr_b16 a[174:175], v5 offset:1032
  s_xor_b32 s36, s11, 3
  s_lshl_b32 s36, s36, 13
  s_add_u32 s36, s36, 114688
  v_add_u32 v6, s36, v2
  ds_read_b64_tr_b16 a[180:181], v6 offset:0
  ds_read_b64_tr_b16 a[182:183], v6 offset:1024
  ds_read_b64_tr_b16 a[188:189], v6 offset:8
  ds_read_b64_tr_b16 a[190:191], v6 offset:1032
  s_waitcnt lgkmcnt(0)
  s_waitcnt vmcnt(16)
  s_barrier
  s_add_u32 m0, s33, 114688
  s_add_u32 s37, s32, 3145728
  buffer_load_dwordx4 v0, s[28:31], s37 offen nt lds
  s_add_u32 m0, s33, 115712
  s_add_u32 s37, s32, 3162112
  buffer_load_dwordx4 v0, s[28:31], s37 offen nt lds
  s_add_u32 m0, s33, 116736
  s_add_u32 s37, s32, 3178496
  buffer_load_dwordx4 v0, s[28:31], s37 offen nt lds
  s_add_u32 m0, s33, 117760
  s_add_u32 s37, s32, 3194880
  buffer_load_dwordx4 v0, s[28:31], s37 offen nt lds
  s_add_u32 m0, s33, 118784
  s_add_u32 s37, s32, 3276800
  buffer_load_dwordx4 v0, s[28:31], s37 offen nt lds
  s_add_u32 m0, s33, 119808
  s_add_u32 s37, s32, 3293184
  buffer_load_dwordx4 v0, s[28:31], s37 offen nt lds
  s_add_u32 m0, s33, 120832
  s_add_u32 s37, s32, 3309568
  buffer_load_dwordx4 v0, s[28:31], s37 offen nt lds
  s_add_u32 m0, s33, 121856
  s_add_u32 s37, s32, 3325952
  buffer_load_dwordx4 v0, s[28:31], s37 offen nt lds
  s_xor_b32 s36, s11, 0
  s_lshl_b32 s36, s36, 13
  s_add_u32 s36, s36, 16384
  v_add_u32 v5, s36, v2
  ds_read_b64_tr_b16 a[192:193], v5 offset:0
  ds_read_b64_tr_b16 a[194:195], v5 offset:1024
  ds_read_b64_tr_b16 a[200:201], v5 offset:8
  ds_read_b64_tr_b16 a[202:203], v5 offset:1032
  s_xor_b32 s36, s11, 1
  s_lshl_b32 s36, s36, 13
  s_add_u32 s36, s36, 16384
  v_add_u32 v6, s36, v2
  ds_read_b64_tr_b16 a[224:225], v6 offset:0
  ds_read_b64_tr_b16 a[226:227], v6 offset:1024
  ds_read_b64_tr_b16 a[232:233], v6 offset:8
  ds_read_b64_tr_b16 a[234:235], v6 offset:1032
  s_waitcnt lgkmcnt(0)
  s_xor_b32 s36, s11, 2
  s_lshl_b32 s36, s36, 13
  s_add_u32 s36, s36, 16384
  v_add_u32 v5, s36, v2
  ds_read_b64_tr_b16 v[144:145], v5 offset:0
  ds_read_b64_tr_b16 v[146:147], v5 offset:1024
  ds_read_b64_tr_b16 v[152:153], v5 offset:8
  ds_read_b64_tr_b16 v[154:155], v5 offset:1032
  s_xor_b32 s36, s11, 3
  s_lshl_b32 s36, s36, 13
  s_add_u32 s36, s36, 16384
  v_add_u32 v6, s36, v2
  ds_read_b64_tr_b16 v[72:73], v6 offset:0
  ds_read_b64_tr_b16 v[74:75], v6 offset:1024
  ds_read_b64_tr_b16 v[80:81], v6 offset:8
  ds_read_b64_tr_b16 v[82:83], v6 offset:1032
  s_waitcnt lgkmcnt(0)
  s_waitcnt vmcnt(16)
  s_barrier
  v_mov_b32 v5, 32
  global_load_dword v0, v5, s[8:9] sc1
  global_load_dword v143, v5, s[8:9] offset:8 sc1
  s_mov_b32 s28, s54
  s_mov_b32 s29, s55
  s_xor_b32 s36, s11, 0
  s_lshl_b32 s36, s36, 15
  s_add_u32 m0, s33, 16384
  s_add_u32 s37, s36, 0
  buffer_load_dwordx4 v1, s[28:31], s37 offen nt lds
  s_add_u32 m0, s33, 17408
  s_add_u32 s37, s36, 8192
  buffer_load_dwordx4 v1, s[28:31], s37 offen nt lds
  s_add_u32 m0, s33, 18432
  s_add_u32 s37, s36, 16384
  buffer_load_dwordx4 v1, s[28:31], s37 offen nt lds
  s_add_u32 m0, s33, 19456
  s_add_u32 s37, s36, 24576
  buffer_load_dwordx4 v1, s[28:31], s37 offen nt lds
  s_xor_b32 s36, s11, 1
  s_lshl_b32 s36, s36, 15
  s_add_u32 m0, s33, 20480
  s_add_u32 s37, s36, 0
  buffer_load_dwordx4 v1, s[28:31], s37 offen nt lds
  s_add_u32 m0, s33, 21504
  s_add_u32 s37, s36, 8192
  buffer_load_dwordx4 v1, s[28:31], s37 offen nt lds
  s_add_u32 m0, s33, 22528
  s_add_u32 s37, s36, 16384
  buffer_load_dwordx4 v1, s[28:31], s37 offen nt lds
  s_add_u32 m0, s33, 23552
  s_add_u32 s37, s36, 24576
  buffer_load_dwordx4 v1, s[28:31], s37 offen nt lds
  s_xor_b32 s36, s11, 0
  s_lshl_b32 s36, s36, 13
  s_add_u32 s36, s36, 49152
  v_add_u32 v5, s36, v2
  ds_read_b64_tr_b16 a[196:197], v5 offset:0
  ds_read_b64_tr_b16 a[198:199], v5 offset:1024
  ds_read_b64_tr_b16 a[204:205], v5 offset:8
  ds_read_b64_tr_b16 a[206:207], v5 offset:1032
  s_xor_b32 s36, s11, 1
  s_lshl_b32 s36, s36, 13
  s_add_u32 s36, s36, 49152
  v_add_u32 v6, s36, v2
  ds_read_b64_tr_b16 a[228:229], v6 offset:0
  ds_read_b64_tr_b16 a[230:231], v6 offset:1024
  ds_read_b64_tr_b16 a[236:237], v6 offset:8
  ds_read_b64_tr_b16 a[238:239], v6 offset:1032
  s_waitcnt lgkmcnt(0)
  s_xor_b32 s36, s11, 2
  s_lshl_b32 s36, s36, 13
  s_add_u32 s36, s36, 49152
  v_add_u32 v5, s36, v2
  ds_read_b64_tr_b16 v[148:149], v5 offset:0
  ds_read_b64_tr_b16 v[150:151], v5 offset:1024
  ds_read_b64_tr_b16 v[156:157], v5 offset:8
  ds_read_b64_tr_b16 v[158:159], v5 offset:1032
  s_xor_b32 s36, s11, 3
  s_lshl_b32 s36, s36, 13
  s_add_u32 s36, s36, 49152
  v_add_u32 v6, s36, v2
  ds_read_b64_tr_b16 v[76:77], v6 offset:0
  ds_read_b64_tr_b16 v[78:79], v6 offset:1024
  ds_read_b64_tr_b16 v[84:85], v6 offset:8
  ds_read_b64_tr_b16 v[86:87], v6 offset:1032
  s_waitcnt lgkmcnt(0)
  s_waitcnt vmcnt(18)
  s_barrier
  s_xor_b32 s36, s11, 2
  s_lshl_b32 s36, s36, 15
  s_add_u32 m0, s33, 49152
  s_add_u32 s37, s36, 0
  buffer_load_dwordx4 v1, s[28:31], s37 offen nt lds
  s_add_u32 m0, s33, 50176
  s_add_u32 s37, s36, 8192
  buffer_load_dwordx4 v1, s[28:31], s37 offen nt lds
  s_add_u32 m0, s33, 51200
  s_add_u32 s37, s36, 16384
  buffer_load_dwordx4 v1, s[28:31], s37 offen nt lds
  s_add_u32 m0, s33, 52224
  s_add_u32 s37, s36, 24576
  buffer_load_dwordx4 v1, s[28:31], s37 offen nt lds
  s_xor_b32 s36, s11, 3
  s_lshl_b32 s36, s36, 15
  s_add_u32 m0, s33, 53248
  s_add_u32 s37, s36, 0
  buffer_load_dwordx4 v1, s[28:31], s37 offen nt lds
  s_add_u32 m0, s33, 54272
  s_add_u32 s37, s36, 8192
  buffer_load_dwordx4 v1, s[28:31], s37 offen nt lds
  s_add_u32 m0, s33, 55296
  s_add_u32 s37, s36, 16384
  buffer_load_dwordx4 v1, s[28:31], s37 offen nt lds
  s_add_u32 m0, s33, 56320
  s_add_u32 s37, s36, 24576
  buffer_load_dwordx4 v1, s[28:31], s37 offen nt lds
  s_xor_b32 s36, s11, 0
  s_lshl_b32 s36, s36, 13
  s_add_u32 s36, s36, 81920
  v_add_u32 v5, s36, v2
  ds_read_b64_tr_b16 a[208:209], v5 offset:0
  ds_read_b64_tr_b16 a[210:211], v5 offset:1024
  ds_read_b64_tr_b16 a[216:217], v5 offset:8
  ds_read_b64_tr_b16 a[218:219], v5 offset:1032
  s_xor_b32 s36, s11, 1
  s_lshl_b32 s36, s36, 13
  s_add_u32 s36, s36, 81920
  v_add_u32 v6, s36, v2
  ds_read_b64_tr_b16 a[240:241], v6 offset:0
  ds_read_b64_tr_b16 a[242:243], v6 offset:1024
  ds_read_b64_tr_b16 a[248:249], v6 offset:8
  ds_read_b64_tr_b16 a[250:251], v6 offset:1032
  s_waitcnt lgkmcnt(0)
  s_xor_b32 s36, s11, 2
  s_lshl_b32 s36, s36, 13
  s_add_u32 s36, s36, 81920
  v_add_u32 v5, s36, v2
  ds_read_b64_tr_b16 v[160:161], v5 offset:0
  ds_read_b64_tr_b16 v[162:163], v5 offset:1024
  ds_read_b64_tr_b16 v[168:169], v5 offset:8
  ds_read_b64_tr_b16 v[170:171], v5 offset:1032
  s_xor_b32 s36, s11, 3
  s_lshl_b32 s36, s36, 13
  s_add_u32 s36, s36, 81920
  v_add_u32 v6, s36, v2
  ds_read_b64_tr_b16 v[88:89], v6 offset:0
  ds_read_b64_tr_b16 v[90:91], v6 offset:1024
  ds_read_b64_tr_b16 v[96:97], v6 offset:8
  ds_read_b64_tr_b16 v[98:99], v6 offset:1032
  s_waitcnt lgkmcnt(0)
  s_waitcnt vmcnt(18)
  s_barrier
  s_xor_b32 s36, s11, 0
  s_lshl_b32 s36, s36, 15
  s_add_u32 m0, s33, 81920
  s_add_u32 s37, s36, 128
  buffer_load_dwordx4 v1, s[28:31], s37 offen nt lds
  s_add_u32 m0, s33, 82944
  s_add_u32 s37, s36, 8320
  buffer_load_dwordx4 v1, s[28:31], s37 offen nt lds
  s_add_u32 m0, s33, 83968
  s_add_u32 s37, s36, 16512
  buffer_load_dwordx4 v1, s[28:31], s37 offen nt lds
  s_add_u32 m0, s33, 84992
  s_add_u32 s37, s36, 24704
  buffer_load_dwordx4 v1, s[28:31], s37 offen nt lds
  s_xor_b32 s36, s11, 1
  s_lshl_b32 s36, s36, 15
  s_add_u32 m0, s33, 86016
  s_add_u32 s37, s36, 128
  buffer_load_dwordx4 v1, s[28:31], s37 offen nt lds
  s_add_u32 m0, s33, 87040
  s_add_u32 s37, s36, 8320
  buffer_load_dwordx4 v1, s[28:31], s37 offen nt lds
  s_add_u32 m0, s33, 88064
  s_add_u32 s37, s36, 16512
  buffer_load_dwordx4 v1, s[28:31], s37 offen nt lds
  s_add_u32 m0, s33, 89088
  s_add_u32 s37, s36, 24704
  buffer_load_dwordx4 v1, s[28:31], s37 offen nt lds
  s_xor_b32 s36, s11, 0
  s_lshl_b32 s36, s36, 13
  s_add_u32 s36, s36, 114688
  v_add_u32 v5, s36, v2
  ds_read_b64_tr_b16 a[212:213], v5 offset:0
  ds_read_b64_tr_b16 a[214:215], v5 offset:1024
  ds_read_b64_tr_b16 a[220:221], v5 offset:8
  ds_read_b64_tr_b16 a[222:223], v5 offset:1032
  s_xor_b32 s36, s11, 1
  s_lshl_b32 s36, s36, 13
  s_add_u32 s36, s36, 114688
  v_add_u32 v6, s36, v2
  ds_read_b64_tr_b16 a[244:245], v6 offset:0
  ds_read_b64_tr_b16 a[246:247], v6 offset:1024
  ds_read_b64_tr_b16 a[252:253], v6 offset:8
  ds_read_b64_tr_b16 a[254:255], v6 offset:1032
  s_waitcnt lgkmcnt(0)
  s_xor_b32 s36, s11, 2
  s_lshl_b32 s36, s36, 13
  s_add_u32 s36, s36, 114688
  v_add_u32 v5, s36, v2
  ds_read_b64_tr_b16 v[164:165], v5 offset:0
  ds_read_b64_tr_b16 v[166:167], v5 offset:1024
  ds_read_b64_tr_b16 v[172:173], v5 offset:8
  ds_read_b64_tr_b16 v[174:175], v5 offset:1032
  s_xor_b32 s36, s11, 3
  s_lshl_b32 s36, s36, 13
  s_add_u32 s36, s36, 114688
  v_add_u32 v6, s36, v2
  ds_read_b64_tr_b16 v[92:93], v6 offset:0
  ds_read_b64_tr_b16 v[94:95], v6 offset:1024
  ds_read_b64_tr_b16 v[100:101], v6 offset:8
  ds_read_b64_tr_b16 v[102:103], v6 offset:1032
  s_waitcnt lgkmcnt(0)
  s_waitcnt vmcnt(16)
  s_barrier
  ds_write_b128 v141, v[88:91] offset:32768
  ds_write_b128 v141, v[92:95] offset:33792
  ds_write_b128 v141, v[96:99] offset:34816
  ds_write_b128 v141, v[100:103] offset:35840
  ds_write_b128 v141, v[104:107] offset:36864
  ds_write_b128 v141, v[108:111] offset:37888
  ds_write_b128 v141, v[112:115] offset:38912
  ds_write_b128 v141, v[116:119] offset:39936
  v_mov_b32 v5, 32
Lteam:
  v_readfirstlane_b32 s36, v0
  v_readfirstlane_b32 s37, v143
  s_add_u32 s36, s36, s37
  s_cmp_ge_u32 s36, 160
  s_cbranch_scc1 Lteamx
  global_load_dword v0, v5, s[8:9] sc1
  global_load_dword v143, v5, s[8:9] offset:8 sc1
  s_sub_u32 s18, s18, 1
  s_waitcnt vmcnt(0)
  s_cbranch_scc0 Lteam
  s_mov_b32 s18, 0
Lteamx:
  s_waitcnt lgkmcnt(0)
  global_load_dwordx4 v[104:107], v4, s[56:57]
  global_load_dwordx4 v[108:111], v4, s[56:57] offset:512
  s_add_u32 s36, s33, 16384
  v_add_u32 v5, s36, v3
  ds_read_b64_tr_b16 v[176:177], v5 offset:0
  ds_read_b64_tr_b16 v[178:179], v5 offset:256
  ds_read_b64_tr_b16 v[180:181], v5 offset:2048
  ds_read_b64_tr_b16 v[182:183], v5 offset:2304
  ds_read_b64_tr_b16 v[184:185], v5 offset:64
  ds_read_b64_tr_b16 v[186:187], v5 offset:320
  ds_read_b64_tr_b16 v[188:189], v5 offset:2112
  ds_read_b64_tr_b16 v[190:191], v5 offset:2368
  s_waitcnt lgkmcnt(0)
  ds_read_b64_tr_b16 v[208:209], v5 offset:4096
  ds_read_b64_tr_b16 v[210:211], v5 offset:4352
  ds_read_b64_tr_b16 v[212:213], v5 offset:6144
  ds_read_b64_tr_b16 v[214:215], v5 offset:6400
  ds_read_b64_tr_b16 v[216:217], v5 offset:4160
  ds_read_b64_tr_b16 v[218:219], v5 offset:4416
  ds_read_b64_tr_b16 v[220:221], v5 offset:6208
  ds_read_b64_tr_b16 v[222:223], v5 offset:6464
  s_waitcnt lgkmcnt(0)
  ds_write_b128 v139, v[72:75] offset:0
  ds_write_b128 v139, v[76:79] offset:1024
  ds_write_b128 v139, v[80:83] offset:2048
  ds_write_b128 v139, v[84:87] offset:3072
  ds_write_b128 v139, v[56:59] offset:4096
  ds_write_b128 v139, v[60:63] offset:5120
  ds_write_b128 v139, v[64:67] offset:6144
  ds_write_b128 v139, v[68:71] offset:7168
  s_waitcnt vmcnt(10)
  s_mov_b64 exec, 15
  buffer_load_dword v0, v137, s[4:7], s62 offen sc1
  s_mov_b64 exec, -1
  s_add_u32 s36, s33, 49152
  v_add_u32 v5, s36, v3
  s_waitcnt lgkmcnt(0)
  ds_read_b64_tr_b16 v[224:225], v5 offset:0
  ds_read_b64_tr_b16 v[226:227], v5 offset:256
  ds_read_b64_tr_b16 v[228:229], v5 offset:2048
  ds_read_b64_tr_b16 v[230:231], v5 offset:2304
  ds_read_b64_tr_b16 v[232:233], v5 offset:64
  ds_read_b64_tr_b16 v[234:235], v5 offset:320
  ds_read_b64_tr_b16 v[236:237], v5 offset:2112
  ds_read_b64_tr_b16 v[238:239], v5 offset:2368
  s_waitcnt lgkmcnt(0)
  ds_read_b64_tr_b16 v[240:241], v5 offset:4096
  ds_read_b64_tr_b16 v[242:243], v5 offset:4352
  ds_read_b64_tr_b16 v[244:245], v5 offset:6144
  ds_read_b64_tr_b16 v[246:247], v5 offset:6400
  ds_read_b64_tr_b16 v[248:249], v5 offset:4160
  ds_read_b64_tr_b16 v[250:251], v5 offset:4416
  ds_read_b64_tr_b16 v[252:253], v5 offset:6208
  ds_read_b64_tr_b16 v[254:255], v5 offset:6464
  s_waitcnt lgkmcnt(0)
  ds_write_b128 v139, v[40:43] offset:32768
  ds_write_b128 v139, v[44:47] offset:33792
  ds_write_b128 v139, v[48:51] offset:34816
  ds_write_b128 v139, v[52:55] offset:35840
  ds_write_b128 v139, v[24:27] offset:36864
  ds_write_b128 v139, v[28:31] offset:37888
  ds_write_b128 v139, v[32:35] offset:38912
  ds_write_b128 v139, v[36:39] offset:39936
  s_waitcnt vmcnt(3)
  v_mbcnt_lo_u32_b32 v1, -1, 0
  v_mbcnt_hi_u32_b32 v1, -1, v1
  v_lshrrev_b32 v2, 4, v1
  v_min_u32 v2, 2, v2
  v_mul_u32_u24 v2, 274432, v2
  v_and_b32 v1, 15, v1
  v_lshl_add_u32 v1, v1, 7, v2
  s_lshl_b32 s36, s11, 11
  s_add_u32 s36, s36, 75759616
  buffer_load_dword v88, v1, s[4:7], s36 offen sc1
  s_xor_b32 s36, s10, 2
  s_lshl_b32 s37, s11, 5
  s_add_u32 s36, s36, s37
  s_lshl_b32 s36, s36, 11
  s_add_u32 s36, s36, 75497472
  buffer_load_dword v88, v1, s[4:7], s36 offen sc1
  s_xor_b32 s36, s10, 0
  s_lshl_b32 s37, s11, 5
  s_add_u32 s36, s36, s37
  s_lshl_b32 s36, s36, 11
  s_add_u32 s36, s36, 75497472
  buffer_load_dword v88, v1, s[4:7], s36 offen sc1
  s_xor_b32 s36, s10, 3
  s_lshl_b32 s37, s11, 5
  s_add_u32 s36, s36, s37
  s_lshl_b32 s36, s36, 11
  s_add_u32 s36, s36, 75497472
  buffer_load_dword v88, v1, s[4:7], s36 offen sc1
  s_add_u32 s36, s33, 81920
  v_add_u32 v5, s36, v3
  s_waitcnt lgkmcnt(0)
  ds_read_b64_tr_b16 v[192:193], v5 offset:0
  ds_read_b64_tr_b16 v[194:195], v5 offset:256
  ds_read_b64_tr_b16 v[196:197], v5 offset:2048
  ds_read_b64_tr_b16 v[198:199], v5 offset:2304
  ds_read_b64_tr_b16 v[200:201], v5 offset:64
  ds_read_b64_tr_b16 v[202:203], v5 offset:320
  ds_read_b64_tr_b16 v[204:205], v5 offset:2112
  ds_read_b64_tr_b16 v[206:207], v5 offset:2368
  s_waitcnt lgkmcnt(0)
  ds_read_b64_tr_b16 v[24:25], v5 offset:4096
  ds_read_b64_tr_b16 v[26:27], v5 offset:4352
  ds_read_b64_tr_b16 v[28:29], v5 offset:6144
  ds_read_b64_tr_b16 v[30:31], v5 offset:6400
  ds_read_b64_tr_b16 v[32:33], v5 offset:4160
  ds_read_b64_tr_b16 v[34:35], v5 offset:4416
  ds_read_b64_tr_b16 v[36:37], v5 offset:6208
  ds_read_b64_tr_b16 v[38:39], v5 offset:6464
  s_waitcnt lgkmcnt(0)
  ds_write_b128 v141, v[8:11] offset:0
  ds_write_b128 v141, v[12:15] offset:1024
  ds_write_b128 v141, v[16:19] offset:2048
  ds_write_b128 v141, v[20:23] offset:3072
  ds_write_b128 v141, v[24:27] offset:4096
  ds_write_b128 v141, v[28:31] offset:5120
  ds_write_b128 v141, v[32:35] offset:6144
  ds_write_b128 v141, v[36:39] offset:7168
  s_add_u32 s28, s4, s62
  s_addc_u32 s29, s5, 0
  s_cmp_eq_u32 s11, 0
  s_cselect_b32 s30, 64, 0
  s_waitcnt vmcnt(4)
  s_mov_b64 exec, 15
LkvA:
  v_cmp_ge_u32 vcc, s21, v0
  s_cbranch_vccz LkvAx
  buffer_load_dword v0, v137, s[4:7], s62 offen sc1
  s_sub_u32 s18, s18, 1
  s_waitcnt vmcnt(0)
  s_cbranch_scc0 LkvA
  s_mov_b32 s18, 0
LkvAx:
  s_mov_b64 exec, -1
  v_mov_b64 v[0:1], v[104:105]
  v_mov_b64 v[2:3], v[106:107]
  v_mov_b64 v[4:5], v[108:109]
  v_mov_b64 v[6:7], v[110:111]
  s_waitcnt lgkmcnt(0)
  s_cmp_lg_u32 s10, 0
  s_cbranch_scc1 Lnopub
  s_add_u32 s36, s20, 262144
  buffer_store_dwordx4 v[0:3], v133, s[4:7], s36 offen sc1
  buffer_store_dwordx4 v[4:7], v133, s[4:7], s36 offen offset:1024 sc1
Lnopub:
  buffer_load_dwordx4 v[88:91], v133, s[4:7], s16 offen sc1
  buffer_load_dwordx4 v[92:95], v133, s[4:7], s16 offen offset:1024 sc1
  ds_read_b128 v[32:35], v141 offset:0
  ds_read_b128 v[36:39], v141 offset:1024
  ds_read_b128 v[40:43], v141 offset:2048
  ds_read_b128 v[44:47], v141 offset:3072
  ds_read_b128 v[48:51], v139 offset:36864
  ds_read_b128 v[52:55], v139 offset:37888
  ds_read_b128 v[56:59], v139 offset:38912
  ds_read_b128 v[60:63], v139 offset:39936
  ds_read_b128 v[104:107], v139 offset:32768
  ds_read_b128 v[108:111], v139 offset:33792
  ds_read_b128 v[112:115], v139 offset:4096
  ds_read_b128 v[116:119], v139 offset:5120
  v_mov_b64 v[64:65], 0
  v_mov_b64 v[66:67], 0
  v_mov_b64 v[68:69], 0
  v_mov_b64 v[70:71], 0
  v_mov_b64 v[72:73], 0
  v_mov_b64 v[74:75], 0
  v_mov_b64 v[76:77], 0
  v_mov_b64 v[78:79], 0
  v_mov_b64 v[80:81], 0
  v_mov_b64 v[82:83], 0
  v_mov_b64 v[84:85], 0
  v_mov_b64 v[86:87], 0
  s_nop 0
  v_smfmac_f32_16x16x64_bf16 v[64:67], v[0:3], a[0:7], v128
  s_branch Lp2cont
.p2align 6
Lp2a:
  s_waitcnt vmcnt(3)
Lstep:
  v_max3_u32 v8, v0, v1, v2
  v_max_u32 v8, v8, v3
  s_waitcnt vmcnt(2)
  v_max3_u32 v8, v8, v4, v5
  v_max3_u32 v8, v8, v6, v7
  v_cmp_le_u32 vcc, 0xffc00000, v8
  v_smfmac_f32_16x16x64_bf16 v[64:67], v[0:3], a[0:7], v128
  s_cbranch_vccnz Lp2r
Lp2cont:
  ds_write_b128 v133, v[0:3]
  v_smfmac_f32_16x16x64_bf16 v[64:67], v[4:7], a[16:23], v128
  ds_write_b128 v133, v[4:7] offset:1024
  v_smfmac_f32_16x16x64_bf16 v[68:71], v[0:3], a[8:15], v128
  v_smfmac_f32_16x16x64_bf16 v[68:71], v[4:7], a[24:31], v128
  v_smfmac_f32_16x16x64_bf16 v[76:79], v[0:3], a[104:111], v128
  v_smfmac_f32_16x16x64_bf16 v[76:79], v[4:7], a[120:127], v128
  v_smfmac_f32_16x16x64_bf16 v[80:83], v[0:3], a[192:199], v128
  s_waitcnt lgkmcnt(0)
  s_barrier
  ds_read_b128 v[8:11], v134 offset:0
  v_smfmac_f32_16x16x64_bf16 v[80:83], v[4:7], a[208:215], v128
  ds_read_b128 v[12:15], v134 offset:1024
  v_smfmac_f32_16x16x64_bf16 v[84:87], v[0:3], a[200:207], v128
  buffer_load_dwordx4 v[96:99], v133, s[4:7], s16 offen offset:2048 sc1
  ds_read_b128 v[16:19], v135 offset:0
  v_smfmac_f32_16x16x64_bf16 v[84:87], v[4:7], a[216:223], v128
  ds_read_b128 v[20:23], v135 offset:1024
  v_smfmac_f32_16x16x64_bf16 v[72:75], v[0:3], a[96:103], v128
  ds_read_b128 v[24:27], v136 offset:0
  v_smfmac_f32_16x16x64_bf16 v[72:75], v[4:7], a[112:119], v128
  ds_read_b128 v[28:31], v136 offset:1024
  s_waitcnt lgkmcnt(5)
  v_smfmac_f32_16x16x64_bf16 v[72:75], v[8:11], v[104:111], v128
  buffer_load_dwordx4 v[100:103], v133, s[4:7], s16 offen offset:3072 sc1
  s_add_u32 s16, s16, 524288
  s_waitcnt lgkmcnt(4)
  v_smfmac_f32_16x16x64_bf16 v[72:75], v[12:15], a[128:135], v128
  ds_read_b128 v[104:107], v139 offset:34816
  s_waitcnt lgkmcnt(4)
  v_smfmac_f32_16x16x64_bf16 v[72:75], v[16:19], a[144:151], v128
  ds_read_b128 v[108:111], v139 offset:35840
  s_waitcnt lgkmcnt(4)
  v_smfmac_f32_16x16x64_bf16 v[72:75], v[20:23], a[160:167], v128
  s_add_u32 s21, s21, 1
  s_waitcnt lgkmcnt(3)
  v_smfmac_f32_16x16x64_bf16 v[72:75], v[24:27], v[112:119], v128
  buffer_load_dword v7, v137, s[28:31], 0 offen sc1
  s_waitcnt lgkmcnt(2)
  v_smfmac_f32_16x16x64_bf16 v[72:75], v[28:31], a[176:183], v128
  ds_read_b128 v[112:115], v139 offset:6144
  v_smfmac_f32_16x16x64_bf16 v[64:67], v[8:11], v[32:39], v128
  ds_read_b128 v[116:119], v139 offset:7168
  v_smfmac_f32_16x16x64_bf16 v[64:67], v[12:15], v[48:55], v128
  s_add_u32 s17, s17, 1
  v_smfmac_f32_16x16x64_bf16 v[64:67], v[16:19], a[32:39], v128
  buffer_store_dword v138, v132, s[4:7], s23 offen sc1
  v_smfmac_f32_16x16x64_bf16 v[64:67], v[20:23], a[48:55], v128
  s_waitcnt vmcnt(4)
  v_smfmac_f32_16x16x64_bf16 v[64:67], v[24:27], a[64:71], v128
  ds_read_b128 v[32:35], v139 offset:0
  v_lshrrev_b32 v4, 1, v133
  v_smfmac_f32_16x16x64_bf16 v[64:67], v[28:31], a[80:87], v128
  ds_read_b128 v[36:39], v139 offset:1024
  v_and_b32 v4, 128, v4
  v_smfmac_f32_16x16x64_bf16 v[68:71], v[8:11], v[40:47], v128
  ds_read_b128 v[48:51], v141 offset:32768
  v_xor_b32 v0, v4, v133
  v_smfmac_f32_16x16x64_bf16 v[68:71], v[12:15], v[56:63], v128
  ds_read_b128 v[52:55], v141 offset:33792
  v_and_or_b32 v1, v134, s35, v4
  v_smfmac_f32_16x16x64_bf16 v[68:71], v[16:19], a[40:47], v128
  ds_read_b128 v[40:43], v139 offset:2048
  v_and_or_b32 v2, v135, s35, v4
  v_smfmac_f32_16x16x64_bf16 v[68:71], v[20:23], a[56:63], v128
  ds_read_b128 v[44:47], v139 offset:3072
  v_and_or_b32 v3, v136, s35, v4
  v_smfmac_f32_16x16x64_bf16 v[68:71], v[24:27], a[72:79], v128
  v_smfmac_f32_16x16x64_bf16 v[68:71], v[28:31], a[88:95], v128
  ds_read_b128 v[56:59], v141 offset:34816
  s_waitcnt lgkmcnt(7)
  v_smfmac_f32_16x16x64_bf16 v[76:79], v[8:11], v[104:111], v128
  buffer_store_dword v140, v132, s[4:7], s13 offen
  s_add_u32 s15, s12, 262144
  v_smfmac_f32_16x16x64_bf16 v[76:79], v[12:15], a[136:143], v128
  ds_read_b128 v[60:63], v141 offset:35840
  v_cvt_pk_bf16_f32 v106, v72, v73
  v_smfmac_f32_16x16x64_bf16 v[76:79], v[16:19], a[152:159], v128
  buffer_store_dword v140, v131, s[4:7], s14 offen
  v_smfmac_f32_16x16x64_bf16 v[76:79], v[20:23], a[168:175], v128
  s_add_u32 s20, s20, 8320
  s_mov_b32 s23, s20
  v_cvt_pk_bf16_f32 v107, v74, v75
  v_smfmac_f32_16x16x64_bf16 v[76:79], v[24:27], v[112:119], v128
  buffer_store_dword v140, v131, s[4:7], s14 offen offset:1024
  v_smfmac_f32_16x16x64_bf16 v[76:79], v[28:31], a[184:191], v128
  v_cvt_pk_bf16_f32 v104, v64, v65
  v_cvt_pk_bf16_f32 v105, v66, v67
  v_cvt_pk_bf16_f32 v108, v68, v69
  v_cvt_pk_bf16_f32 v109, v70, v71
  v_mfma_f32_16x16x32_bf16 v[64:67], v[104:107], v[120:123], 0
  v_cvt_pk_bf16_f32 v110, v76, v77
  v_cvt_pk_bf16_f32 v111, v78, v79
  s_waitcnt lgkmcnt(0)
  s_nop 0
  v_mfma_f32_16x16x32_bf16 v[68:71], v[108:111], v[120:123], 0
  v_smfmac_f32_16x16x64_bf16 v[84:87], v[24:27], v[40:47], v128
  v_cvt_pk_bf16_f32 v112, v64, v65
  v_cvt_pk_bf16_f32 v113, v66, v67
  v_cvt_pk_bf16_f32 v114, v68, v69
  v_cvt_pk_bf16_f32 v115, v70, v71
  s_nop 1
  v_mfma_f32_16x16x32_bf16 v[64:67], v[88:91], v[112:115], 0
  v_mfma_f32_16x16x32_bf16 v[68:71], v[92:95], v[112:115], 0
  v_mfma_f32_16x16x32_bf16 v[72:75], v[112:115], v[112:115], 0
  v_smfmac_f32_16x16x64_bf16 v[84:87], v[28:31], v[56:63], v128
  v_mov_b32_dpp v64, v68 row_ror:8 row_mask:0xf bank_mask:0xc
  v_mov_b32_dpp v65, v69 row_ror:8 row_mask:0xf bank_mask:0xc
  v_mov_b32_dpp v66, v70 row_ror:8 row_mask:0xf bank_mask:0xc
  v_mov_b32_dpp v67, v71 row_ror:8 row_mask:0xf bank_mask:0xc
  v_smfmac_f32_16x16x64_bf16 v[80:83], v[24:27], v[32:39], v128
  ds_write_b128 v133, v[64:67] offset:8192
  v_mov_b32_dpp v72, v74 row_ror:8 row_mask:0xf bank_mask:0xc
  v_mov_b32_dpp v73, v75 row_ror:8 row_mask:0xf bank_mask:0xc
  v_smfmac_f32_16x16x64_bf16 v[80:83], v[28:31], v[48:55], v128
  ds_write_b64 v129, v[72:73] offset:9216
  v_smfmac_f32_16x16x64_bf16 v[80:83], v[16:19], v[144:151], v128
  buffer_load_dwordx4 v[88:91], v133, s[4:7], s16 offen sc1
  v_smfmac_f32_16x16x64_bf16 v[80:83], v[20:23], v[160:167], v128
  v_mov_b64 v[24:25], 0
  v_smfmac_f32_16x16x64_bf16 v[80:83], v[8:11], a[224:231], v128
  buffer_load_dwordx4 v[92:95], v133, s[4:7], s16 offen offset:1024 sc1
  v_smfmac_f32_16x16x64_bf16 v[80:83], v[12:15], a[240:247], v128
  s_waitcnt lgkmcnt(0)
  s_barrier
  ds_read_b128 v[68:71], v134 offset:8192
  v_smfmac_f32_16x16x64_bf16 v[84:87], v[16:19], v[152:159], v128
  ds_read_b128 v[72:75], v135 offset:8192
  ds_read_b128 v[76:79], v136 offset:8192
  v_mov_b64 v[26:27], 0
  v_smfmac_f32_16x16x64_bf16 v[84:87], v[20:23], v[168:175], v128
  ds_read_b128 v[104:107], v137 offset:9216
  ds_read_b128 v[108:111], v137 offset:11264
  v_mov_b64 v[28:29], 0
  v_smfmac_f32_16x16x64_bf16 v[84:87], v[8:11], a[232:239], v128
  v_mov_b64 v[30:31], 0
  v_smfmac_f32_16x16x64_bf16 v[84:87], v[12:15], a[248:255], v128
  v_mov_b64 v[16:17], 0
  s_waitcnt lgkmcnt(2)
  v_pk_add_f32 v[64:65], v[64:65], v[68:69]
  v_pk_add_f32 v[66:67], v[66:67], v[70:71]
  v_pk_add_f32 v[72:73], v[72:73], v[76:77]
  v_pk_add_f32 v[74:75], v[74:75], v[78:79]
  v_pk_add_f32 v[64:65], v[64:65], v[72:73]
  v_pk_add_f32 v[66:67], v[66:67], v[74:75]
  s_waitcnt lgkmcnt(0)
  v_pk_add_f32 v[104:105], v[104:105], v[106:107]
  v_pk_add_f32 v[108:109], v[108:109], v[110:111]
  v_pk_add_f32 v[104:105], v[104:105], v[108:109]
  v_max3_f32 v106, v64, v65, v66
  v_max3_f32 v107, v67, v104, v105
  v_max_f32 v106, v106, v107
  v_cvt_pk_bf16_f32 v116, v80, v81
  v_cvt_pk_bf16_f32 v117, v82, v83
  v_max_f32_dpp v107, v106, v106 row_ror:8 row_mask:0xf bank_mask:0xf
  v_max_f32_dpp v106, v106, v106 row_ror:8 row_mask:0xf bank_mask:0xf
  v_cvt_pk_bf16_f32 v118, v84, v85
  v_cvt_pk_bf16_f32 v119, v86, v87
  v_permlane16_swap_b32 v106, v107
  v_max_f32 v108, v106, v107
  v_max_f32 v109, v106, v107
  v_pk_mov_b32 v[70:71], s[58:59], s[58:59] op_sel:[0,0]
  v_pk_mov_b32 v[68:69], s[58:59], s[58:59] op_sel:[1,1]
  v_permlane32_swap_b32 v108, v109
  v_max_f32 v106, v108, v109
  v_mul_f32 v106, s26, v106
  v_pk_fma_f32 v[64:65], v[64:65], s[26:27], v[106:107] op_sel_hi:[1,0,0] neg_lo:[0,0,1] neg_hi:[0,0,1]
  v_pk_fma_f32 v[66:67], v[66:67], s[26:27], v[106:107] op_sel_hi:[1,0,0] neg_lo:[0,0,1] neg_hi:[0,0,1]
  v_pk_fma_f32 v[104:105], v[104:105], s[26:27], v[106:107] op_sel_hi:[1,0,0] neg_lo:[0,0,1] neg_hi:[0,0,1]
  v_exp_f32 v104, v104
  v_exp_f32 v105, v105
  v_exp_f32 v64, v64
  v_exp_f32 v65, v65
  v_exp_f32 v66, v66
  v_exp_f32 v67, v67
  v_cvt_pk_bf16_f32 v108, v104, v105
  v_cvt_pk_bf16_f32 v110, v64, v65
  v_cvt_pk_bf16_f32 v111, v66, v67
  v_mov_b32_dpp v109, v108 row_ror:8 row_mask:0xf bank_mask:0xf
  v_mov_b32_dpp v112, v110 row_ror:8 row_mask:0xf bank_mask:0xf
  v_mov_b32_dpp v113, v111 row_ror:8 row_mask:0xf bank_mask:0xf
  v_mfma_f32_16x16x32_bf16 v[72:75], v[68:71], v[108:111], 0
  ds_read_b128 v[32:35], v141 offset:4096
  s_waitcnt vmcnt(6)
  v_mfma_f32_16x16x32_bf16 v[80:83], v[96:99], v[110:113], 0
  ds_read_b128 v[36:39], v141 offset:5120
  v_mov_b64 v[18:19], 0
  v_mfma_f32_16x16x32_bf16 v[84:87], v[100:103], v[110:113], 0
  ds_read_b128 v[48:51], v142 offset:0
  v_add_f32_dpp v106, v72, v72 row_ror:8 row_mask:0xf bank_mask:0xf
  v_mfma_f32_16x16x16_bf16 v[80:83], v[116:117], v[108:109], v[80:83]
  ds_read_b128 v[52:55], v142 offset:1024
  v_rcp_f32 v106, v106
  v_mfma_f32_16x16x16_bf16 v[84:87], v[118:119], v[108:109], v[84:87]
  ds_read_b128 v[40:43], v141 offset:6144
  s_nop 0
  v_mov_b64 v[20:21], 0
  v_mov_b64 v[22:23], 0
  v_pk_mul_f32 v[80:81], v[80:81], v[106:107] op_sel_hi:[1,0]
  v_pk_mul_f32 v[82:83], v[82:83], v[106:107] op_sel_hi:[1,0]
  v_cvt_pk_bf16_f32 v108, v80, v81
  v_cvt_pk_bf16_f32 v109, v82, v83
  v_pk_mul_f32 v[84:85], v[84:85], v[106:107] op_sel_hi:[1,0]
  v_pk_mul_f32 v[86:87], v[86:87], v[106:107] op_sel_hi:[1,0]
  v_cvt_pk_bf16_f32 v110, v84, v85
  v_cvt_pk_bf16_f32 v111, v86, v87
  ds_write_b128 v0, v[108:111]
  v_mov_b32_dpp v108, v108 row_ror:8 row_mask:0xf bank_mask:0xc
  v_mov_b32_dpp v109, v109 row_ror:8 row_mask:0xf bank_mask:0xc
  v_mov_b32_dpp v110, v110 row_ror:8 row_mask:0xf bank_mask:0xc
  v_mov_b32_dpp v111, v111 row_ror:8 row_mask:0xf bank_mask:0xc
  v_cmp_ge_u32 s[24:25], s21, v7
  s_nop 0
  v_smfmac_f32_16x16x64_bf16 v[24:27], v[108:111], v[192:199], v128
  s_waitcnt lgkmcnt(0)
  s_barrier
  ds_read_b128 v[96:99], v1
  ds_read_b128 v[100:103], v2
  ds_read_b128 v[112:115], v3
  v_smfmac_f32_16x16x64_bf16 v[28:31], v[108:111], v[200:207], v128
  s_add_u32 s36, s12, 65536
  v_smfmac_f32_16x16x64_bf16 v[20:23], v[108:111], v[184:191], v128
  s_add_u32 s37, s12, 131072
  v_smfmac_f32_16x16x64_bf16 v[16:19], v[108:111], v[176:183], v128
  ds_read_b128 v[0:3], v141 offset:36864
  s_add_u32 s38, s12, 196608
  s_waitcnt lgkmcnt(3)
  v_smfmac_f32_16x16x64_bf16 v[16:19], v[96:99], v[208:215], v128
  ds_read_b128 v[4:7], v141 offset:37888
  s_waitcnt lgkmcnt(3)
  v_smfmac_f32_16x16x64_bf16 v[16:19], v[100:103], v[224:231], v128
  ds_read_b128 v[44:47], v141 offset:7168
  s_waitcnt lgkmcnt(3)
  v_smfmac_f32_16x16x64_bf16 v[16:19], v[112:115], v[240:247], v128
  ds_read_b128 v[56:59], v142 offset:2048
  v_smfmac_f32_16x16x64_bf16 v[20:23], v[96:99], v[216:223], v128
  ds_read_b128 v[60:63], v142 offset:3072
  v_smfmac_f32_16x16x64_bf16 v[20:23], v[100:103], v[232:239], v128
  ds_read_b128 v[8:11], v141 offset:38912
  v_cvt_pk_bf16_f32 v80, v16, v17
  v_cvt_pk_bf16_f32 v81, v18, v19
  v_smfmac_f32_16x16x64_bf16 v[20:23], v[112:115], v[248:255], v128
  buffer_store_dwordx2 v[80:81], v130, s[4:7], s12 offen
  v_smfmac_f32_16x16x64_bf16 v[24:27], v[96:99], v[32:39], v128
  ds_read_b128 v[12:15], v141 offset:39936
  v_smfmac_f32_16x16x64_bf16 v[24:27], v[100:103], v[48:55], v128
  s_waitcnt lgkmcnt(2)
  v_cvt_pk_bf16_f32 v82, v20, v21
  v_cvt_pk_bf16_f32 v83, v22, v23
  v_smfmac_f32_16x16x64_bf16 v[24:27], v[112:115], v[0:7], v128
  buffer_store_dwordx2 v[82:83], v130, s[4:7], s36 offen
  v_smfmac_f32_16x16x64_bf16 v[28:31], v[96:99], v[40:47], v128
  v_smfmac_f32_16x16x64_bf16 v[28:31], v[100:103], v[56:63], v128
  s_waitcnt lgkmcnt(0)
  v_cvt_pk_bf16_f32 v84, v24, v25
  v_cvt_pk_bf16_f32 v85, v26, v27
  v_smfmac_f32_16x16x64_bf16 v[28:31], v[112:115], v[8:15], v128
  buffer_store_dwordx2 v[84:85], v130, s[4:7], s37 offen
  s_nop 6
  v_cvt_pk_bf16_f32 v86, v28, v29
  v_cvt_pk_bf16_f32 v87, v30, v31
  buffer_store_dwordx2 v[86:87], v130, s[4:7], s38 offen
  s_barrier
  s_cmp_eq_u32 s11, 1
  s_cbranch_scc1 Lh1
  s_cmp_eq_u32 s11, 2
  s_cbranch_scc1 Lh2
  s_cmp_eq_u32 s11, 3
  s_cbranch_scc1 Lh3
Lh0:
  ds_read_b128 v[32:35], v141 offset:0
  s_nop 1
  ds_read_b128 v[36:39], v141 offset:1024
  s_nop 1
  s_nop 5
  buffer_load_dwordx4 v[0:3], v131, s[4:7], s12 offen offset:0 sc1
  buffer_load_dwordx4 v[4:7], v131, s[4:7], s12 offen offset:1024 sc1
  v_mov_b64 v[64:65], 0
  v_mov_b64 v[66:67], 0
  v_mov_b64 v[68:69], 0
  v_mov_b64 v[70:71], 0
  v_mov_b64 v[72:73], 0
  v_mov_b64 v[74:75], 0
  v_mov_b64 v[76:77], 0
  v_mov_b64 v[78:79], 0
  v_mov_b64 v[80:81], 0
  v_mov_b64 v[82:83], 0
  v_mov_b64 v[84:85], 0
  v_mov_b64 v[86:87], 0
  s_nop 15
  s_nop 15
  s_nop 3
  buffer_load_dwordx4 v[8:11], v131, s[4:7], s12 offen offset:0 sc1
  buffer_load_dwordx4 v[12:15], v131, s[4:7], s12 offen offset:1024 sc1
  ds_read_b128 v[40:43], v141 offset:2048
  ds_read_b128 v[44:47], v141 offset:3072
  ds_read_b128 v[48:51], v139 offset:36864
  ds_read_b128 v[52:55], v139 offset:37888
  ds_read_b128 v[56:59], v139 offset:38912
  ds_read_b128 v[60:63], v139 offset:39936
  ds_read_b128 v[104:107], v139 offset:32768
Lp1w0:
  s_waitcnt vmcnt(3)
  v_mfma_f32_16x16x32_bf16 v[96:99], v[124:127], v[0:3], 0
  s_waitcnt vmcnt(2)
  v_mfma_f32_16x16x32_bf16 v[96:99], v[124:127], v[4:7], v[96:99]
  s_nop 7
  v_add_f32_dpp v96, v96, v96 row_ror:4 row_mask:0xf bank_mask:0xf
  v_add_f32_dpp v97, v97, v97 row_ror:4 row_mask:0xf bank_mask:0xf
  s_nop 0
  v_add_f32_dpp v96, v96, v96 row_ror:8 row_mask:0xf bank_mask:0xf
  v_add_f32_dpp v97, v97, v97 row_ror:8 row_mask:0xf bank_mask:0xf
  s_mov_b64 exec, s[60:61]
  v_cvt_pk_bf16_f32 v138, v96, v97
  buffer_store_dword v138, v132, s[4:7], s12 offen
  v_cmp_u_f32 vcc, v97, v97
  s_mov_b64 exec, -1
  s_cbranch_vccnz Lp1r0
Lp1done0:
  s_cmp_ge_u32 s17, 63
  s_cbranch_scc1 Lexit
  ds_read_b128 v[108:111], v139 offset:33792
  ds_read_b128 v[112:115], v139 offset:4096
  ds_read_b128 v[116:119], v139 offset:5120
  s_and_b32 s24, s24, 15
  s_cbranch_scc1 LkvB
  s_nop 15
  s_nop 3
Lp2_0:
  buffer_load_dwordx4 v[0:3], v133, s[4:7], s15 offen sc1
  buffer_load_dwordx4 v[4:7], v133, s[4:7], s15 offen offset:1024 sc1
  s_mov_b32 s36, s12
  s_mov_b32 s12, s13
  s_mov_b32 s13, s14
  s_mov_b32 s14, s36
  s_nop 15
  s_nop 15
  buffer_load_dwordx4 v[0:3], v133, s[4:7], s15 offen sc1
  buffer_load_dwordx4 v[4:7], v133, s[4:7], s15 offen offset:1024 sc1
  s_branch Lp2a
Lp1r0:
  s_waitcnt vmcnt(2)
  v_mfma_f32_16x16x32_bf16 v[96:99], v[124:127], v[8:11], 0
  s_waitcnt vmcnt(1)
  v_mfma_f32_16x16x32_bf16 v[96:99], v[124:127], v[12:15], v[96:99]
  s_nop 7
  v_add_f32_dpp v96, v96, v96 row_ror:4 row_mask:0xf bank_mask:0xf
  v_add_f32_dpp v97, v97, v97 row_ror:4 row_mask:0xf bank_mask:0xf
  s_nop 0
  v_add_f32_dpp v96, v96, v96 row_ror:8 row_mask:0xf bank_mask:0xf
  v_add_f32_dpp v97, v97, v97 row_ror:8 row_mask:0xf bank_mask:0xf
  s_mov_b64 exec, s[60:61]
  v_cvt_pk_bf16_f32 v138, v96, v97
  buffer_store_dword v138, v132, s[4:7], s12 offen
  v_cmp_u_f32 vcc, v97, v97
  s_mov_b64 exec, -1
  s_cbranch_vccz Lp1done0
  buffer_load_dwordx4 v[0:3], v131, s[4:7], s12 offen offset:0 sc1
  buffer_load_dwordx4 v[4:7], v131, s[4:7], s12 offen offset:1024 sc1
  s_nop 15
  s_nop 7
  buffer_load_dwordx4 v[8:11], v131, s[4:7], s12 offen offset:0 sc1
  buffer_load_dwordx4 v[12:15], v131, s[4:7], s12 offen offset:1024 sc1
  s_sub_u32 s18, s18, 1
  s_cbranch_scc0 Lp1w0
  s_mov_b32 s18, 0
  v_mov_b32 v138, 0x7fc07fc0
  s_waitcnt vmcnt(0)
  buffer_store_dword v138, v132, s[4:7], s12 offen
  s_branch Lp1done0
Lh1:
  ds_read_b128 v[32:35], v141 offset:0
  s_nop 1
  ds_read_b128 v[36:39], v141 offset:1024
  s_nop 1
  ds_read_b128 v[40:43], v141 offset:2048
  s_nop 1
  ds_read_b128 v[44:47], v141 offset:3072
  s_nop 1
  ds_read_b128 v[48:51], v139 offset:36864
  s_nop 1
  ds_read_b128 v[52:55], v139 offset:37888
  s_nop 1
  ds_read_b128 v[56:59], v139 offset:38912
  s_nop 1
  ds_read_b128 v[60:63], v139 offset:39936
  s_nop 1
  s_nop 4
  buffer_load_dwordx4 v[0:3], v131, s[4:7], s12 offen offset:0 sc1
  buffer_load_dwordx4 v[4:7], v131, s[4:7], s12 offen offset:1024 sc1
  v_mov_b64 v[64:65], 0
  v_mov_b64 v[66:67], 0
  v_mov_b64 v[68:69], 0
  v_mov_b64 v[70:71], 0
  v_mov_b64 v[72:73], 0
  v_mov_b64 v[74:75], 0
  v_mov_b64 v[76:77], 0
  v_mov_b64 v[78:79], 0
  v_mov_b64 v[80:81], 0
  v_mov_b64 v[82:83], 0
  v_mov_b64 v[84:85], 0
  v_mov_b64 v[86:87], 0
  s_nop 15
  s_nop 5
  buffer_load_dwordx4 v[8:11], v131, s[4:7], s12 offen offset:0 sc1
  buffer_load_dwordx4 v[12:15], v131, s[4:7], s12 offen offset:1024 sc1
  ds_read_b128 v[104:107], v139 offset:32768
  ds_read_b128 v[108:111], v139 offset:33792
  ds_read_b128 v[112:115], v139 offset:4096
  ds_read_b128 v[116:119], v139 offset:5120
Lp1w1:
  s_waitcnt vmcnt(3)
  v_mfma_f32_16x16x32_bf16 v[96:99], v[124:127], v[0:3], 0
  s_waitcnt vmcnt(2)
  v_mfma_f32_16x16x32_bf16 v[96:99], v[124:127], v[4:7], v[96:99]
  s_nop 7
  v_add_f32_dpp v96, v96, v96 row_ror:4 row_mask:0xf bank_mask:0xf
  v_add_f32_dpp v97, v97, v97 row_ror:4 row_mask:0xf bank_mask:0xf
  s_nop 0
  v_add_f32_dpp v96, v96, v96 row_ror:8 row_mask:0xf bank_mask:0xf
  v_add_f32_dpp v97, v97, v97 row_ror:8 row_mask:0xf bank_mask:0xf
  s_mov_b64 exec, s[60:61]
  v_cvt_pk_bf16_f32 v138, v96, v97
  buffer_store_dword v138, v132, s[4:7], s12 offen
  v_cmp_u_f32 vcc, v97, v97
  s_mov_b64 exec, -1
  s_cbranch_vccnz Lp1r1
Lp1done1:
  s_cmp_ge_u32 s17, 63
  s_cbranch_scc1 Lexit
  s_nop 15
  s_nop 15
  s_nop 1
Lp2_1:
  buffer_load_dwordx4 v[0:3], v133, s[4:7], s15 offen sc1
  buffer_load_dwordx4 v[4:7], v133, s[4:7], s15 offen offset:1024 sc1
  s_mov_b32 s36, s12
  s_mov_b32 s12, s13
  s_mov_b32 s13, s14
  s_mov_b32 s14, s36
  s_nop 15
  s_nop 15
  s_nop 5
  buffer_load_dwordx4 v[0:3], v133, s[4:7], s15 offen sc1
  buffer_load_dwordx4 v[4:7], v133, s[4:7], s15 offen offset:1024 sc1
  s_branch Lp2a
Lp1r1:
  s_waitcnt vmcnt(2)
  v_mfma_f32_16x16x32_bf16 v[96:99], v[124:127], v[8:11], 0
  s_waitcnt vmcnt(1)
  v_mfma_f32_16x16x32_bf16 v[96:99], v[124:127], v[12:15], v[96:99]
  s_nop 7
  v_add_f32_dpp v96, v96, v96 row_ror:4 row_mask:0xf bank_mask:0xf
  v_add_f32_dpp v97, v97, v97 row_ror:4 row_mask:0xf bank_mask:0xf
  s_nop 0
  v_add_f32_dpp v96, v96, v96 row_ror:8 row_mask:0xf bank_mask:0xf
  v_add_f32_dpp v97, v97, v97 row_ror:8 row_mask:0xf bank_mask:0xf
  s_mov_b64 exec, s[60:61]
  v_cvt_pk_bf16_f32 v138, v96, v97
  buffer_store_dword v138, v132, s[4:7], s12 offen
  v_cmp_u_f32 vcc, v97, v97
  s_mov_b64 exec, -1
  s_cbranch_vccz Lp1done1
  buffer_load_dwordx4 v[0:3], v131, s[4:7], s12 offen offset:0 sc1
  buffer_load_dwordx4 v[4:7], v131, s[4:7], s12 offen offset:1024 sc1
  s_nop 15
  s_nop 7
  buffer_load_dwordx4 v[8:11], v131, s[4:7], s12 offen offset:0 sc1
  buffer_load_dwordx4 v[12:15], v131, s[4:7], s12 offen offset:1024 sc1
  s_sub_u32 s18, s18, 1
  s_cbranch_scc0 Lp1w1
  s_mov_b32 s18, 0
  v_mov_b32 v138, 0x7fc07fc0
  s_waitcnt vmcnt(0)
  buffer_store_dword v138, v132, s[4:7], s12 offen
  s_branch Lp1done1
Lh2:
  ds_read_b128 v[32:35], v141 offset:0
  s_nop 1
  s_nop 15
  s_nop 15
  s_nop 5
  buffer_load_dwordx4 v[0:3], v131, s[4:7], s12 offen offset:0 sc1
  buffer_load_dwordx4 v[4:7], v131, s[4:7], s12 offen offset:1024 sc1
  v_mov_b64 v[64:65], 0
  v_mov_b64 v[66:67], 0
  v_mov_b64 v[68:69], 0
  v_mov_b64 v[70:71], 0
  v_mov_b64 v[72:73], 0
  v_mov_b64 v[74:75], 0
  v_mov_b64 v[76:77], 0
  v_mov_b64 v[78:79], 0
  v_mov_b64 v[80:81], 0
  v_mov_b64 v[82:83], 0
  v_mov_b64 v[84:85], 0
  v_mov_b64 v[86:87], 0
  s_nop 14
  buffer_load_dwordx4 v[8:11], v131, s[4:7], s12 offen offset:0 sc1
  buffer_load_dwordx4 v[12:15], v131, s[4:7], s12 offen offset:1024 sc1
Lp1w2:
  s_waitcnt vmcnt(3)
  v_mfma_f32_16x16x32_bf16 v[96:99], v[124:127], v[0:3], 0
  s_waitcnt vmcnt(2)
  v_mfma_f32_16x16x32_bf16 v[96:99], v[124:127], v[4:7], v[96:99]
  s_nop 7
  v_add_f32_dpp v96, v96, v96 row_ror:4 row_mask:0xf bank_mask:0xf
  v_add_f32_dpp v97, v97, v97 row_ror:4 row_mask:0xf bank_mask:0xf
  s_nop 0
  v_add_f32_dpp v96, v96, v96 row_ror:8 row_mask:0xf bank_mask:0xf
  v_add_f32_dpp v97, v97, v97 row_ror:8 row_mask:0xf bank_mask:0xf
  s_mov_b64 exec, s[60:61]
  v_cvt_pk_bf16_f32 v138, v96, v97
  buffer_store_dword v138, v132, s[4:7], s12 offen
  v_cmp_u_f32 vcc, v97, v97
  s_mov_b64 exec, -1
  s_cbranch_vccnz Lp1r2
Lp1done2:
  s_cmp_ge_u32 s17, 63
  s_cbranch_scc1 Lexit
  ds_read_b128 v[36:39], v141 offset:1024
  ds_read_b128 v[40:43], v141 offset:2048
  ds_read_b128 v[44:47], v141 offset:3072
  ds_read_b128 v[48:51], v139 offset:36864
  ds_read_b128 v[52:55], v139 offset:37888
  ds_read_b128 v[56:59], v139 offset:38912
  ds_read_b128 v[60:63], v139 offset:39936
  ds_read_b128 v[104:107], v139 offset:32768
  ds_read_b128 v[108:111], v139 offset:33792
  ds_read_b128 v[112:115], v139 offset:4096
  ds_read_b128 v[116:119], v139 offset:5120
  s_nop 15
  s_nop 8
Lp2_2:
  buffer_load_dwordx4 v[0:3], v133, s[4:7], s15 offen sc1
  buffer_load_dwordx4 v[4:7], v133, s[4:7], s15 offen offset:1024 sc1
  s_mov_b32 s36, s12
  s_mov_b32 s12, s13
  s_mov_b32 s13, s14
  s_mov_b32 s14, s36
  s_nop 15
  s_nop 15
  s_nop 3
  buffer_load_dwordx4 v[0:3], v133, s[4:7], s15 offen sc1
  buffer_load_dwordx4 v[4:7], v133, s[4:7], s15 offen offset:1024 sc1
  s_branch Lp2a
Lp1r2:
  s_waitcnt vmcnt(2)
  v_mfma_f32_16x16x32_bf16 v[96:99], v[124:127], v[8:11], 0
  s_waitcnt vmcnt(1)
  v_mfma_f32_16x16x32_bf16 v[96:99], v[124:127], v[12:15], v[96:99]
  s_nop 7
  v_add_f32_dpp v96, v96, v96 row_ror:4 row_mask:0xf bank_mask:0xf
  v_add_f32_dpp v97, v97, v97 row_ror:4 row_mask:0xf bank_mask:0xf
  s_nop 0
  v_add_f32_dpp v96, v96, v96 row_ror:8 row_mask:0xf bank_mask:0xf
  v_add_f32_dpp v97, v97, v97 row_ror:8 row_mask:0xf bank_mask:0xf
  s_mov_b64 exec, s[60:61]
  v_cvt_pk_bf16_f32 v138, v96, v97
  buffer_store_dword v138, v132, s[4:7], s12 offen
  v_cmp_u_f32 vcc, v97, v97
  s_mov_b64 exec, -1
  s_cbranch_vccz Lp1done2
  buffer_load_dwordx4 v[0:3], v131, s[4:7], s12 offen offset:0 sc1
  buffer_load_dwordx4 v[4:7], v131, s[4:7], s12 offen offset:1024 sc1
  s_nop 15
  s_nop 7
  buffer_load_dwordx4 v[8:11], v131, s[4:7], s12 offen offset:0 sc1
  buffer_load_dwordx4 v[12:15], v131, s[4:7], s12 offen offset:1024 sc1
  s_sub_u32 s18, s18, 1
  s_cbranch_scc0 Lp1w2
  s_mov_b32 s18, 0
  v_mov_b32 v138, 0x7fc07fc0
  s_waitcnt vmcnt(0)
  buffer_store_dword v138, v132, s[4:7], s12 offen
  s_branch Lp1done2
Lh3:
  ds_read_b128 v[32:35], v141 offset:0
  s_nop 1
  ds_read_b128 v[36:39], v141 offset:1024
  s_nop 1
  ds_read_b128 v[40:43], v141 offset:2048
  s_nop 1
  ds_read_b128 v[44:47], v141 offset:3072
  s_nop 1
  ds_read_b128 v[48:51], v139 offset:36864
  s_nop 1
  ds_read_b128 v[52:55], v139 offset:37888
  s_nop 1
  ds_read_b128 v[56:59], v139 offset:38912
  s_nop 1
  ds_read_b128 v[60:63], v139 offset:39936
  s_nop 1
  ds_read_b128 v[104:107], v139 offset:32768
  s_nop 1
  ds_read_b128 v[108:111], v139 offset:33792
  s_nop 1
  ds_read_b128 v[112:115], v139 offset:4096
  s_nop 1
  s_nop 8
  buffer_load_dwordx4 v[0:3], v131, s[4:7], s12 offen offset:0 sc1
  buffer_load_dwordx4 v[4:7], v131, s[4:7], s12 offen offset:1024 sc1
  v_mov_b64 v[64:65], 0
  v_mov_b64 v[66:67], 0
  v_mov_b64 v[68:69], 0
  v_mov_b64 v[70:71], 0
  v_mov_b64 v[72:73], 0
  v_mov_b64 v[74:75], 0
  v_mov_b64 v[76:77], 0
  v_mov_b64 v[78:79], 0
  v_mov_b64 v[80:81], 0
  v_mov_b64 v[82:83], 0
  v_mov_b64 v[84:85], 0
  v_mov_b64 v[86:87], 0
  s_nop 15
  s_nop 6
  buffer_load_dwordx4 v[8:11], v131, s[4:7], s12 offen offset:0 sc1
  buffer_load_dwordx4 v[12:15], v131, s[4:7], s12 offen offset:1024 sc1
  ds_read_b128 v[116:119], v139 offset:5120
Lp1w3:
  s_waitcnt vmcnt(3)
  v_mfma_f32_16x16x32_bf16 v[96:99], v[124:127], v[0:3], 0
  s_waitcnt vmcnt(2)
  v_mfma_f32_16x16x32_bf16 v[96:99], v[124:127], v[4:7], v[96:99]
  s_nop 7
  v_add_f32_dpp v96, v96, v96 row_ror:4 row_mask:0xf bank_mask:0xf
  v_add_f32_dpp v97, v97, v97 row_ror:4 row_mask:0xf bank_mask:0xf
  s_nop 0
  v_add_f32_dpp v96, v96, v96 row_ror:8 row_mask:0xf bank_mask:0xf
  v_add_f32_dpp v97, v97, v97 row_ror:8 row_mask:0xf bank_mask:0xf
  s_mov_b64 exec, s[60:61]
  v_cvt_pk_bf16_f32 v138, v96, v97
  buffer_store_dword v138, v132, s[4:7], s12 offen
  v_cmp_u_f32 vcc, v97, v97
  s_mov_b64 exec, -1
  s_cbranch_vccnz Lp1r3
Lp1done3:
  s_cmp_ge_u32 s17, 63
  s_cbranch_scc1 Lexit
  s_nop 15
  s_nop 4
Lp2_3:
  buffer_load_dwordx4 v[0:3], v133, s[4:7], s15 offen sc1
  buffer_load_dwordx4 v[4:7], v133, s[4:7], s15 offen offset:1024 sc1
  s_mov_b32 s36, s12
  s_mov_b32 s12, s13
  s_mov_b32 s13, s14
  s_mov_b32 s14, s36
  s_nop 15
  s_nop 12
  buffer_load_dwordx4 v[0:3], v133, s[4:7], s15 offen sc1
  buffer_load_dwordx4 v[4:7], v133, s[4:7], s15 offen offset:1024 sc1
  s_branch Lp2a
Lp1r3:
  s_waitcnt vmcnt(2)
  v_mfma_f32_16x16x32_bf16 v[96:99], v[124:127], v[8:11], 0
  s_waitcnt vmcnt(1)
  v_mfma_f32_16x16x32_bf16 v[96:99], v[124:127], v[12:15], v[96:99]
  s_nop 7
  v_add_f32_dpp v96, v96, v96 row_ror:4 row_mask:0xf bank_mask:0xf
  v_add_f32_dpp v97, v97, v97 row_ror:4 row_mask:0xf bank_mask:0xf
  s_nop 0
  v_add_f32_dpp v96, v96, v96 row_ror:8 row_mask:0xf bank_mask:0xf
  v_add_f32_dpp v97, v97, v97 row_ror:8 row_mask:0xf bank_mask:0xf
  s_mov_b64 exec, s[60:61]
  v_cvt_pk_bf16_f32 v138, v96, v97
  buffer_store_dword v138, v132, s[4:7], s12 offen
  v_cmp_u_f32 vcc, v97, v97
  s_mov_b64 exec, -1
  s_cbranch_vccz Lp1done3
  buffer_load_dwordx4 v[0:3], v131, s[4:7], s12 offen offset:0 sc1
  buffer_load_dwordx4 v[4:7], v131, s[4:7], s12 offen offset:1024 sc1
  s_nop 15
  s_nop 7
  buffer_load_dwordx4 v[8:11], v131, s[4:7], s12 offen offset:0 sc1
  buffer_load_dwordx4 v[12:15], v131, s[4:7], s12 offen offset:1024 sc1
  s_sub_u32 s18, s18, 1
  s_cbranch_scc0 Lp1w3
  s_mov_b32 s18, 0
  v_mov_b32 v138, 0x7fc07fc0
  s_waitcnt vmcnt(0)
  buffer_store_dword v138, v132, s[4:7], s12 offen
  s_branch Lp1done3
.p2align 4
Lp2r:
  s_waitcnt vmcnt(1)
  v_max3_u32 v8, v0, v1, v2
  v_max_u32 v8, v8, v3
  s_waitcnt vmcnt(0)
  v_max3_u32 v8, v8, v4, v5
  v_max3_u32 v8, v8, v6, v7
  v_cmp_le_u32 vcc, 0xffc00000, v8
  v_mov_b64 v[64:65], 0
  v_mov_b64 v[66:67], 0
  s_nop 1
  v_smfmac_f32_16x16x64_bf16 v[64:67], v[0:3], a[0:7], v128
  s_cbranch_vccz Lp2cont
  s_mov_b64 exec, vcc
  buffer_load_dwordx4 v[0:3], v133, s[4:7], s15 offen sc1
  buffer_load_dwordx4 v[4:7], v133, s[4:7], s15 offen offset:1024 sc1
  s_mov_b64 exec, -1
  s_nop 15
Lp2q:
  s_mov_b64 exec, vcc
  buffer_load_dwordx4 v[0:3], v133, s[4:7], s15 offen sc1
  buffer_load_dwordx4 v[4:7], v133, s[4:7], s15 offen offset:1024 sc1
  s_mov_b64 exec, -1
  s_sub_u32 s18, s18, 1
  s_cbranch_scc1 Lp2giveup
  s_waitcnt vmcnt(3)
  v_max3_u32 v8, v0, v1, v2
  v_max_u32 v8, v8, v3
  s_waitcnt vmcnt(2)
  v_max3_u32 v8, v8, v4, v5
  v_max3_u32 v8, v8, v6, v7
  v_cmp_le_u32 vcc, 0xffc00000, v8
  v_mov_b64 v[64:65], 0
  v_mov_b64 v[66:67], 0
  s_nop 1
  v_smfmac_f32_16x16x64_bf16 v[64:67], v[0:3], a[0:7], v128
  s_cbranch_vccz Lp2cont
  s_branch Lp2q
Lp2giveup:
  s_mov_b32 s18, 0
  s_waitcnt vmcnt(0)
  s_branch Lp2cont
LkvB:
  s_mov_b64 exec, 15
  buffer_load_dword v16, v137, s[28:31], 0 offen sc1
  s_waitcnt vmcnt(0)
  v_cmp_ge_u32 vcc, s21, v16
  s_mov_b64 exec, -1
  s_cbranch_vccz Lp2_0
  s_sleep 1
  s_sub_u32 s18, s18, 1
  s_cbranch_scc0 LkvB
  s_mov_b32 s18, 0
  s_branch Lp2_0
Lexit:
  buffer_store_dword v138, v132, s[4:7], s23 offen sc1
  s_waitcnt vmcnt(0) lgkmcnt(0)
Lend:
Lend2:
s_endpgm
.section .rodata,"a"
.p2align 6
.amdhsa_kernel gated_mix__memory_aug_recurrent_mem_tr__ssm_conv_h3__prompt_kernel
  .amdhsa_next_free_vgpr 512
  .amdhsa_next_free_sgpr 102
  .amdhsa_accum_offset 256
  .amdhsa_group_segment_fixed_size 0
  .amdhsa_kernarg_size 136
  .amdhsa_user_sgpr_count 2
  .amdhsa_user_sgpr_kernarg_segment_ptr 1
  .amdhsa_system_sgpr_workgroup_id_x 1
  .amdhsa_float_denorm_mode_32 3
.end_amdhsa_kernel
```
